```python
import torch

def _softmax(x, axis=-1):
    return torch.softmax(x, dim=axis)

def _gelu(x):
    return torch.nn.functional.gelu(x, approximate='tanh')

def _silu(x):
    return torch.nn.functional.silu(x)

def _sigmoid(x):
    return torch.sigmoid(x)

def _layernorm(x, axis=-1, eps=1e-05):
    m = x.mean(dim=axis, keepdim=True)
    v = x.var(dim=axis, keepdim=True, unbiased=False)
    return (x - m) / torch.sqrt(v + eps)

def _scatter_add(tgt, idx, src, axis=0):
    return tgt.clone().index_add_(axis, idx, src)

def _segment_sum(src, seg, n):
    out = torch.zeros((n,) + src.shape[1:], dtype=src.dtype)
    return out.index_add_(0, seg, src)

def _pad(x, pw):
    flat = tuple((v for pair in reversed(pw) for v in pair))
    return torch.nn.functional.pad(x, flat)
kernel_name = 'parallel_sum__grouped_kv_mqa__mixer_gmlp__prompt'

def setup_inputs():

    _w = lambda a: (lambda t: t.to(torch.bfloat16) if t.is_floating_point() else t)(torch.as_tensor(a))

    def _A_setup():
        B, S, D, H = (1, 2048, 512, 32)
        Dh = D // H
        return {'x': _w((lambda *s: torch.randn(*s, dtype=torch.bfloat16) * 0.05)(B, S, D)), 'wq': _w((lambda *s: torch.randn(*s, dtype=torch.bfloat16) * 0.1)(D, H * Dh)), 'wk': _w((lambda *s: torch.randn(*s, dtype=torch.bfloat16) * 0.1)(D, Dh)), 'wv': _w((lambda *s: torch.randn(*s, dtype=torch.bfloat16) * 0.05)(D, Dh)), 'wo': _w((lambda *s: torch.randn(*s, dtype=torch.bfloat16) * 0.05)(H * Dh, D))}
    _A_in = _A_setup()

    def _B_setup():
        B, S, D, F = (1, 2048, 512, 1792)
        Fh = F // 2
        return {'x': _w((lambda *s: torch.randn(*s, dtype=torch.bfloat16) * 0.05)(B, S, D)), 'w_in': _w((lambda *s: torch.randn(*s, dtype=torch.bfloat16) * 0.2)(D, 2 * Fh)), 'w_sp': _w(0.01 * (lambda *s: torch.randn(*s, dtype=torch.bfloat16) * 0.2)(S, S)), 'b_sp': _w(1.0 + 0.01 * (lambda *s: torch.randn(*s, dtype=torch.bfloat16) * 0.05)(S)), 'w_out': _w((lambda *s: torch.randn(*s, dtype=torch.bfloat16) * 0.05)(Fh, D))}
    _B_in = _B_setup()
    return {'A_x': _A_in['x'], 'A_wq': _A_in['wq'], 'A_wk': _A_in['wk'], 'A_wv': _A_in['wv'], 'A_wo': _A_in['wo'], 'B_x': _B_in['x'], 'B_w_in': _B_in['w_in'], 'B_w_sp': _B_in['w_sp'], 'B_b_sp': _B_in['b_sp'], 'B_w_out': _B_in['w_out']}

def reference(A_x, A_wq, A_wk, A_wv, A_wo, B_x, B_w_in, B_w_sp, B_b_sp, B_w_out):

    def _A_ref(x, wq, wk, wv, wo):
        B, S, D = x.shape
        H = 32
        Dh = D // H
        q = (lambda x, *d: x.permute(*d))((x @ wq).reshape(B, S, H, Dh), 0, 2, 1, 3)
        k = x @ wk
        v = x @ wv
        scores = torch.einsum('bhqd,bkd->bhqk', q, k) * Dh ** (-0.5)
        p = _softmax(scores, axis=-1)
        o = torch.einsum('bhqk,bkd->bhqd', p, v)
        return (lambda x, *d: x.permute(*d))(o, 0, 2, 1, 3).reshape(B, S, H * Dh) @ wo

    def _B_ref(x, w_in, w_sp, b_sp, w_out):
        B, S, D = x.shape
        F = w_in.shape[-1]
        Fh = F // 2
        z = _gelu(torch.einsum('bsd,df->bsf', x, w_in))
        z1 = z[..., :Fh].clone()
        z2 = _layernorm(z[..., Fh:], axis=-1)
        g = torch.einsum('ts,bsf->btf', w_sp, z2) + b_sp[None, :, None]
        return torch.einsum('bsf,fd->bsd', z1 * g, w_out)
    x = A_x
    xn = _layernorm(x, axis=-1)
    return x + _A_ref(xn, A_wq, A_wk, A_wv, A_wo) + _B_ref(xn, B_w_in, B_w_sp, B_b_sp, B_w_out)
```

```asm
; @launch grid=(256,1,1) block=(512,1,1) lds=163840
.amdgcn_target "amdgcn-amd-amdhsa--gfx950"
.text
.globl parallel_sum__grouped_kv_mqa__mixer_gmlp__prompt_kernel
.p2align 8
.type parallel_sum__grouped_kv_mqa__mixer_gmlp__prompt_kernel,@function
parallel_sum__grouped_kv_mqa__mixer_gmlp__prompt_kernel:
    s_cmp_ge_u32 s2, 256
    s_cbranch_scc1 parallel_sum__grouped_kv_mqa__mixer_gmlp__prompt_kernel_exit
    s_load_dwordx2 s[4:5], s[0:1], 96
    s_load_dwordx2 s[8:9], s[0:1], 0
    s_load_dwordx2 s[12:13], s[0:1], 8
    s_load_dwordx2 s[16:17], s[0:1], 48
    s_load_dwordx2 s[20:21], s[0:1], 56
    s_load_dwordx2 s[24:25], s[0:1], 64
    s_load_dwordx2 s[28:29], s[0:1], 32
    s_load_dwordx2 s[32:33], s[0:1], 72
    s_load_dwordx2 s[36:37], s[0:1], 80
    s_load_dwordx2 s[44:45], s[0:1], 88
    s_load_dwordx4 s[40:43], s[0:1], 16
    v_readfirstlane_b32 s48, v0
    v_and_b32 v1, 63, v0
    v_lshrrev_b32 v2, 5, v1
    v_and_b32 v3, 31, v0
    s_lshr_b32 s48, s48, 6
    s_and_b32 s46, s2, 7
    s_lshl_b32 s46, s46, 2
    s_bfe_u32 s62, s2, 0x20003
    s_add_u32 s46, s46, s62
    s_lshr_b32 s47, s2, 5
    s_lshr_b32 s49, s48, 2
    s_and_b32 s50, s48, 3
    s_mov_b32 s52, 0x0000ffff
    s_mov_b32 s53, 0x0000ffff
    s_cmp_eq_u32 s47, 7
    s_cbranch_scc0 parallel_sum__grouped_kv_mqa__mixer_gmlp__prompt_kernel_npc
    s_cmp_eq_u32 s48, 3
    s_cbranch_scc0 parallel_sum__grouped_kv_mqa__mixer_gmlp__prompt_kernel_npc
    s_getpc_b64 s[66:67]
parallel_sum__grouped_kv_mqa__mixer_gmlp__prompt_kernel_pc:
    v_lshlrev_b32 v61, 6, v1
    s_mov_b32 s68, parallel_sum__grouped_kv_mqa__mixer_gmlp__prompt_kernel_last - parallel_sum__grouped_kv_mqa__mixer_gmlp__prompt_kernel_pc
    v_add_u32 v62, 0, v61
    v_min_u32 v62, s68, v62
    global_load_dword v63, v62, s[66:67]
    v_add_u32 v62, 4096, v61
    v_min_u32 v62, s68, v62
    global_load_dword v63, v62, s[66:67]
    v_add_u32 v62, 8192, v61
    v_min_u32 v62, s68, v62
    global_load_dword v63, v62, s[66:67]
    v_add_u32 v62, 12288, v61
    v_min_u32 v62, s68, v62
    global_load_dword v63, v62, s[66:67]
    v_add_u32 v62, 16384, v61
    v_min_u32 v62, s68, v62
    global_load_dword v63, v62, s[66:67]
    v_add_u32 v62, 20480, v61
    v_min_u32 v62, s68, v62
    global_load_dword v63, v62, s[66:67]
    v_add_u32 v62, 24576, v61
    v_min_u32 v62, s68, v62
    global_load_dword v63, v62, s[66:67]
    v_add_u32 v62, 28672, v61
    v_min_u32 v62, s68, v62
    global_load_dword v63, v62, s[66:67]
    v_add_u32 v62, 32768, v61
    v_min_u32 v62, s68, v62
    global_load_dword v63, v62, s[66:67]
    v_add_u32 v62, 36864, v61
    v_min_u32 v62, s68, v62
    global_load_dword v63, v62, s[66:67]
    v_add_u32 v62, 40960, v61
    v_min_u32 v62, s68, v62
    global_load_dword v63, v62, s[66:67]
    v_add_u32 v62, 45056, v61
    v_min_u32 v62, s68, v62
    global_load_dword v63, v62, s[66:67]
parallel_sum__grouped_kv_mqa__mixer_gmlp__prompt_kernel_npc:
    v_and_b32 v14, 7, v1
    v_lshrrev_b32 v15, 3, v1
    s_lshl_b32 s62, s46, 6
    s_lshl_b32 s63, s48, 3
    s_add_u32 s62, s62, s63
    v_add_u32 v16, s62, v15
    v_lshlrev_b32 v16, 10, v16
    v_lshl_add_u32 v16, v14, 4, v16
    s_waitcnt lgkmcnt(0)
    s_mov_b32 s10, 2097152
    s_mov_b32 s11, 0x00020000
    buffer_load_dwordx4 v[64:67], v16, s[8:11], 0 offen offset:0
    buffer_load_dwordx4 v[68:71], v16, s[8:11], 0 offen offset:128
    buffer_load_dwordx4 v[72:75], v16, s[8:11], 0 offen offset:256
    buffer_load_dwordx4 v[76:79], v16, s[8:11], 0 offen offset:384
    buffer_load_dwordx4 v[80:83], v16, s[8:11], 0 offen offset:512
    buffer_load_dwordx4 v[84:87], v16, s[8:11], 0 offen offset:640
    buffer_load_dwordx4 v[88:91], v16, s[8:11], 0 offen offset:768
    buffer_load_dwordx4 v[92:95], v16, s[8:11], 0 offen offset:896
    v_bfe_u32 v22, v1, 2, 2
    v_and_b32 v23, 3, v1
    v_lshrrev_b32 v24, 4, v1
    s_lshl_b32 s62, s48, 3
    v_add_u32 v4, s62, v22
    v_mul_u32_u24 v4, 3584, v4
    v_lshl_add_u32 v4, v24, 6, v4
    v_lshl_add_u32 v4, v23, 4, v4
    v_lshrrev_b32 v25, 1, v24
    v_lshl_add_u32 v25, v25, 2, v22
    s_lshl_b32 s62, s48, 4
    v_add_u32 v25, s62, v25
    v_lshlrev_b32 v5, 10, v25
    v_and_b32 v25, 1, v24
    v_lshl_add_u32 v5, v25, 6, v5
    v_lshl_add_u32 v5, v23, 4, v5
    s_lshl_b32 s58, s47, 8
    s_lshl_b32 s59, s47, 7
    s_lshl_b32 s60, s48, 11
    v_lshlrev_b32 v25, 6, v22
    v_and_b32 v26, 1, v24
    v_lshl_add_u32 v25, v26, 5, v25
    v_lshl_add_u32 v25, v23, 3, v25
    v_lshlrev_b32 v6, 11, v2
    s_lshl_b32 s62, s50, 8
    v_add3_u32 v6, v6, s62, v25
    v_lshlrev_b32 v8, 10, v2
    s_and_b32 s62, s48, 1
    s_lshl_b32 s62, s62, 8
    v_add3_u32 v8, v8, s62, v25
    v_add_u32 v9, 131072, v8
    s_lshl_b32 s62, s49, 15
    s_add_u32 s62, s62, 65536
    v_add_u32 v26, 0, v2
    v_xor_b32 v26, v26, v3
    v_lshlrev_b32 v26, 4, v26
    v_lshl_add_u32 v26, v2, 9, v26
    v_add_u32 v10, s62, v26
    v_add_u32 v26, 2, v2
    v_xor_b32 v26, v26, v3
    v_lshlrev_b32 v26, 4, v26
    v_lshl_add_u32 v26, v2, 9, v26
    v_add_u32 v11, s62, v26
    v_add_u32 v26, 4, v2
    v_xor_b32 v26, v26, v3
    v_lshlrev_b32 v26, 4, v26
    v_lshl_add_u32 v26, v2, 9, v26
    v_add_u32 v12, s62, v26
    v_add_u32 v26, 6, v2
    v_xor_b32 v26, v26, v3
    v_lshlrev_b32 v26, 4, v26
    v_lshl_add_u32 v26, v2, 9, v26
    v_add_u32 v13, s62, v26
    s_mov_b32 s54, 3184710632
    v_mov_b32 v112, 3222493025
    s_lshl_b32 s62, 1, s48
    s_and_b32 s55, s62, 0xc3
    s_and_b32 s56, s62, 0x24
    s_mov_b32 s6, 15499264
    s_mov_b32 s7, 0x00020000
    s_mov_b32 s14, 524288
    s_mov_b32 s15, 0x00020000
    s_mov_b32 s18, 1835008
    s_mov_b32 s19, 0x00020000
    s_mov_b32 s22, 8388608
    s_mov_b32 s23, 0x00020000
    s_mov_b32 s26, 4096
    s_mov_b32 s27, 0x00020000
    s_mov_b32 s30, 524288
    s_mov_b32 s31, 0x00020000
    s_mov_b32 s34, 917504
    s_mov_b32 s35, 0x00020000
    s_mov_b32 s38, 2097152
    s_mov_b32 s39, 0x00020000
    s_cmp_eq_u32 s48, 7
    s_cbranch_scc0 parallel_sum__grouped_kv_mqa__mixer_gmlp__prompt_kernel_noclr
    s_lshl_b32 s62, s46, 3
    s_add_u32 s62, s62, s47
    s_lshl_b32 s62, s62, 7
    s_add_u32 s62, s62, 15466496
    v_mov_b32 v115, 0
    v_mov_b32 v116, 0
    v_mov_b32 v117, 0
    v_mov_b32 v118, 0
    v_mov_b32 v119, 0
    s_mov_b64 exec, 1
    buffer_store_dwordx4 v[116:119], v115, s[4:7], s62 offen sc1
    s_mov_b64 exec, -1
    s_cmp_eq_u32 s47, 7
    s_cbranch_scc1 parallel_sum__grouped_kv_mqa__mixer_gmlp__prompt_kernel_noclr
    s_mul_i32 s62, s46, 7
    s_add_u32 s62, s62, s47
    s_lshl_b32 s62, s62, 9
    s_add_u32 s62, s62, 2228224
    v_mov_b32 v116, -1
    v_mov_b32 v117, -1
    v_lshlrev_b32 v115, 3, v1
    buffer_store_dwordx2 v[116:117], v115, s[4:7], s62 offen sc1
parallel_sum__grouped_kv_mqa__mixer_gmlp__prompt_kernel_noclr:
    s_cmp_eq_u32 s47, 7
    s_cbranch_scc1 parallel_sum__grouped_kv_mqa__mixer_gmlp__prompt_kernel_j7
    v_add_u32 v7, 131072, v6
    s_and_b32 s62, s46, 3
    s_add_u32 s63, s62, 0
    s_and_b32 s63, s63, 3
    s_mul_i32 s64, s63, 458752
    s_add_u32 s96, s64, s58
    s_lshl_b32 s64, s63, 17
    s_add_u32 s51, s64, s59
    s_add_u32 s63, s62, 1
    s_and_b32 s63, s63, 3
    s_mul_i32 s64, s63, 458752
    s_add_u32 s97, s64, s58
    s_lshl_b32 s64, s63, 17
    s_add_u32 s61, s64, s59
    s_add_u32 s63, s62, 2
    s_and_b32 s63, s63, 3
    s_mul_i32 s64, s63, 458752
    s_add_u32 s98, s64, s58
    s_lshl_b32 s64, s63, 17
    s_add_u32 s100, s64, s59
    s_add_u32 s63, s62, 3
    s_and_b32 s63, s63, 3
    s_mul_i32 s64, s63, 458752
    s_add_u32 s99, s64, s58
    s_lshl_b32 s64, s63, 17
    s_add_u32 s101, s64, s59
    s_lshl_b32 s62, s62, 13
    v_add_u32 v10, s62, v10
    v_add_u32 v11, s62, v11
    v_add_u32 v12, s62, v12
    v_add_u32 v13, s62, v13
    v_lshrrev_b32 v31, 3, v1
    s_lshl_b32 s62, s46, 6
    s_lshl_b32 s63, s48, 3
    s_add_u32 s62, s62, s63
    v_add_u32 v31, s62, v31
    v_lshlrev_b32 v113, 12, v31
    s_and_b32 s62, s48, 1
    s_lshl_b32 s62, s62, 2
    v_lshrrev_b32 v31, 4, v1
    v_add_u32 v31, s62, v31
    v_xor_b32 v31, v31, v1
    v_and_b32 v31, 7, v31
    v_lshl_add_u32 v113, v31, 4, v113
    v_and_b32 v31, 15, v1
    v_lshlrev_b32 v31, 4, v31
    s_and_b32 s62, s48, 1
    s_lshl_b32 s62, s62, 8
    v_add_u32 v31, s62, v31
    s_lshr_b32 s63, s48, 1
    s_cmp_lt_u32 s63, 2
    s_cselect_b32 s64, 9, 10
    v_lshlrev_b32 v114, s64, v2
    v_add_u32 v114, v114, v31
    s_lshl_b32 s64, s63, 10
    s_add_u32 s64, s64, 2097152
    s_mov_b32 s65, 2162688
    s_cmp_eq_u32 s63, 2
    s_cselect_b32 s64, s65, s64
    s_mov_b32 s65, 2161152
    s_cmp_eq_u32 s63, 3
    s_cselect_b32 s64, s65, s64
    v_add_u32 v114, s64, v114
    s_lshl_b32 s62, s47, 2
    s_add_u32 s62, s62, s50
    s_lshl_b32 s62, s62, 7
    s_lshl_b32 s63, s49, 1
    s_add_u32 s62, s62, s63
    s_lshl_b32 s62, s62, 10
    s_add_u32 s62, s62, 6029312
    v_lshlrev_b32 v31, 4, v1
    v_add_u32 v115, s62, v31
    s_lshl_b32 s62, s49, 10
    s_add_u32 s62, s62, 8192
    v_add_u32 v116, s62, v31
    v_and_b32 v31, 15, v1
    v_lshlrev_b32 v31, 4, v31
    v_lshl_add_u32 v117, v2, 8, v31
    s_lshl_b32 s62, s49, 9
    s_add_u32 s62, s62, 10240
    v_add_u32 v117, s62, v117
    v_lshrrev_b32 v31, 1, v3
    s_lshl_b32 s62, s49, 2
    v_add_u32 v118, s62, v2
    v_xor_b32 v118, v118, v31
    v_and_b32 v118, 7, v118
    v_xor_b32 v119, 2, v118
    v_lshlrev_b32 v31, 7, v3
    v_lshl_add_u32 v118, v118, 4, v31
    v_lshl_add_u32 v119, v119, 4, v31
    s_waitcnt vmcnt(0)
    s_waitcnt vmcnt(0)
    s_add_u32 s57, s96, 1792
    s_add_u32 m0, s60, 0
    s_nop 0
    buffer_load_dwordx4 v4, s[16:19], s57 offen lds
    s_add_u32 s57, s96, 16128
    s_add_u32 m0, s60, 1024
    s_nop 0
    buffer_load_dwordx4 v4, s[16:19], s57 offen lds
    s_add_u32 s57, s96, 231168
    s_add_u32 m0, s60, 16384
    s_nop 0
    buffer_load_dwordx4 v4, s[16:19], s57 offen lds
    s_add_u32 s57, s96, 245504
    s_add_u32 m0, s60, 17408
    s_nop 0
    buffer_load_dwordx4 v4, s[16:19], s57 offen lds
    s_add_u32 s57, s97, 1792
    s_add_u32 m0, s60, 32768
    s_nop 0
    buffer_load_dwordx4 v4, s[16:19], s57 offen lds
    s_add_u32 s57, s97, 16128
    s_add_u32 m0, s60, 33792
    s_nop 0
    buffer_load_dwordx4 v4, s[16:19], s57 offen lds
    s_add_u32 s57, s97, 231168
    s_add_u32 m0, s60, 49152
    s_nop 0
    buffer_load_dwordx4 v4, s[16:19], s57 offen lds
    s_add_u32 s57, s97, 245504
    s_add_u32 m0, s60, 50176
    s_nop 0
    buffer_load_dwordx4 v4, s[16:19], s57 offen lds
    s_cmp_eq_u32 s48, 7
    s_cbranch_scc0 parallel_sum__grouped_kv_mqa__mixer_gmlp__prompt_kernel_a1_nocnt
    s_and_b32 s62, s2, 1
    s_lshl_b32 s62, s62, 7
    v_mov_b32 v26, s62
    v_mov_b32 v27, 1
    s_mov_b64 exec, 1
    global_atomic_add v26, v27, s[44:45] sc1
    s_mov_b64 exec, -1
parallel_sum__grouped_kv_mqa__mixer_gmlp__prompt_kernel_a1_nocnt:
    v_mov_b32 v19, 0x3f803f80
    v_mov_b32 v17, 0
    v_mov_b32 v18, 0
    v_mov_b32 v20, 0
    v_mov_b32 v21, 0
    v_dot2_f32_bf16 v17, v64, v19, v17
    v_dot2_f32_bf16 v18, v64, v64, v18
    v_dot2_f32_bf16 v20, v65, v19, v20
    v_dot2_f32_bf16 v21, v65, v65, v21
    v_dot2_f32_bf16 v17, v66, v19, v17
    v_dot2_f32_bf16 v18, v66, v66, v18
    v_dot2_f32_bf16 v20, v67, v19, v20
    v_dot2_f32_bf16 v21, v67, v67, v21
    v_dot2_f32_bf16 v17, v68, v19, v17
    v_dot2_f32_bf16 v18, v68, v68, v18
    v_dot2_f32_bf16 v20, v69, v19, v20
    v_dot2_f32_bf16 v21, v69, v69, v21
    v_dot2_f32_bf16 v17, v70, v19, v17
    v_dot2_f32_bf16 v18, v70, v70, v18
    v_dot2_f32_bf16 v20, v71, v19, v20
    v_dot2_f32_bf16 v21, v71, v71, v21
    v_dot2_f32_bf16 v17, v72, v19, v17
    v_dot2_f32_bf16 v18, v72, v72, v18
    v_dot2_f32_bf16 v20, v73, v19, v20
    v_dot2_f32_bf16 v21, v73, v73, v21
    v_dot2_f32_bf16 v17, v74, v19, v17
    v_dot2_f32_bf16 v18, v74, v74, v18
    v_dot2_f32_bf16 v20, v75, v19, v20
    v_dot2_f32_bf16 v21, v75, v75, v21
    v_dot2_f32_bf16 v17, v76, v19, v17
    v_dot2_f32_bf16 v18, v76, v76, v18
    v_dot2_f32_bf16 v20, v77, v19, v20
    v_dot2_f32_bf16 v21, v77, v77, v21
    v_dot2_f32_bf16 v17, v78, v19, v17
    v_dot2_f32_bf16 v18, v78, v78, v18
    v_dot2_f32_bf16 v20, v79, v19, v20
    v_dot2_f32_bf16 v21, v79, v79, v21
    v_dot2_f32_bf16 v17, v80, v19, v17
    v_dot2_f32_bf16 v18, v80, v80, v18
    v_dot2_f32_bf16 v20, v81, v19, v20
    v_dot2_f32_bf16 v21, v81, v81, v21
    v_dot2_f32_bf16 v17, v82, v19, v17
    v_dot2_f32_bf16 v18, v82, v82, v18
    v_dot2_f32_bf16 v20, v83, v19, v20
    v_dot2_f32_bf16 v21, v83, v83, v21
    v_dot2_f32_bf16 v17, v84, v19, v17
    v_dot2_f32_bf16 v18, v84, v84, v18
    v_dot2_f32_bf16 v20, v85, v19, v20
    v_dot2_f32_bf16 v21, v85, v85, v21
    v_dot2_f32_bf16 v17, v86, v19, v17
    v_dot2_f32_bf16 v18, v86, v86, v18
    v_dot2_f32_bf16 v20, v87, v19, v20
    v_dot2_f32_bf16 v21, v87, v87, v21
    v_dot2_f32_bf16 v17, v88, v19, v17
    v_dot2_f32_bf16 v18, v88, v88, v18
    v_dot2_f32_bf16 v20, v89, v19, v20
    v_dot2_f32_bf16 v21, v89, v89, v21
    v_dot2_f32_bf16 v17, v90, v19, v17
    v_dot2_f32_bf16 v18, v90, v90, v18
    v_dot2_f32_bf16 v20, v91, v19, v20
    v_dot2_f32_bf16 v21, v91, v91, v21
    v_dot2_f32_bf16 v17, v92, v19, v17
    v_dot2_f32_bf16 v18, v92, v92, v18
    v_dot2_f32_bf16 v20, v93, v19, v20
    v_dot2_f32_bf16 v21, v93, v93, v21
    v_dot2_f32_bf16 v17, v94, v19, v17
    v_dot2_f32_bf16 v18, v94, v94, v18
    v_dot2_f32_bf16 v20, v95, v19, v20
    v_dot2_f32_bf16 v21, v95, v95, v21
    s_nop 1
    v_add_f32 v17, v17, v20
    v_add_f32 v18, v18, v21
    s_nop 1
    v_add_f32_dpp v17, v17, v17 quad_perm:[1,0,3,2] row_mask:0xf bank_mask:0xf
    v_add_f32_dpp v18, v18, v18 quad_perm:[1,0,3,2] row_mask:0xf bank_mask:0xf
    s_nop 1
    v_add_f32_dpp v17, v17, v17 quad_perm:[2,3,0,1] row_mask:0xf bank_mask:0xf
    v_add_f32_dpp v18, v18, v18 quad_perm:[2,3,0,1] row_mask:0xf bank_mask:0xf
    s_nop 1
    v_add_f32_dpp v17, v17, v17 row_half_mirror row_mask:0xf bank_mask:0xf
    v_add_f32_dpp v18, v18, v18 row_half_mirror row_mask:0xf bank_mask:0xf
    s_nop 0
    v_mul_f32 v17, 989855744, v17
    v_mul_f32 v18, 989855744, v18
    v_fma_f32 v18, -v17, v17, v18
    v_max_f32 v18, 0, v18
    v_add_f32 v18, 925353388, v18
    v_rsq_f32 v18, v18
    s_nop 0
    v_mul_f32 v17, v17, v18
    v_sub_f32 v17, 0, v17
    s_and_b32 s62, s48, 3
    s_lshl_b32 s62, s62, 3
    v_add_u32 v22, s62, v15
    v_xor_b32 v22, v22, v14
    v_lshlrev_b32 v22, 4, v22
    v_lshrrev_b32 v23, 1, v14
    v_lshl_add_u32 v22, v23, 10, v22
    v_and_b32 v23, 1, v14
    v_lshl_add_u32 v22, v23, 9, v22
    s_lshl_b32 s62, s49, 15
    s_add_u32 s62, s62, 65536
    v_add_u32 v22, s62, v22
    v_lshlrev_b32 v20, 16, v64
    v_and_b32 v21, 0xffff0000, v64
    v_fma_f32 v20, v20, v18, v17
    v_fma_f32 v21, v21, v18, v17
    v_cvt_pk_bf16_f32 v64, v20, v21
    v_lshlrev_b32 v23, 16, v65
    v_and_b32 v24, 0xffff0000, v65
    v_fma_f32 v23, v23, v18, v17
    v_fma_f32 v24, v24, v18, v17
    v_cvt_pk_bf16_f32 v65, v23, v24
    v_lshlrev_b32 v20, 16, v66
    v_and_b32 v21, 0xffff0000, v66
    v_fma_f32 v20, v20, v18, v17
    v_fma_f32 v21, v21, v18, v17
    v_cvt_pk_bf16_f32 v66, v20, v21
    v_lshlrev_b32 v23, 16, v67
    v_and_b32 v24, 0xffff0000, v67
    v_fma_f32 v23, v23, v18, v17
    v_fma_f32 v24, v24, v18, v17
    v_cvt_pk_bf16_f32 v67, v23, v24
    ds_write_b128 v22, v[64:67] offset:0
    v_lshlrev_b32 v20, 16, v68
    v_and_b32 v21, 0xffff0000, v68
    v_fma_f32 v20, v20, v18, v17
    v_fma_f32 v21, v21, v18, v17
    v_cvt_pk_bf16_f32 v68, v20, v21
    v_lshlrev_b32 v23, 16, v69
    v_and_b32 v24, 0xffff0000, v69
    v_fma_f32 v23, v23, v18, v17
    v_fma_f32 v24, v24, v18, v17
    v_cvt_pk_bf16_f32 v69, v23, v24
    v_lshlrev_b32 v20, 16, v70
    v_and_b32 v21, 0xffff0000, v70
    v_fma_f32 v20, v20, v18, v17
    v_fma_f32 v21, v21, v18, v17
    v_cvt_pk_bf16_f32 v70, v20, v21
    v_lshlrev_b32 v23, 16, v71
    v_and_b32 v24, 0xffff0000, v71
    v_fma_f32 v23, v23, v18, v17
    v_fma_f32 v24, v24, v18, v17
    v_cvt_pk_bf16_f32 v71, v23, v24
    ds_write_b128 v22, v[68:71] offset:4096
    v_lshlrev_b32 v20, 16, v72
    v_and_b32 v21, 0xffff0000, v72
    v_fma_f32 v20, v20, v18, v17
    v_fma_f32 v21, v21, v18, v17
    v_cvt_pk_bf16_f32 v72, v20, v21
    v_lshlrev_b32 v23, 16, v73
    v_and_b32 v24, 0xffff0000, v73
    v_fma_f32 v23, v23, v18, v17
    v_fma_f32 v24, v24, v18, v17
    v_cvt_pk_bf16_f32 v73, v23, v24
    v_lshlrev_b32 v20, 16, v74
    v_and_b32 v21, 0xffff0000, v74
    v_fma_f32 v20, v20, v18, v17
    v_fma_f32 v21, v21, v18, v17
    v_cvt_pk_bf16_f32 v74, v20, v21
    v_lshlrev_b32 v23, 16, v75
    v_and_b32 v24, 0xffff0000, v75
    v_fma_f32 v23, v23, v18, v17
    v_fma_f32 v24, v24, v18, v17
    v_cvt_pk_bf16_f32 v75, v23, v24
    ds_write_b128 v22, v[72:75] offset:8192
    v_lshlrev_b32 v20, 16, v76
    v_and_b32 v21, 0xffff0000, v76
    v_fma_f32 v20, v20, v18, v17
    v_fma_f32 v21, v21, v18, v17
    v_cvt_pk_bf16_f32 v76, v20, v21
    v_lshlrev_b32 v23, 16, v77
    v_and_b32 v24, 0xffff0000, v77
    v_fma_f32 v23, v23, v18, v17
    v_fma_f32 v24, v24, v18, v17
    v_cvt_pk_bf16_f32 v77, v23, v24
    v_lshlrev_b32 v20, 16, v78
    v_and_b32 v21, 0xffff0000, v78
    v_fma_f32 v20, v20, v18, v17
    v_fma_f32 v21, v21, v18, v17
    v_cvt_pk_bf16_f32 v78, v20, v21
    v_lshlrev_b32 v23, 16, v79
    v_and_b32 v24, 0xffff0000, v79
    v_fma_f32 v23, v23, v18, v17
    v_fma_f32 v24, v24, v18, v17
    v_cvt_pk_bf16_f32 v79, v23, v24
    ds_write_b128 v22, v[76:79] offset:12288
    v_lshlrev_b32 v20, 16, v80
    v_and_b32 v21, 0xffff0000, v80
    v_fma_f32 v20, v20, v18, v17
    v_fma_f32 v21, v21, v18, v17
    v_cvt_pk_bf16_f32 v80, v20, v21
    v_lshlrev_b32 v23, 16, v81
    v_and_b32 v24, 0xffff0000, v81
    v_fma_f32 v23, v23, v18, v17
    v_fma_f32 v24, v24, v18, v17
    v_cvt_pk_bf16_f32 v81, v23, v24
    v_lshlrev_b32 v20, 16, v82
    v_and_b32 v21, 0xffff0000, v82
    v_fma_f32 v20, v20, v18, v17
    v_fma_f32 v21, v21, v18, v17
    v_cvt_pk_bf16_f32 v82, v20, v21
    v_lshlrev_b32 v23, 16, v83
    v_and_b32 v24, 0xffff0000, v83
    v_fma_f32 v23, v23, v18, v17
    v_fma_f32 v24, v24, v18, v17
    v_cvt_pk_bf16_f32 v83, v23, v24
    ds_write_b128 v22, v[80:83] offset:16384
    v_lshlrev_b32 v20, 16, v84
    v_and_b32 v21, 0xffff0000, v84
    v_fma_f32 v20, v20, v18, v17
    v_fma_f32 v21, v21, v18, v17
    v_cvt_pk_bf16_f32 v84, v20, v21
    v_lshlrev_b32 v23, 16, v85
    v_and_b32 v24, 0xffff0000, v85
    v_fma_f32 v23, v23, v18, v17
    v_fma_f32 v24, v24, v18, v17
    v_cvt_pk_bf16_f32 v85, v23, v24
    v_lshlrev_b32 v20, 16, v86
    v_and_b32 v21, 0xffff0000, v86
    v_fma_f32 v20, v20, v18, v17
    v_fma_f32 v21, v21, v18, v17
    v_cvt_pk_bf16_f32 v86, v20, v21
    v_lshlrev_b32 v23, 16, v87
    v_and_b32 v24, 0xffff0000, v87
    v_fma_f32 v23, v23, v18, v17
    v_fma_f32 v24, v24, v18, v17
    v_cvt_pk_bf16_f32 v87, v23, v24
    ds_write_b128 v22, v[84:87] offset:20480
    v_lshlrev_b32 v20, 16, v88
    v_and_b32 v21, 0xffff0000, v88
    v_fma_f32 v20, v20, v18, v17
    v_fma_f32 v21, v21, v18, v17
    v_cvt_pk_bf16_f32 v88, v20, v21
    v_lshlrev_b32 v23, 16, v89
    v_and_b32 v24, 0xffff0000, v89
    v_fma_f32 v23, v23, v18, v17
    v_fma_f32 v24, v24, v18, v17
    v_cvt_pk_bf16_f32 v89, v23, v24
    v_lshlrev_b32 v20, 16, v90
    v_and_b32 v21, 0xffff0000, v90
    v_fma_f32 v20, v20, v18, v17
    v_fma_f32 v21, v21, v18, v17
    v_cvt_pk_bf16_f32 v90, v20, v21
    v_lshlrev_b32 v23, 16, v91
    v_and_b32 v24, 0xffff0000, v91
    v_fma_f32 v23, v23, v18, v17
    v_fma_f32 v24, v24, v18, v17
    v_cvt_pk_bf16_f32 v91, v23, v24
    ds_write_b128 v22, v[88:91] offset:24576
    v_lshlrev_b32 v20, 16, v92
    v_and_b32 v21, 0xffff0000, v92
    v_fma_f32 v20, v20, v18, v17
    v_fma_f32 v21, v21, v18, v17
    v_cvt_pk_bf16_f32 v92, v20, v21
    v_lshlrev_b32 v23, 16, v93
    v_and_b32 v24, 0xffff0000, v93
    v_fma_f32 v23, v23, v18, v17
    v_fma_f32 v24, v24, v18, v17
    v_cvt_pk_bf16_f32 v93, v23, v24
    v_lshlrev_b32 v20, 16, v94
    v_and_b32 v21, 0xffff0000, v94
    v_fma_f32 v20, v20, v18, v17
    v_fma_f32 v21, v21, v18, v17
    v_cvt_pk_bf16_f32 v94, v20, v21
    v_lshlrev_b32 v23, 16, v95
    v_and_b32 v24, 0xffff0000, v95
    v_fma_f32 v23, v23, v18, v17
    v_fma_f32 v24, v24, v18, v17
    v_cvt_pk_bf16_f32 v95, v23, v24
    ds_write_b128 v22, v[92:95] offset:28672
    s_waitcnt lgkmcnt(0)
    s_waitcnt vmcnt(6)
    s_barrier
    ds_read_b64_tr_b16 v[32:33], v6 offset:0
    ds_read_b64_tr_b16 v[34:35], v6 offset:1024
    ds_read_b128 v[128:131], v10 offset:0
    ds_read_b64_tr_b16 v[36:37], v6 offset:4096
    ds_read_b64_tr_b16 v[38:39], v6 offset:5120
    ds_read_b128 v[132:135], v11 offset:1024
    ds_read_b64_tr_b16 v[40:41], v6 offset:8192
    ds_read_b64_tr_b16 v[42:43], v6 offset:9216
    ds_read_b128 v[136:139], v12 offset:2048
    ds_read_b64_tr_b16 v[44:45], v6 offset:12288
    ds_read_b64_tr_b16 v[46:47], v6 offset:13312
    ds_read_b128 v[140:143], v13 offset:3072
    s_add_u32 s57, s98, 1792
    s_add_u32 m0, s60, 131072
    s_nop 0
    buffer_load_dwordx4 v4, s[16:19], s57 offen lds
    s_add_u32 s57, s98, 16128
    s_add_u32 m0, s60, 132096
    s_nop 0
    buffer_load_dwordx4 v4, s[16:19], s57 offen lds
    s_waitcnt lgkmcnt(0)
    s_waitcnt vmcnt(6)
    s_barrier
    v_mfma_f32_32x32x16_bf16 v[64:79], v[32:35], v[128:131], 0
    ds_read_b64_tr_b16 v[48:49], v6 offset:16384
    ds_read_b64_tr_b16 v[50:51], v6 offset:17408
    ds_read_b128 v[144:147], v10 offset:4096
    ds_read_b64_tr_b16 v[52:53], v6 offset:20480
    ds_read_b64_tr_b16 v[54:55], v6 offset:21504
    ds_read_b128 v[148:151], v11 offset:5120
    v_mfma_f32_32x32x16_bf16 v[64:79], v[36:39], v[132:135], v[64:79]
    ds_read_b64_tr_b16 v[56:57], v6 offset:24576
    ds_read_b64_tr_b16 v[58:59], v6 offset:25600
    ds_read_b128 v[152:155], v12 offset:6144
    ds_read_b64_tr_b16 v[60:61], v6 offset:28672
    ds_read_b64_tr_b16 v[62:63], v6 offset:29696
    ds_read_b128 v[156:159], v13 offset:7168
    v_mfma_f32_32x32x16_bf16 v[64:79], v[40:43], v[136:139], v[64:79]
    s_add_u32 s57, s98, 231168
    s_add_u32 m0, s60, 0
    s_nop 0
    buffer_load_dwordx4 v4, s[16:19], s57 offen lds
    v_mfma_f32_32x32x16_bf16 v[64:79], v[44:47], v[140:143], v[64:79]
    s_add_u32 s57, s98, 245504
    s_add_u32 m0, s60, 1024
    s_nop 0
    buffer_load_dwordx4 v4, s[16:19], s57 offen lds
    s_waitcnt lgkmcnt(0)
    s_waitcnt vmcnt(6)
    s_barrier
    s_and_b32 s62, s46, 3
    s_add_u32 s62, s62, 1
    s_and_b32 s62, s62, 3
    s_cmp_eq_u32 s62, 0
    s_mov_b32 s63, 8192
    s_cselect_b32 s62, 4294942720, s63
    v_add_u32 v10, s62, v10
    v_add_u32 v11, s62, v11
    v_add_u32 v12, s62, v12
    v_add_u32 v13, s62, v13
    v_mfma_f32_32x32x16_bf16 v[64:79], v[48:51], v[144:147], v[64:79]
    ds_read_b64_tr_b16 v[32:33], v6 offset:32768
    ds_read_b64_tr_b16 v[34:35], v6 offset:33792
    ds_read_b128 v[160:163], v10 offset:0
    ds_read_b64_tr_b16 v[36:37], v6 offset:36864
    ds_read_b64_tr_b16 v[38:39], v6 offset:37888
    ds_read_b128 v[164:167], v11 offset:1024
    v_mfma_f32_32x32x16_bf16 v[64:79], v[52:55], v[148:151], v[64:79]
    ds_read_b64_tr_b16 v[40:41], v6 offset:40960
    ds_read_b64_tr_b16 v[42:43], v6 offset:41984
    ds_read_b128 v[168:171], v12 offset:2048
    ds_read_b64_tr_b16 v[44:45], v6 offset:45056
    ds_read_b64_tr_b16 v[46:47], v6 offset:46080
    ds_read_b128 v[172:175], v13 offset:3072
    v_mfma_f32_32x32x16_bf16 v[64:79], v[56:59], v[152:155], v[64:79]
    s_add_u32 s57, s99, 1792
    s_add_u32 m0, s60, 16384
    s_nop 0
    buffer_load_dwordx4 v4, s[16:19], s57 offen lds
    v_mfma_f32_32x32x16_bf16 v[64:79], v[60:63], v[156:159], v[64:79]
    s_add_u32 s57, s99, 16128
    s_add_u32 m0, s60, 17408
    s_nop 0
    buffer_load_dwordx4 v4, s[16:19], s57 offen lds
    s_waitcnt lgkmcnt(0)
    s_waitcnt vmcnt(6)
    s_barrier
    v_mfma_f32_32x32x16_bf16 v[64:79], v[32:35], v[160:163], v[64:79]
    ds_read_b64_tr_b16 v[48:49], v6 offset:49152
    ds_read_b64_tr_b16 v[50:51], v6 offset:50176
    ds_read_b128 v[176:179], v10 offset:4096
    ds_read_b64_tr_b16 v[52:53], v6 offset:53248
    ds_read_b64_tr_b16 v[54:55], v6 offset:54272
    ds_read_b128 v[180:183], v11 offset:5120
    v_mfma_f32_32x32x16_bf16 v[64:79], v[36:39], v[164:167], v[64:79]
    ds_read_b64_tr_b16 v[56:57], v6 offset:57344
    ds_read_b64_tr_b16 v[58:59], v6 offset:58368
    ds_read_b128 v[184:187], v12 offset:6144
    ds_read_b64_tr_b16 v[60:61], v6 offset:61440
    ds_read_b64_tr_b16 v[62:63], v6 offset:62464
    ds_read_b128 v[188:191], v13 offset:7168
    v_mfma_f32_32x32x16_bf16 v[64:79], v[40:43], v[168:171], v[64:79]
    s_add_u32 s57, s99, 231168
    s_add_u32 m0, s60, 32768
    s_nop 0
    buffer_load_dwordx4 v4, s[16:19], s57 offen lds
    v_mfma_f32_32x32x16_bf16 v[64:79], v[44:47], v[172:175], v[64:79]
    s_add_u32 s57, s99, 245504
    s_add_u32 m0, s60, 33792
    s_nop 0
    buffer_load_dwordx4 v4, s[16:19], s57 offen lds
    s_waitcnt lgkmcnt(0)
    s_waitcnt vmcnt(6)
    s_barrier
    s_and_b32 s62, s46, 3
    s_add_u32 s62, s62, 2
    s_and_b32 s62, s62, 3
    s_cmp_eq_u32 s62, 0
    s_mov_b32 s63, 8192
    s_cselect_b32 s62, 4294942720, s63
    v_add_u32 v10, s62, v10
    v_add_u32 v11, s62, v11
    v_add_u32 v12, s62, v12
    v_add_u32 v13, s62, v13
    v_mfma_f32_32x32x16_bf16 v[64:79], v[48:51], v[176:179], v[64:79]
    ds_read_b64_tr_b16 v[32:33], v7 offset:0
    ds_read_b64_tr_b16 v[34:35], v7 offset:1024
    ds_read_b128 v[192:195], v10 offset:0
    ds_read_b64_tr_b16 v[36:37], v7 offset:4096
    ds_read_b64_tr_b16 v[38:39], v7 offset:5120
    ds_read_b128 v[196:199], v11 offset:1024
    v_mfma_f32_32x32x16_bf16 v[64:79], v[52:55], v[180:183], v[64:79]
    ds_read_b64_tr_b16 v[40:41], v7 offset:8192
    ds_read_b64_tr_b16 v[42:43], v7 offset:9216
    ds_read_b128 v[200:203], v12 offset:2048
    ds_read_b64_tr_b16 v[44:45], v7 offset:12288
    ds_read_b64_tr_b16 v[46:47], v7 offset:13312
    ds_read_b128 v[204:207], v13 offset:3072
    v_mfma_f32_32x32x16_bf16 v[64:79], v[56:59], v[184:187], v[64:79]
    s_add_u32 s57, s51, 0
    s_add_u32 m0, s60, 49152
    s_nop 0
    buffer_load_dwordx4 v5, s[12:15], s57 offen lds
    v_mfma_f32_32x32x16_bf16 v[64:79], v[60:63], v[188:191], v[64:79]
    s_add_u32 s57, s51, 8192
    s_add_u32 m0, s60, 50176
    s_nop 0
    buffer_load_dwordx4 v5, s[12:15], s57 offen lds
    s_waitcnt lgkmcnt(0)
    s_waitcnt vmcnt(6)
    s_barrier
    v_mfma_f32_32x32x16_bf16 v[64:79], v[32:35], v[192:195], v[64:79]
    ds_read_b64_tr_b16 v[48:49], v6 offset:0
    ds_read_b64_tr_b16 v[50:51], v6 offset:1024
    ds_read_b128 v[208:211], v10 offset:4096
    ds_read_b64_tr_b16 v[52:53], v6 offset:4096
    ds_read_b64_tr_b16 v[54:55], v6 offset:5120
    ds_read_b128 v[212:215], v11 offset:5120
    v_mfma_f32_32x32x16_bf16 v[64:79], v[36:39], v[196:199], v[64:79]
    ds_read_b64_tr_b16 v[56:57], v6 offset:8192
    ds_read_b64_tr_b16 v[58:59], v6 offset:9216
    ds_read_b128 v[216:219], v12 offset:6144
    ds_read_b64_tr_b16 v[60:61], v6 offset:12288
    ds_read_b64_tr_b16 v[62:63], v6 offset:13312
    ds_read_b128 v[220:223], v13 offset:7168
    v_mfma_f32_32x32x16_bf16 v[64:79], v[40:43], v[200:203], v[64:79]
    s_add_u32 s57, s61, 0
    s_add_u32 m0, s60, 131072
    s_nop 0
    buffer_load_dwordx4 v5, s[12:15], s57 offen lds
    v_mfma_f32_32x32x16_bf16 v[64:79], v[44:47], v[204:207], v[64:79]
    s_add_u32 s57, s61, 8192
    s_add_u32 m0, s60, 132096
    s_nop 0
    buffer_load_dwordx4 v5, s[12:15], s57 offen lds
    s_waitcnt lgkmcnt(0)
    s_waitcnt vmcnt(6)
    s_barrier
    s_and_b32 s62, s46, 3
    s_add_u32 s62, s62, 3
    s_and_b32 s62, s62, 3
    s_cmp_eq_u32 s62, 0
    s_mov_b32 s63, 8192
    s_cselect_b32 s62, 4294942720, s63
    v_add_u32 v10, s62, v10
    v_add_u32 v11, s62, v11
    v_add_u32 v12, s62, v12
    v_add_u32 v13, s62, v13
    v_mfma_f32_32x32x16_bf16 v[64:79], v[48:51], v[208:211], v[64:79]
    ds_read_b64_tr_b16 v[32:33], v6 offset:16384
    ds_read_b64_tr_b16 v[34:35], v6 offset:17408
    ds_read_b128 v[224:227], v10 offset:0
    ds_read_b64_tr_b16 v[36:37], v6 offset:20480
    ds_read_b64_tr_b16 v[38:39], v6 offset:21504
    ds_read_b128 v[228:231], v11 offset:1024
    v_mfma_f32_32x32x16_bf16 v[64:79], v[52:55], v[212:215], v[64:79]
    ds_read_b64_tr_b16 v[40:41], v6 offset:24576
    ds_read_b64_tr_b16 v[42:43], v6 offset:25600
    ds_read_b128 v[232:235], v12 offset:2048
    ds_read_b64_tr_b16 v[44:45], v6 offset:28672
    ds_read_b64_tr_b16 v[46:47], v6 offset:29696
    ds_read_b128 v[236:239], v13 offset:3072
    v_mfma_f32_32x32x16_bf16 v[64:79], v[56:59], v[216:219], v[64:79]
    s_add_u32 s57, s100, 0
    s_add_u32 m0, s60, 0
    s_nop 0
    buffer_load_dwordx4 v5, s[12:15], s57 offen lds
    v_mfma_f32_32x32x16_bf16 v[64:79], v[60:63], v[220:223], v[64:79]
    s_add_u32 s57, s100, 8192
    s_add_u32 m0, s60, 1024
    s_nop 0
    buffer_load_dwordx4 v5, s[12:15], s57 offen lds
    s_waitcnt lgkmcnt(0)
    s_waitcnt vmcnt(6)
    s_barrier
    v_mfma_f32_32x32x16_bf16 v[64:79], v[32:35], v[224:227], v[64:79]
    ds_read_b64_tr_b16 v[48:49], v6 offset:32768
    ds_read_b64_tr_b16 v[50:51], v6 offset:33792
    ds_read_b128 v[240:243], v10 offset:4096
    ds_read_b64_tr_b16 v[52:53], v6 offset:36864
    ds_read_b64_tr_b16 v[54:55], v6 offset:37888
    ds_read_b128 v[244:247], v11 offset:5120
    v_mfma_f32_32x32x16_bf16 v[64:79], v[36:39], v[228:231], v[64:79]
    ds_read_b64_tr_b16 v[56:57], v6 offset:40960
    ds_read_b64_tr_b16 v[58:59], v6 offset:41984
    ds_read_b128 v[248:251], v12 offset:6144
    ds_read_b64_tr_b16 v[60:61], v6 offset:45056
    ds_read_b64_tr_b16 v[62:63], v6 offset:46080
    ds_read_b128 v[252:255], v13 offset:7168
    v_mfma_f32_32x32x16_bf16 v[64:79], v[40:43], v[232:235], v[64:79]
    s_add_u32 s57, s101, 0
    s_add_u32 m0, s60, 16384
    s_nop 0
    buffer_load_dwordx4 v5, s[12:15], s57 offen lds
    v_mfma_f32_32x32x16_bf16 v[64:79], v[44:47], v[236:239], v[64:79]
    s_add_u32 s57, s101, 8192
    s_add_u32 m0, s60, 17408
    s_nop 0
    buffer_load_dwordx4 v5, s[12:15], s57 offen lds
    s_waitcnt lgkmcnt(0)
    s_waitcnt vmcnt(6)
    s_barrier
    s_cmp_eq_u32 s55, 0
    s_cbranch_scc1 parallel_sum__grouped_kv_mqa__mixer_gmlp__prompt_kernel_a1_n8
    v_mfma_f32_32x32x16_bf16 v[64:79], v[48:51], v[240:243], v[64:79]
    ds_read_b64_tr_b16 v[32:33], v8 offset:49152
    ds_read_b64_tr_b16 v[34:35], v8 offset:49664
    ds_read_b64_tr_b16 v[36:37], v8 offset:51200
    ds_read_b64_tr_b16 v[38:39], v8 offset:51712
    v_mfma_f32_32x32x16_bf16 v[64:79], v[52:55], v[244:247], v[64:79]
    ds_read_b64_tr_b16 v[40:41], v8 offset:53248
    ds_read_b64_tr_b16 v[42:43], v8 offset:53760
    ds_read_b64_tr_b16 v[44:45], v8 offset:55296
    ds_read_b64_tr_b16 v[46:47], v8 offset:55808
    v_mfma_f32_32x32x16_bf16 v[64:79], v[56:59], v[248:251], v[64:79]
    s_add_u32 s57, s96, 0
    s_add_u32 m0, s60, 32768
    s_nop 0
    buffer_load_dwordx4 v4, s[16:19], s57 offen lds
    v_mfma_f32_32x32x16_bf16 v[64:79], v[60:63], v[252:255], v[64:79]
    s_add_u32 s57, s96, 14336
    s_add_u32 m0, s60, 33792
    s_nop 0
    buffer_load_dwordx4 v4, s[16:19], s57 offen lds
    s_branch parallel_sum__grouped_kv_mqa__mixer_gmlp__prompt_kernel_a1_e8
parallel_sum__grouped_kv_mqa__mixer_gmlp__prompt_kernel_a1_n8:
    v_mfma_f32_32x32x16_bf16 v[64:79], v[48:51], v[240:243], v[64:79]
    v_mfma_f32_32x32x16_bf16 v[64:79], v[52:55], v[244:247], v[64:79]
    v_mfma_f32_32x32x16_bf16 v[64:79], v[56:59], v[248:251], v[64:79]
    s_add_u32 s57, s96, 0
    s_add_u32 m0, s60, 32768
    s_nop 0
    buffer_load_dwordx4 v4, s[16:19], s57 offen lds
    v_mfma_f32_32x32x16_bf16 v[64:79], v[60:63], v[252:255], v[64:79]
    s_add_u32 s57, s96, 14336
    s_add_u32 m0, s60, 33792
    s_nop 0
    buffer_load_dwordx4 v4, s[16:19], s57 offen lds
parallel_sum__grouped_kv_mqa__mixer_gmlp__prompt_kernel_a1_e8:
    s_waitcnt lgkmcnt(0)
    s_cmp_eq_u32 s55, 0
    s_cbranch_scc1 parallel_sum__grouped_kv_mqa__mixer_gmlp__prompt_kernel_a1_n9
    v_mfma_f32_32x32x16_bf16 v[96:111], v[32:35], v[128:131], 0
    ds_read_b64_tr_b16 v[48:49], v8 offset:57344
    ds_read_b64_tr_b16 v[50:51], v8 offset:57856
    ds_read_b64_tr_b16 v[52:53], v8 offset:59392
    ds_read_b64_tr_b16 v[54:55], v8 offset:59904
    s_nop 7
    s_nop 7
    v_mul_f32 v14, v64, v64
    v_mul_f32 v15, v65, v65
    v_mul_f32 v16, v66, v66
    v_mul_f32 v17, v67, v67
    v_fma_f32 v14, v14, s54, v112
    v_fma_f32 v15, v15, s54, v112
    v_fma_f32 v16, v16, s54, v112
    v_fma_f32 v17, v17, s54, v112
    v_mfma_f32_32x32x16_bf16 v[96:111], v[36:39], v[132:135], v[96:111]
    ds_read_b64_tr_b16 v[56:57], v8 offset:61440
    ds_read_b64_tr_b16 v[58:59], v8 offset:61952
    ds_read_b64_tr_b16 v[60:61], v8 offset:63488
    ds_read_b64_tr_b16 v[62:63], v8 offset:64000
    v_mul_f32 v14, v14, v64
    v_mul_f32 v15, v15, v65
    v_mul_f32 v16, v16, v66
    v_mul_f32 v17, v17, v67
    v_exp_f32 v14, v14
    v_exp_f32 v15, v15
    v_exp_f32 v16, v16
    v_exp_f32 v17, v17
    v_add_f32 v14, 1.0, v14
    v_add_f32 v15, 1.0, v15
    v_mfma_f32_32x32x16_bf16 v[96:111], v[40:43], v[136:139], v[96:111]
    v_add_f32 v16, 1.0, v16
    v_add_f32 v17, 1.0, v17
    v_rcp_f32 v14, v14
    v_rcp_f32 v15, v15
    v_rcp_f32 v16, v16
    v_rcp_f32 v17, v17
    v_mul_f32 v64, v64, v14
    v_mul_f32 v65, v65, v15
    v_mul_f32 v66, v66, v16
    v_mul_f32 v67, v67, v17
    v_mfma_f32_32x32x16_bf16 v[96:111], v[44:47], v[140:143], v[96:111]
    v_mul_f32 v14, v68, v68
    v_mul_f32 v15, v69, v69
    v_mul_f32 v16, v70, v70
    v_mul_f32 v17, v71, v71
    v_fma_f32 v14, v14, s54, v112
    v_fma_f32 v15, v15, s54, v112
    v_fma_f32 v16, v16, s54, v112
    v_fma_f32 v17, v17, s54, v112
    v_mul_f32 v14, v14, v68
    v_mul_f32 v15, v15, v69
    s_branch parallel_sum__grouped_kv_mqa__mixer_gmlp__prompt_kernel_a1_e9
parallel_sum__grouped_kv_mqa__mixer_gmlp__prompt_kernel_a1_n9:
    s_nop 7
    s_nop 7
    v_mul_f32 v14, v64, v64
    v_mul_f32 v15, v65, v65
    v_mul_f32 v16, v66, v66
    v_mul_f32 v17, v67, v67
    v_fma_f32 v14, v14, s54, v112
    v_fma_f32 v15, v15, s54, v112
    v_fma_f32 v16, v16, s54, v112
    v_fma_f32 v17, v17, s54, v112
    v_mul_f32 v14, v14, v64
    v_mul_f32 v15, v15, v65
    v_mul_f32 v16, v16, v66
    v_mul_f32 v17, v17, v67
    v_exp_f32 v14, v14
    v_exp_f32 v15, v15
    v_exp_f32 v16, v16
    v_exp_f32 v17, v17
    v_add_f32 v14, 1.0, v14
    v_add_f32 v15, 1.0, v15
    v_add_f32 v16, 1.0, v16
    v_add_f32 v17, 1.0, v17
    v_rcp_f32 v14, v14
    v_rcp_f32 v15, v15
    v_rcp_f32 v16, v16
    v_rcp_f32 v17, v17
    v_mul_f32 v64, v64, v14
    v_mul_f32 v65, v65, v15
    v_mul_f32 v66, v66, v16
    v_mul_f32 v67, v67, v17
    v_mul_f32 v14, v68, v68
    v_mul_f32 v15, v69, v69
    v_mul_f32 v16, v70, v70
    v_mul_f32 v17, v71, v71
    v_fma_f32 v14, v14, s54, v112
    v_fma_f32 v15, v15, s54, v112
    v_fma_f32 v16, v16, s54, v112
    v_fma_f32 v17, v17, s54, v112
    v_mul_f32 v14, v14, v68
    v_mul_f32 v15, v15, v69
parallel_sum__grouped_kv_mqa__mixer_gmlp__prompt_kernel_a1_e9:
    s_waitcnt lgkmcnt(0)
    s_waitcnt vmcnt(6)
    s_barrier
    s_cmp_eq_u32 s48, 2
    s_cbranch_scc0 parallel_sum__grouped_kv_mqa__mixer_gmlp__prompt_kernel_a1_cw
    s_mov_b32 s63, 0
    v_and_b32 v22, 1, v1
    v_lshlrev_b32 v22, 7, v22
parallel_sum__grouped_kv_mqa__mixer_gmlp__prompt_kernel_a1_cw_cl:
    global_load_dword v23, v22, s[44:45] sc1
    s_waitcnt vmcnt(0)
    v_cmp_le_u32 vcc, 128, v23
    s_nop 1
    s_cmp_eq_u64 vcc, exec
    s_cbranch_scc1 parallel_sum__grouped_kv_mqa__mixer_gmlp__prompt_kernel_a1_cw_cld
    s_add_u32 s63, s63, 1
    s_cmp_lt_u32 s63, 100000
    s_cbranch_scc1 parallel_sum__grouped_kv_mqa__mixer_gmlp__prompt_kernel_a1_cw_cl
parallel_sum__grouped_kv_mqa__mixer_gmlp__prompt_kernel_a1_cw_cld:
parallel_sum__grouped_kv_mqa__mixer_gmlp__prompt_kernel_a1_cw:
    s_cmp_eq_u32 s55, 0
    s_cbranch_scc1 parallel_sum__grouped_kv_mqa__mixer_gmlp__prompt_kernel_a1_n10
    v_mfma_f32_32x32x16_bf16 v[96:111], v[48:51], v[144:147], v[96:111]
    ds_read_b64_tr_b16 v[32:33], v9 offset:0
    ds_read_b64_tr_b16 v[34:35], v9 offset:512
    ds_read_b64_tr_b16 v[36:37], v9 offset:2048
    ds_read_b64_tr_b16 v[38:39], v9 offset:2560
    v_mul_f32 v16, v16, v70
    v_mul_f32 v17, v17, v71
    v_exp_f32 v14, v14
    v_exp_f32 v15, v15
    v_exp_f32 v16, v16
    v_exp_f32 v17, v17
    v_add_f32 v14, 1.0, v14
    v_add_f32 v15, 1.0, v15
    v_add_f32 v16, 1.0, v16
    v_add_f32 v17, 1.0, v17
    v_mfma_f32_32x32x16_bf16 v[96:111], v[52:55], v[148:151], v[96:111]
    ds_read_b64_tr_b16 v[40:41], v9 offset:4096
    ds_read_b64_tr_b16 v[42:43], v9 offset:4608
    ds_read_b64_tr_b16 v[44:45], v9 offset:6144
    ds_read_b64_tr_b16 v[46:47], v9 offset:6656
    v_rcp_f32 v14, v14
    v_rcp_f32 v15, v15
    v_rcp_f32 v16, v16
    v_rcp_f32 v17, v17
    v_mul_f32 v68, v68, v14
    v_mul_f32 v69, v69, v15
    v_mul_f32 v70, v70, v16
    v_mul_f32 v71, v71, v17
    v_mul_f32 v14, v72, v72
    v_mul_f32 v15, v73, v73
    v_mfma_f32_32x32x16_bf16 v[96:111], v[56:59], v[152:155], v[96:111]
    s_add_u32 s57, s96, 229376
    s_add_u32 m0, s60, 49152
    s_nop 0
    buffer_load_dwordx4 v4, s[16:19], s57 offen lds
    v_mul_f32 v16, v74, v74
    v_mul_f32 v17, v75, v75
    v_fma_f32 v14, v14, s54, v112
    v_fma_f32 v15, v15, s54, v112
    v_fma_f32 v16, v16, s54, v112
    v_fma_f32 v17, v17, s54, v112
    v_mul_f32 v14, v14, v72
    v_mul_f32 v15, v15, v73
    v_mul_f32 v16, v16, v74
    v_mul_f32 v17, v17, v75
    v_mfma_f32_32x32x16_bf16 v[96:111], v[60:63], v[156:159], v[96:111]
    s_add_u32 s57, s96, 243712
    s_add_u32 m0, s60, 50176
    s_nop 0
    buffer_load_dwordx4 v4, s[16:19], s57 offen lds
    v_exp_f32 v14, v14
    v_exp_f32 v15, v15
    v_exp_f32 v16, v16
    v_exp_f32 v17, v17
    v_add_f32 v14, 1.0, v14
    v_add_f32 v15, 1.0, v15
    v_add_f32 v16, 1.0, v16
    v_add_f32 v17, 1.0, v17
    v_rcp_f32 v14, v14
    v_rcp_f32 v15, v15
    s_branch parallel_sum__grouped_kv_mqa__mixer_gmlp__prompt_kernel_a1_e10
parallel_sum__grouped_kv_mqa__mixer_gmlp__prompt_kernel_a1_n10:
    s_add_u32 s57, s96, 229376
    s_add_u32 m0, s60, 49152
    s_nop 0
    buffer_load_dwordx4 v4, s[16:19], s57 offen lds
    s_add_u32 s57, s96, 243712
    s_add_u32 m0, s60, 50176
    s_nop 0
    buffer_load_dwordx4 v4, s[16:19], s57 offen lds
    v_mul_f32 v16, v16, v70
    v_mul_f32 v17, v17, v71
    v_exp_f32 v14, v14
    v_exp_f32 v15, v15
    v_exp_f32 v16, v16
    v_exp_f32 v17, v17
    v_add_f32 v14, 1.0, v14
    v_add_f32 v15, 1.0, v15
    v_add_f32 v16, 1.0, v16
    v_add_f32 v17, 1.0, v17
    v_rcp_f32 v14, v14
    v_rcp_f32 v15, v15
    v_rcp_f32 v16, v16
    v_rcp_f32 v17, v17
    v_mul_f32 v68, v68, v14
    v_mul_f32 v69, v69, v15
    v_mul_f32 v70, v70, v16
    v_mul_f32 v71, v71, v17
    v_mul_f32 v14, v72, v72
    v_mul_f32 v15, v73, v73
    v_mul_f32 v16, v74, v74
    v_mul_f32 v17, v75, v75
    v_fma_f32 v14, v14, s54, v112
    v_fma_f32 v15, v15, s54, v112
    v_fma_f32 v16, v16, s54, v112
    v_fma_f32 v17, v17, s54, v112
    v_mul_f32 v14, v14, v72
    v_mul_f32 v15, v15, v73
    v_mul_f32 v16, v16, v74
    v_mul_f32 v17, v17, v75
    v_exp_f32 v14, v14
    v_exp_f32 v15, v15
    v_exp_f32 v16, v16
    v_exp_f32 v17, v17
    v_add_f32 v14, 1.0, v14
    v_add_f32 v15, 1.0, v15
    v_add_f32 v16, 1.0, v16
    v_add_f32 v17, 1.0, v17
    v_rcp_f32 v14, v14
    v_rcp_f32 v15, v15
parallel_sum__grouped_kv_mqa__mixer_gmlp__prompt_kernel_a1_e10:
    s_waitcnt lgkmcnt(0)
    s_cmp_eq_u32 s55, 0
    s_cbranch_scc1 parallel_sum__grouped_kv_mqa__mixer_gmlp__prompt_kernel_a1_n11
    v_mfma_f32_32x32x16_bf16 v[96:111], v[32:35], v[160:163], v[96:111]
    ds_read_b64_tr_b16 v[48:49], v9 offset:8192
    ds_read_b64_tr_b16 v[50:51], v9 offset:8704
    ds_read_b64_tr_b16 v[52:53], v9 offset:10240
    ds_read_b64_tr_b16 v[54:55], v9 offset:10752
    v_rcp_f32 v16, v16
    v_rcp_f32 v17, v17
    v_mul_f32 v72, v72, v14
    v_mul_f32 v73, v73, v15
    v_mul_f32 v74, v74, v16
    v_mul_f32 v75, v75, v17
    v_mul_f32 v14, v76, v76
    v_mul_f32 v15, v77, v77
    v_mul_f32 v16, v78, v78
    v_mul_f32 v17, v79, v79
    v_mfma_f32_32x32x16_bf16 v[96:111], v[36:39], v[164:167], v[96:111]
    ds_read_b64_tr_b16 v[56:57], v9 offset:12288
    ds_read_b64_tr_b16 v[58:59], v9 offset:12800
    ds_read_b64_tr_b16 v[60:61], v9 offset:14336
    ds_read_b64_tr_b16 v[62:63], v9 offset:14848
    v_fma_f32 v14, v14, s54, v112
    v_fma_f32 v15, v15, s54, v112
    v_fma_f32 v16, v16, s54, v112
    v_fma_f32 v17, v17, s54, v112
    v_mul_f32 v14, v14, v76
    v_mul_f32 v15, v15, v77
    v_mul_f32 v16, v16, v78
    v_mul_f32 v17, v17, v79
    v_exp_f32 v14, v14
    v_exp_f32 v15, v15
    v_mfma_f32_32x32x16_bf16 v[96:111], v[40:43], v[168:171], v[96:111]
    v_exp_f32 v16, v16
    v_exp_f32 v17, v17
    v_add_f32 v14, 1.0, v14
    v_add_f32 v15, 1.0, v15
    v_add_f32 v16, 1.0, v16
    v_add_f32 v17, 1.0, v17
    v_rcp_f32 v14, v14
    v_rcp_f32 v15, v15
    v_rcp_f32 v16, v16
    v_rcp_f32 v17, v17
    v_mfma_f32_32x32x16_bf16 v[96:111], v[44:47], v[172:175], v[96:111]
    v_mul_f32 v76, v76, v14
    v_mul_f32 v77, v77, v15
    v_mul_f32 v78, v78, v16
    v_mul_f32 v79, v79, v17
    v_add_f32 v18, v64, v65
    v_mul_f32 v19, v64, v64
    v_fmac_f32 v19, v65, v65
    v_add_f32 v18, v18, v66
    v_fmac_f32 v19, v66, v66
    v_add_f32 v18, v18, v67
    s_branch parallel_sum__grouped_kv_mqa__mixer_gmlp__prompt_kernel_a1_e11
parallel_sum__grouped_kv_mqa__mixer_gmlp__prompt_kernel_a1_n11:
    v_rcp_f32 v16, v16
    v_rcp_f32 v17, v17
    v_mul_f32 v72, v72, v14
    v_mul_f32 v73, v73, v15
    v_mul_f32 v74, v74, v16
    v_mul_f32 v75, v75, v17
    v_mul_f32 v14, v76, v76
    v_mul_f32 v15, v77, v77
    v_mul_f32 v16, v78, v78
    v_mul_f32 v17, v79, v79
    v_fma_f32 v14, v14, s54, v112
    v_fma_f32 v15, v15, s54, v112
    v_fma_f32 v16, v16, s54, v112
    v_fma_f32 v17, v17, s54, v112
    v_mul_f32 v14, v14, v76
    v_mul_f32 v15, v15, v77
    v_mul_f32 v16, v16, v78
    v_mul_f32 v17, v17, v79
    v_exp_f32 v14, v14
    v_exp_f32 v15, v15
    v_exp_f32 v16, v16
    v_exp_f32 v17, v17
    v_add_f32 v14, 1.0, v14
    v_add_f32 v15, 1.0, v15
    v_add_f32 v16, 1.0, v16
    v_add_f32 v17, 1.0, v17
    v_rcp_f32 v14, v14
    v_rcp_f32 v15, v15
    v_rcp_f32 v16, v16
    v_rcp_f32 v17, v17
    v_mul_f32 v76, v76, v14
    v_mul_f32 v77, v77, v15
    v_mul_f32 v78, v78, v16
    v_mul_f32 v79, v79, v17
    v_add_f32 v18, v64, v65
    v_mul_f32 v19, v64, v64
    v_fmac_f32 v19, v65, v65
    v_add_f32 v18, v18, v66
    v_fmac_f32 v19, v66, v66
    v_add_f32 v18, v18, v67
parallel_sum__grouped_kv_mqa__mixer_gmlp__prompt_kernel_a1_e11:
    s_waitcnt lgkmcnt(0)
    s_waitcnt vmcnt(6)
    s_barrier
    s_cmp_eq_u32 s55, 0
    s_cbranch_scc1 parallel_sum__grouped_kv_mqa__mixer_gmlp__prompt_kernel_a1_n12
    v_mfma_f32_32x32x16_bf16 v[96:111], v[48:51], v[176:179], v[96:111]
    ds_read_b64_tr_b16 v[32:33], v8 offset:0
    ds_read_b64_tr_b16 v[34:35], v8 offset:512
    ds_read_b64_tr_b16 v[36:37], v8 offset:2048
    ds_read_b64_tr_b16 v[38:39], v8 offset:2560
    v_fmac_f32 v19, v67, v67
    v_add_f32 v18, v18, v68
    v_fmac_f32 v19, v68, v68
    v_add_f32 v18, v18, v69
    v_fmac_f32 v19, v69, v69
    v_add_f32 v18, v18, v70
    v_fmac_f32 v19, v70, v70
    v_add_f32 v18, v18, v71
    v_fmac_f32 v19, v71, v71
    v_mfma_f32_32x32x16_bf16 v[96:111], v[52:55], v[180:183], v[96:111]
    ds_read_b64_tr_b16 v[40:41], v8 offset:4096
    ds_read_b64_tr_b16 v[42:43], v8 offset:4608
    ds_read_b64_tr_b16 v[44:45], v8 offset:6144
    ds_read_b64_tr_b16 v[46:47], v8 offset:6656
    v_add_f32 v18, v18, v72
    v_fmac_f32 v19, v72, v72
    v_add_f32 v18, v18, v73
    v_fmac_f32 v19, v73, v73
    v_add_f32 v18, v18, v74
    v_fmac_f32 v19, v74, v74
    v_add_f32 v18, v18, v75
    v_fmac_f32 v19, v75, v75
    v_add_f32 v18, v18, v76
    v_fmac_f32 v19, v76, v76
    v_mfma_f32_32x32x16_bf16 v[96:111], v[56:59], v[184:187], v[96:111]
    s_add_u32 s57, s97, 0
    s_add_u32 m0, s60, 131072
    s_nop 0
    buffer_load_dwordx4 v4, s[16:19], s57 offen lds
    v_add_f32 v18, v18, v77
    v_fmac_f32 v19, v77, v77
    v_add_f32 v18, v18, v78
    v_fmac_f32 v19, v78, v78
    v_add_f32 v18, v18, v79
    v_fmac_f32 v19, v79, v79
    v_mov_b32 v20, v18
    v_mov_b32 v21, v19
    s_lshl_b32 s62, s50, 9
    v_mfma_f32_32x32x16_bf16 v[96:111], v[60:63], v[188:191], v[96:111]
    s_add_u32 s57, s97, 14336
    s_add_u32 m0, s60, 132096
    s_nop 0
    buffer_load_dwordx4 v4, s[16:19], s57 offen lds
    s_lshl_b32 s63, s49, 8
    v_permlane32_swap_b32 v18, v20
    v_permlane32_swap_b32 v19, v21
    s_add_u32 s62, s62, s63
    s_add_u32 s62, s62, 147456
    v_add_f32 v18, v18, v20
    v_add_f32 v19, v19, v21
    v_lshlrev_b32 v20, 3, v3
    v_add_u32 v20, s62, v20
    ds_write_b64 v20, v[18:19]
    s_branch parallel_sum__grouped_kv_mqa__mixer_gmlp__prompt_kernel_a1_e12
parallel_sum__grouped_kv_mqa__mixer_gmlp__prompt_kernel_a1_n12:
    s_add_u32 s57, s97, 0
    s_add_u32 m0, s60, 131072
    s_nop 0
    buffer_load_dwordx4 v4, s[16:19], s57 offen lds
    s_add_u32 s57, s97, 14336
    s_add_u32 m0, s60, 132096
    s_nop 0
    buffer_load_dwordx4 v4, s[16:19], s57 offen lds
    v_fmac_f32 v19, v67, v67
    v_add_f32 v18, v18, v68
    v_fmac_f32 v19, v68, v68
    v_add_f32 v18, v18, v69
    v_fmac_f32 v19, v69, v69
    v_add_f32 v18, v18, v70
    v_fmac_f32 v19, v70, v70
    v_add_f32 v18, v18, v71
    v_fmac_f32 v19, v71, v71
    v_add_f32 v18, v18, v72
    v_fmac_f32 v19, v72, v72
    v_add_f32 v18, v18, v73
    v_fmac_f32 v19, v73, v73
    v_add_f32 v18, v18, v74
    v_fmac_f32 v19, v74, v74
    v_add_f32 v18, v18, v75
    v_fmac_f32 v19, v75, v75
    v_add_f32 v18, v18, v76
    v_fmac_f32 v19, v76, v76
    v_add_f32 v18, v18, v77
    v_fmac_f32 v19, v77, v77
    v_add_f32 v18, v18, v78
    v_fmac_f32 v19, v78, v78
    v_add_f32 v18, v18, v79
    v_fmac_f32 v19, v79, v79
    v_mov_b32 v20, v18
    v_mov_b32 v21, v19
    s_lshl_b32 s62, s50, 9
    s_lshl_b32 s63, s49, 8
    v_permlane32_swap_b32 v18, v20
    v_permlane32_swap_b32 v19, v21
    s_add_u32 s62, s62, s63
    s_add_u32 s62, s62, 147456
    v_add_f32 v18, v18, v20
    v_add_f32 v19, v19, v21
    v_lshlrev_b32 v20, 3, v3
    v_add_u32 v20, s62, v20
    ds_write_b64 v20, v[18:19]
parallel_sum__grouped_kv_mqa__mixer_gmlp__prompt_kernel_a1_e12:
    s_waitcnt lgkmcnt(0)
    s_cmp_eq_u32 s55, 0
    s_cbranch_scc1 parallel_sum__grouped_kv_mqa__mixer_gmlp__prompt_kernel_a1_n13
    v_mfma_f32_32x32x16_bf16 v[96:111], v[32:35], v[192:195], v[96:111]
    ds_read_b64_tr_b16 v[48:49], v8 offset:8192
    ds_read_b64_tr_b16 v[50:51], v8 offset:8704
    ds_read_b64_tr_b16 v[52:53], v8 offset:10240
    ds_read_b64_tr_b16 v[54:55], v8 offset:10752
    v_mfma_f32_32x32x16_bf16 v[96:111], v[36:39], v[196:199], v[96:111]
    ds_read_b64_tr_b16 v[56:57], v8 offset:12288
    ds_read_b64_tr_b16 v[58:59], v8 offset:12800
    ds_read_b64_tr_b16 v[60:61], v8 offset:14336
    ds_read_b64_tr_b16 v[62:63], v8 offset:14848
    v_mfma_f32_32x32x16_bf16 v[96:111], v[40:43], v[200:203], v[96:111]
    v_mfma_f32_32x32x16_bf16 v[96:111], v[44:47], v[204:207], v[96:111]
    s_branch parallel_sum__grouped_kv_mqa__mixer_gmlp__prompt_kernel_a1_e13
parallel_sum__grouped_kv_mqa__mixer_gmlp__prompt_kernel_a1_n13:
parallel_sum__grouped_kv_mqa__mixer_gmlp__prompt_kernel_a1_e13:
    s_waitcnt lgkmcnt(0)
    s_waitcnt vmcnt(6)
    s_barrier
    s_cmp_eq_u32 s48, 0
    s_cbranch_scc0 parallel_sum__grouped_kv_mqa__mixer_gmlp__prompt_kernel_a1_pub
    v_lshlrev_b32 v22, 3, v1
    v_add_u32 v23, 147456, v22
    ds_read_b64 v[24:25], v23 offset:0
    ds_read_b64 v[26:27], v23 offset:512
    ds_read_b64 v[28:29], v23 offset:1024
    ds_read_b64 v[30:31], v23 offset:1536
    s_waitcnt lgkmcnt(0)
    v_add_f32 v24, v24, v26
    v_add_f32 v25, v25, v27
    v_add_f32 v24, v24, v28
    v_add_f32 v25, v25, v29
    v_add_f32 v24, v24, v30
    v_add_f32 v25, v25, v31
    s_mul_i32 s62, s46, 7
    s_add_u32 s62, s62, s47
    s_lshl_b32 s62, s62, 9
    s_add_u32 s62, s62, 2228224
    buffer_store_dwordx2 v[24:25], v22, s[4:7], s62 offen sc1
parallel_sum__grouped_kv_mqa__mixer_gmlp__prompt_kernel_a1_pub:
    s_cmp_eq_u32 s55, 0
    s_cbranch_scc1 parallel_sum__grouped_kv_mqa__mixer_gmlp__prompt_kernel_a1_n14
    v_mfma_f32_32x32x16_bf16 v[96:111], v[48:51], v[208:211], v[96:111]
    ds_read_b64_tr_b16 v[32:33], v8 offset:16384
    ds_read_b64_tr_b16 v[34:35], v8 offset:16896
    ds_read_b64_tr_b16 v[36:37], v8 offset:18432
    ds_read_b64_tr_b16 v[38:39], v8 offset:18944
    v_mfma_f32_32x32x16_bf16 v[96:111], v[52:55], v[212:215], v[96:111]
    ds_read_b64_tr_b16 v[40:41], v8 offset:20480
    ds_read_b64_tr_b16 v[42:43], v8 offset:20992
    ds_read_b64_tr_b16 v[44:45], v8 offset:22528
    ds_read_b64_tr_b16 v[46:47], v8 offset:23040
    v_mfma_f32_32x32x16_bf16 v[96:111], v[56:59], v[216:219], v[96:111]
    s_add_u32 s57, s97, 229376
    s_add_u32 m0, s60, 0
    s_nop 0
    buffer_load_dwordx4 v4, s[16:19], s57 offen lds
    v_mfma_f32_32x32x16_bf16 v[96:111], v[60:63], v[220:223], v[96:111]
    s_add_u32 s57, s97, 243712
    s_add_u32 m0, s60, 1024
    s_nop 0
    buffer_load_dwordx4 v4, s[16:19], s57 offen lds
    s_branch parallel_sum__grouped_kv_mqa__mixer_gmlp__prompt_kernel_a1_e14
parallel_sum__grouped_kv_mqa__mixer_gmlp__prompt_kernel_a1_n14:
    s_add_u32 s57, s97, 229376
    s_add_u32 m0, s60, 0
    s_nop 0
    buffer_load_dwordx4 v4, s[16:19], s57 offen lds
    s_add_u32 s57, s97, 243712
    s_add_u32 m0, s60, 1024
    s_nop 0
    buffer_load_dwordx4 v4, s[16:19], s57 offen lds
parallel_sum__grouped_kv_mqa__mixer_gmlp__prompt_kernel_a1_e14:
    s_waitcnt lgkmcnt(0)
    s_cmp_eq_u32 s55, 0
    s_cbranch_scc1 parallel_sum__grouped_kv_mqa__mixer_gmlp__prompt_kernel_a1_n15
    v_mfma_f32_32x32x16_bf16 v[96:111], v[32:35], v[224:227], v[96:111]
    ds_read_b64_tr_b16 v[48:49], v8 offset:24576
    ds_read_b64_tr_b16 v[50:51], v8 offset:25088
    ds_read_b64_tr_b16 v[52:53], v8 offset:26624
    ds_read_b64_tr_b16 v[54:55], v8 offset:27136
    v_mfma_f32_32x32x16_bf16 v[96:111], v[36:39], v[228:231], v[96:111]
    ds_read_b64_tr_b16 v[56:57], v8 offset:28672
    ds_read_b64_tr_b16 v[58:59], v8 offset:29184
    ds_read_b64_tr_b16 v[60:61], v8 offset:30720
    ds_read_b64_tr_b16 v[62:63], v8 offset:31232
    v_mfma_f32_32x32x16_bf16 v[96:111], v[40:43], v[232:235], v[96:111]
    v_mfma_f32_32x32x16_bf16 v[96:111], v[44:47], v[236:239], v[96:111]
    s_branch parallel_sum__grouped_kv_mqa__mixer_gmlp__prompt_kernel_a1_e15
parallel_sum__grouped_kv_mqa__mixer_gmlp__prompt_kernel_a1_n15:
parallel_sum__grouped_kv_mqa__mixer_gmlp__prompt_kernel_a1_e15:
    s_waitcnt lgkmcnt(0)
    s_waitcnt vmcnt(6)
    s_barrier
    s_cmp_eq_u32 s55, 0
    s_cbranch_scc1 parallel_sum__grouped_kv_mqa__mixer_gmlp__prompt_kernel_a1_m16
    v_mfma_f32_32x32x16_bf16 v[96:111], v[48:51], v[240:243], v[96:111]
    v_mfma_f32_32x32x16_bf16 v[96:111], v[52:55], v[244:247], v[96:111]
    v_mfma_f32_32x32x16_bf16 v[96:111], v[56:59], v[248:251], v[96:111]
    v_mfma_f32_32x32x16_bf16 v[96:111], v[60:63], v[252:255], v[96:111]
parallel_sum__grouped_kv_mqa__mixer_gmlp__prompt_kernel_a1_m16:
    ds_read_b64_tr_b16 v[32:33], v6 offset:32768
    ds_read_b64_tr_b16 v[34:35], v6 offset:33792
    ds_read_b64_tr_b16 v[36:37], v6 offset:36864
    ds_read_b64_tr_b16 v[38:39], v6 offset:37888
    ds_read_b64_tr_b16 v[40:41], v6 offset:40960
    ds_read_b64_tr_b16 v[42:43], v6 offset:41984
    ds_read_b64_tr_b16 v[44:45], v6 offset:45056
    ds_read_b64_tr_b16 v[46:47], v6 offset:46080
    s_add_u32 s57, s98, 0
    s_add_u32 m0, s60, 16384
    s_nop 0
    buffer_load_dwordx4 v4, s[16:19], s57 offen lds
    s_add_u32 s57, s98, 14336
    s_add_u32 m0, s60, 17408
    s_nop 0
    buffer_load_dwordx4 v4, s[16:19], s57 offen lds
    s_waitcnt lgkmcnt(0)
    s_cmp_eq_u32 s55, 0
    s_cbranch_scc1 parallel_sum__grouped_kv_mqa__mixer_gmlp__prompt_kernel_a1_x16
    s_nop 7
    s_nop 7
    s_mov_b32 s62, 1052289595
    v_mul_f32 v96, s62, v96
    v_mul_f32 v97, s62, v97
    v_mul_f32 v98, s62, v98
    v_mul_f32 v99, s62, v99
    v_mul_f32 v100, s62, v100
    v_mul_f32 v101, s62, v101
    v_mul_f32 v102, s62, v102
    v_mul_f32 v103, s62, v103
    v_mul_f32 v104, s62, v104
    v_mul_f32 v105, s62, v105
    v_mul_f32 v106, s62, v106
    v_mul_f32 v107, s62, v107
    v_mul_f32 v108, s62, v108
    v_mul_f32 v109, s62, v109
    v_mul_f32 v110, s62, v110
    v_mul_f32 v111, s62, v111
    v_cvt_pk_bf16_f32 v14, v96, v97
    v_cvt_pk_bf16_f32 v15, v98, v99
    v_cvt_pk_bf16_f32 v16, v100, v101
    v_cvt_pk_bf16_f32 v17, v102, v103
    v_cvt_pk_bf16_f32 v18, v104, v105
    v_cvt_pk_bf16_f32 v19, v106, v107
    v_cvt_pk_bf16_f32 v20, v108, v109
    v_cvt_pk_bf16_f32 v21, v110, v111
    s_lshl_b32 s62, s49, 12
    s_and_b32 s63, s48, 1
    s_lshl_b32 s63, s63, 11
    s_add_u32 s62, s62, s63
    s_add_u32 s62, s62, 155648
    v_lshlrev_b32 v22, 4, v1
    v_add_u32 v22, s62, v22
    ds_write_b128 v22, v[14:17]
    ds_write_b128 v22, v[18:21] offset:1024
    s_waitcnt lgkmcnt(0)
parallel_sum__grouped_kv_mqa__mixer_gmlp__prompt_kernel_a1_x16:
    s_waitcnt vmcnt(6)
    s_barrier
    v_mfma_f32_32x32x16_bf16 v[80:95], v[32:35], v[128:131], 0
    ds_read_b64_tr_b16 v[48:49], v6 offset:49152
    ds_read_b64_tr_b16 v[50:51], v6 offset:50176
    ds_read_b64_tr_b16 v[52:53], v6 offset:53248
    ds_read_b64_tr_b16 v[54:55], v6 offset:54272
    v_mfma_f32_32x32x16_bf16 v[80:95], v[36:39], v[132:135], v[80:95]
    ds_read_b64_tr_b16 v[56:57], v6 offset:57344
    ds_read_b64_tr_b16 v[58:59], v6 offset:58368
    ds_read_b64_tr_b16 v[60:61], v6 offset:61440
    ds_read_b64_tr_b16 v[62:63], v6 offset:62464
    v_mfma_f32_32x32x16_bf16 v[80:95], v[40:43], v[136:139], v[80:95]
    s_add_u32 s57, s98, 229376
    s_add_u32 m0, s60, 32768
    s_nop 0
    buffer_load_dwordx4 v4, s[16:19], s57 offen lds
    v_mfma_f32_32x32x16_bf16 v[80:95], v[44:47], v[140:143], v[80:95]
    s_add_u32 s57, s98, 243712
    s_add_u32 m0, s60, 33792
    s_nop 0
    buffer_load_dwordx4 v4, s[16:19], s57 offen lds
    s_waitcnt lgkmcnt(0)
    s_cmp_eq_u32 s48, 3
    s_cbranch_scc0 parallel_sum__grouped_kv_mqa__mixer_gmlp__prompt_kernel_a1_sl
    s_mul_i32 s62, s46, 3584
    s_add_u32 s62, s62, 2228224
    v_lshlrev_b32 v96, 3, v1
    buffer_load_dwordx2 v[98:99], v96, s[4:7], s62 offen offset:0 sc1
    buffer_load_dwordx2 v[100:101], v96, s[4:7], s62 offen offset:512 sc1
    buffer_load_dwordx2 v[102:103], v96, s[4:7], s62 offen offset:1024 sc1
    buffer_load_dwordx2 v[104:105], v96, s[4:7], s62 offen offset:1536 sc1
    buffer_load_dwordx2 v[106:107], v96, s[4:7], s62 offen offset:2048 sc1
    buffer_load_dwordx2 v[108:109], v96, s[4:7], s62 offen offset:2560 sc1
    buffer_load_dwordx2 v[110:111], v96, s[4:7], s62 offen offset:3072 sc1
parallel_sum__grouped_kv_mqa__mixer_gmlp__prompt_kernel_a1_sl:
    s_waitcnt vmcnt(6)
    s_barrier
    v_mfma_f32_32x32x16_bf16 v[80:95], v[48:51], v[144:147], v[80:95]
    ds_read_b64_tr_b16 v[32:33], v7 offset:0
    ds_read_b64_tr_b16 v[34:35], v7 offset:1024
    ds_read_b64_tr_b16 v[36:37], v7 offset:4096
    ds_read_b64_tr_b16 v[38:39], v7 offset:5120
    v_mfma_f32_32x32x16_bf16 v[80:95], v[52:55], v[148:151], v[80:95]
    ds_read_b64_tr_b16 v[40:41], v7 offset:8192
    ds_read_b64_tr_b16 v[42:43], v7 offset:9216
    ds_read_b64_tr_b16 v[44:45], v7 offset:12288
    ds_read_b64_tr_b16 v[46:47], v7 offset:13312
    v_mfma_f32_32x32x16_bf16 v[80:95], v[56:59], v[152:155], v[80:95]
    s_add_u32 s57, s99, 0
    s_add_u32 m0, s60, 49152
    s_nop 0
    buffer_load_dwordx4 v4, s[16:19], s57 offen lds
    v_mfma_f32_32x32x16_bf16 v[80:95], v[60:63], v[156:159], v[80:95]
    s_add_u32 s57, s99, 14336
    s_add_u32 m0, s60, 50176
    s_nop 0
    buffer_load_dwordx4 v4, s[16:19], s57 offen lds
    s_waitcnt lgkmcnt(0)
    s_waitcnt vmcnt(6)
    s_barrier
    s_cmp_eq_u32 s48, 3
    s_cbranch_scc0 parallel_sum__grouped_kv_mqa__mixer_gmlp__prompt_kernel_a1_sc_w
    s_mul_i32 s62, s46, 3584
    s_add_u32 s62, s62, 2228224
    s_mov_b32 s63, 0
    v_lshlrev_b32 v96, 3, v1
    s_waitcnt vmcnt(2)
    s_branch parallel_sum__grouped_kv_mqa__mixer_gmlp__prompt_kernel_a1_sc_ck
parallel_sum__grouped_kv_mqa__mixer_gmlp__prompt_kernel_a1_sc_sp:
    buffer_load_dwordx2 v[98:99], v96, s[4:7], s62 offen offset:0 sc1
    buffer_load_dwordx2 v[100:101], v96, s[4:7], s62 offen offset:512 sc1
    buffer_load_dwordx2 v[102:103], v96, s[4:7], s62 offen offset:1024 sc1
    buffer_load_dwordx2 v[104:105], v96, s[4:7], s62 offen offset:1536 sc1
    buffer_load_dwordx2 v[106:107], v96, s[4:7], s62 offen offset:2048 sc1
    buffer_load_dwordx2 v[108:109], v96, s[4:7], s62 offen offset:2560 sc1
    buffer_load_dwordx2 v[110:111], v96, s[4:7], s62 offen offset:3072 sc1
    s_waitcnt vmcnt(0)
parallel_sum__grouped_kv_mqa__mixer_gmlp__prompt_kernel_a1_sc_ck:
    v_max3_u32 v97, v98, v99, v100
    v_max3_u32 v97, v97, v101, v102
    v_max3_u32 v97, v97, v103, v104
    v_max3_u32 v97, v97, v105, v106
    v_max3_u32 v97, v97, v107, v108
    v_max3_u32 v97, v97, v109, v110
    v_max_u32 v97, v97, v111
    v_cmp_eq_u32 vcc, -1, v97
    s_add_u32 s63, s63, 1
    s_cmp_ge_u32 s63, 100000
    s_cbranch_scc1 parallel_sum__grouped_kv_mqa__mixer_gmlp__prompt_kernel_a1_sc_spd
    s_cbranch_vccnz parallel_sum__grouped_kv_mqa__mixer_gmlp__prompt_kernel_a1_sc_sp
parallel_sum__grouped_kv_mqa__mixer_gmlp__prompt_kernel_a1_sc_spd:
    v_add_f32 v98, v98, v100
    v_add_f32 v99, v99, v101
    v_add_f32 v98, v98, v102
    v_add_f32 v99, v99, v103
    v_add_f32 v98, v98, v104
    v_add_f32 v99, v99, v105
    v_add_f32 v98, v98, v106
    v_add_f32 v99, v99, v107
    v_add_f32 v98, v98, v108
    v_add_f32 v99, v99, v109
    v_add_f32 v98, v98, v110
    v_add_f32 v99, v99, v111
    v_mul_f32 v98, 982665509, v98
    v_mul_f32 v99, 982665509, v99
    v_fma_f32 v99, -v98, v98, v99
    v_max_f32 v99, 0, v99
    v_add_f32 v99, 925353388, v99
    v_rsq_f32 v99, v99
    s_nop 0
    v_mul_f32 v98, v98, v99
    v_sub_f32 v98, 0, v98
    v_add_u32 v96, 149504, v96
    ds_write_b64 v96, v[98:99]
    s_waitcnt lgkmcnt(0)
parallel_sum__grouped_kv_mqa__mixer_gmlp__prompt_kernel_a1_sc_w:
    v_mfma_f32_32x32x16_bf16 v[80:95], v[32:35], v[160:163], v[80:95]
    ds_read_b64_tr_b16 v[48:49], v6 offset:0
    ds_read_b64_tr_b16 v[50:51], v6 offset:1024
    ds_read_b64_tr_b16 v[52:53], v6 offset:4096
    ds_read_b64_tr_b16 v[54:55], v6 offset:5120
    v_mfma_f32_32x32x16_bf16 v[80:95], v[36:39], v[164:167], v[80:95]
    ds_read_b64_tr_b16 v[56:57], v6 offset:8192
    ds_read_b64_tr_b16 v[58:59], v6 offset:9216
    ds_read_b64_tr_b16 v[60:61], v6 offset:12288
    ds_read_b64_tr_b16 v[62:63], v6 offset:13312
    v_mfma_f32_32x32x16_bf16 v[80:95], v[40:43], v[168:171], v[80:95]
    s_add_u32 s57, s99, 229376
    s_add_u32 m0, s60, 131072
    s_nop 0
    buffer_load_dwordx4 v4, s[16:19], s57 offen lds
    v_mfma_f32_32x32x16_bf16 v[80:95], v[44:47], v[172:175], v[80:95]
    s_add_u32 s57, s99, 243712
    s_add_u32 m0, s60, 132096
    s_nop 0
    buffer_load_dwordx4 v4, s[16:19], s57 offen lds
    s_waitcnt lgkmcnt(0)
    s_waitcnt vmcnt(6)
    s_barrier
    v_mfma_f32_32x32x16_bf16 v[80:95], v[48:51], v[176:179], v[80:95]
    ds_read_b64_tr_b16 v[32:33], v6 offset:16384
    ds_read_b64_tr_b16 v[34:35], v6 offset:17408
    ds_read_b64_tr_b16 v[36:37], v6 offset:20480
    ds_read_b64_tr_b16 v[38:39], v6 offset:21504
    v_mfma_f32_32x32x16_bf16 v[80:95], v[52:55], v[180:183], v[80:95]
    ds_read_b64_tr_b16 v[40:41], v6 offset:24576
    ds_read_b64_tr_b16 v[42:43], v6 offset:25600
    ds_read_b64_tr_b16 v[44:45], v6 offset:28672
    ds_read_b64_tr_b16 v[46:47], v6 offset:29696
    v_mfma_f32_32x32x16_bf16 v[80:95], v[56:59], v[184:187], v[80:95]
    v_mfma_f32_32x32x16_bf16 v[80:95], v[60:63], v[188:191], v[80:95]
    s_waitcnt lgkmcnt(0)
    s_cmp_eq_u32 s48, 2
    s_cbranch_scc0 parallel_sum__grouped_kv_mqa__mixer_gmlp__prompt_kernel_a1_kl
    v_lshlrev_b32 v24, 10, v3
    v_add_u32 v24, 15467396, v24
    buffer_load_dword v25, v24, s[4:7], 0 offen sc1
parallel_sum__grouped_kv_mqa__mixer_gmlp__prompt_kernel_a1_kl:
    s_lshl_b32 s62, s49, 8
    s_add_u32 s62, s62, 149504
    v_lshlrev_b32 v14, 3, v3
    v_add_u32 v14, s62, v14
    ds_read_b64 v[16:17], v14
    s_mul_i32 s65, s48, 2304
    s_add_u32 s65, s65, 102400
    v_mul_u32_u24 v18, 72, v3
    v_lshl_add_u32 v18, v2, 3, v18
    v_add_u32 v18, s65, v18
    v_bfe_u32 v19, v1, 2, 2
    v_lshl_add_u32 v19, v2, 3, v19
    v_mul_u32_u24 v19, 72, v19
    v_bfe_u32 v20, v1, 4, 1
    v_lshl_add_u32 v19, v20, 5, v19
    v_and_b32 v20, 3, v1
    v_lshl_add_u32 v19, v20, 3, v19
    v_add_u32 v19, s65, v19
    s_waitcnt lgkmcnt(0)
    v_fma_f32 v64, v64, v17, v16
    v_fma_f32 v65, v65, v17, v16
    v_fma_f32 v66, v66, v17, v16
    v_fma_f32 v67, v67, v17, v16
    v_fma_f32 v68, v68, v17, v16
    v_fma_f32 v69, v69, v17, v16
    v_fma_f32 v70, v70, v17, v16
    v_fma_f32 v71, v71, v17, v16
    v_fma_f32 v72, v72, v17, v16
    v_fma_f32 v73, v73, v17, v16
    v_fma_f32 v74, v74, v17, v16
    v_fma_f32 v75, v75, v17, v16
    v_fma_f32 v76, v76, v17, v16
    v_fma_f32 v77, v77, v17, v16
    v_fma_f32 v78, v78, v17, v16
    v_fma_f32 v79, v79, v17, v16
    v_cvt_pk_bf16_f32 v96, v64, v65
    v_cvt_pk_bf16_f32 v97, v66, v67
    v_cvt_pk_bf16_f32 v98, v68, v69
    v_cvt_pk_bf16_f32 v99, v70, v71
    v_cvt_pk_bf16_f32 v100, v72, v73
    v_cvt_pk_bf16_f32 v101, v74, v75
    v_cvt_pk_bf16_f32 v102, v76, v77
    v_cvt_pk_bf16_f32 v103, v78, v79
    ds_write_b64 v18, v[96:97] offset:0
    ds_write_b64 v18, v[98:99] offset:16
    ds_write_b64 v18, v[100:101] offset:32
    ds_write_b64 v18, v[102:103] offset:48
    s_lshl_b32 s62, s47, 2
    s_add_u32 s62, s62, s50
    s_lshl_b32 s62, s62, 7
    s_lshl_b32 s63, s46, 2
    s_add_u32 s62, s62, s63
    s_lshl_b32 s63, s49, 1
    s_add_u32 s62, s62, s63
    s_lshl_b32 s62, s62, 10
    s_add_u32 s62, s62, 6029312
    v_lshlrev_b32 v22, 4, v1
    s_waitcnt lgkmcnt(0)
    ds_read_b64_tr_b16 v[104:105], v19 offset:0
    ds_read_b64_tr_b16 v[106:107], v19 offset:288
    ds_read_b64_tr_b16 v[108:109], v19 offset:1152
    ds_read_b64_tr_b16 v[110:111], v19 offset:1440
    s_waitcnt lgkmcnt(0)
    buffer_store_dwordx4 v[104:107], v22, s[4:7], s62 offen sc1
    buffer_store_dwordx4 v[108:111], v22, s[4:7], s62 offen offset:1024 sc1
    s_waitcnt vmcnt(6)
    s_barrier
    v_mfma_f32_32x32x16_bf16 v[80:95], v[32:35], v[192:195], v[80:95]
    ds_read_b64_tr_b16 v[48:49], v6 offset:32768
    ds_read_b64_tr_b16 v[50:51], v6 offset:33792
    ds_read_b64_tr_b16 v[52:53], v6 offset:36864
    ds_read_b64_tr_b16 v[54:55], v6 offset:37888
    v_mfma_f32_32x32x16_bf16 v[80:95], v[36:39], v[196:199], v[80:95]
    ds_read_b64_tr_b16 v[56:57], v6 offset:40960
    ds_read_b64_tr_b16 v[58:59], v6 offset:41984
    ds_read_b64_tr_b16 v[60:61], v6 offset:45056
    ds_read_b64_tr_b16 v[62:63], v6 offset:46080
    v_mfma_f32_32x32x16_bf16 v[80:95], v[40:43], v[200:203], v[80:95]
    v_mfma_f32_32x32x16_bf16 v[80:95], v[44:47], v[204:207], v[80:95]
    s_waitcnt lgkmcnt(0)
    s_waitcnt vmcnt(4)
    s_barrier
    s_cmp_eq_u32 s48, 2
    s_cbranch_scc0 parallel_sum__grouped_kv_mqa__mixer_gmlp__prompt_kernel_a1_kc
    s_waitcnt vmcnt(2)
    v_cmp_ne_u32 vcc, 0, v25
    s_nop 1
    s_cmp_eq_u64 vcc, exec
    s_cbranch_scc1 parallel_sum__grouped_kv_mqa__mixer_gmlp__prompt_kernel_a1_kc
    v_lshlrev_b32 v24, 10, v3
    v_add_u32 v24, 15467396, v24
    s_mov_b32 s63, 0
    s_mov_b64 s[64:65], -1
parallel_sum__grouped_kv_mqa__mixer_gmlp__prompt_kernel_a1_kvp_poll:
    buffer_load_dword v25, v24, s[4:7], 0 offen sc1
    s_waitcnt vmcnt(0)
    v_cmp_ne_u32 vcc, 0, v25
    s_nop 1
    s_and_b64 vcc, vcc, s[64:65]
    s_cmp_eq_u64 vcc, s[64:65]
    s_cbranch_scc1 parallel_sum__grouped_kv_mqa__mixer_gmlp__prompt_kernel_a1_kvp_done
    s_add_u32 s63, s63, 1
    s_cmp_lt_u32 s63, 100000
    s_cbranch_scc1 parallel_sum__grouped_kv_mqa__mixer_gmlp__prompt_kernel_a1_kvp_poll
parallel_sum__grouped_kv_mqa__mixer_gmlp__prompt_kernel_a1_kvp_done:
parallel_sum__grouped_kv_mqa__mixer_gmlp__prompt_kernel_a1_kc:
    v_mfma_f32_32x32x16_bf16 v[80:95], v[48:51], v[208:211], v[80:95]
    ds_read_b64_tr_b16 v[32:33], v6 offset:49152
    ds_read_b64_tr_b16 v[34:35], v6 offset:50176
    ds_read_b64_tr_b16 v[36:37], v6 offset:53248
    ds_read_b64_tr_b16 v[38:39], v6 offset:54272
    v_mfma_f32_32x32x16_bf16 v[80:95], v[52:55], v[212:215], v[80:95]
    ds_read_b64_tr_b16 v[40:41], v6 offset:57344
    ds_read_b64_tr_b16 v[42:43], v6 offset:58368
    ds_read_b64_tr_b16 v[44:45], v6 offset:61440
    ds_read_b64_tr_b16 v[46:47], v6 offset:62464
    v_mfma_f32_32x32x16_bf16 v[80:95], v[56:59], v[216:219], v[80:95]
    v_mfma_f32_32x32x16_bf16 v[80:95], v[60:63], v[220:223], v[80:95]
    s_waitcnt lgkmcnt(0)
    s_waitcnt vmcnt(0)
    s_barrier
    s_lshr_b32 s63, s48, 1
    s_lshl_b32 s66, s63, 10
    s_and_b32 s62, s48, 1
    s_lshl_b32 s62, s62, 8
    s_add_u32 s66, s66, s62
    s_add_u32 m0, s66, 94208
    s_mov_b64 exec, s[52:53]
    buffer_load_dwordx4 v114, s[4:7], 0 offen sc1 lds
    s_mov_b64 exec, -1
    s_cmp_eq_u32 s48, 1
    s_cbranch_scc0 parallel_sum__grouped_kv_mqa__mixer_gmlp__prompt_kernel_a1_zfl
    s_lshl_b32 s62, s46, 3
    s_add_u32 s62, s62, s47
    s_lshl_b32 s62, s62, 7
    s_add_u32 s62, s62, 15466500
    v_mov_b32 v22, 0
    v_mov_b32 v23, 1
    s_mov_b64 exec, 1
    buffer_store_dword v23, v22, s[4:7], s62 offen sc1
    s_mov_b64 exec, -1
parallel_sum__grouped_kv_mqa__mixer_gmlp__prompt_kernel_a1_zfl:
    v_mfma_f32_32x32x16_bf16 v[80:95], v[32:35], v[224:227], v[80:95]
    ds_read_b64_tr_b16 v[48:49], v7 offset:0
    ds_read_b64_tr_b16 v[50:51], v7 offset:1024
    ds_read_b64_tr_b16 v[52:53], v7 offset:4096
    ds_read_b64_tr_b16 v[54:55], v7 offset:5120
    v_mfma_f32_32x32x16_bf16 v[80:95], v[36:39], v[228:231], v[80:95]
    ds_read_b64_tr_b16 v[56:57], v7 offset:8192
    ds_read_b64_tr_b16 v[58:59], v7 offset:9216
    ds_read_b64_tr_b16 v[60:61], v7 offset:12288
    ds_read_b64_tr_b16 v[62:63], v7 offset:13312
    v_mfma_f32_32x32x16_bf16 v[80:95], v[40:43], v[232:235], v[80:95]
    v_mfma_f32_32x32x16_bf16 v[80:95], v[44:47], v[236:239], v[80:95]
    s_waitcnt lgkmcnt(0)
    v_mfma_f32_32x32x16_bf16 v[80:95], v[48:51], v[240:243], v[80:95]
    v_mfma_f32_32x32x16_bf16 v[80:95], v[52:55], v[244:247], v[80:95]
    v_mfma_f32_32x32x16_bf16 v[80:95], v[56:59], v[248:251], v[80:95]
    v_mfma_f32_32x32x16_bf16 v[80:95], v[60:63], v[252:255], v[80:95]
    s_waitcnt lgkmcnt(0)
    s_waitcnt vmcnt(0)
    s_barrier
    s_lshl_b32 s62, s46, 6
    s_lshl_b32 s63, s49, 5
    s_add_u32 s62, s62, s63
    v_add_u32 v14, s62, v3
    v_lshlrev_b32 v14, 1, v14
    buffer_load_ushort v104, v14, s[24:27], 0 offen
    s_lshl_b32 s62, s50, 10
    s_add_u32 s62, s62, 155648
    v_lshlrev_b32 v224, 4, v1
    v_add_u32 v227, s62, v224
    ds_read_b128 v[4:7], v227
    ds_read_b128 v[8:11], v227 offset:4096
    v_add_u32 v224, 94208, v224
    v_add_u32 v225, 86016, v116
    v_add_u32 v226, 86016, v117
    ds_read_b128 v[32:35], v224
    ds_read_b128 v[12:15], v225
    v_and_b32 v228, 0x1b, v0
    v_cmp_eq_u32 vcc, 16, v228
    v_mov_b32 v229, 0x3f803f80
    s_mov_b32 s55, 2048
    s_mov_b32 s54, 0
    s_mov_b32 s56, 0
    s_mov_b32 s57, 0
    s_lshl_b32 s58, s48, 10
    s_lshr_b32 s63, s48, 1
    s_lshl_b32 s59, s63, 10
    s_and_b32 s62, s48, 1
    s_lshl_b32 s62, s62, 8
    s_add_u32 s59, s59, s62
    s_add_u32 s59, s59, 8192
    s_mov_b32 s60, 49152
    v_cndmask_b32 v16, 0, v229, vcc
    v_cndmask_b32 v20, 0, v229, vcc
    v_cndmask_b32 v17, 0, v229, vcc
    v_cndmask_b32 v21, 0, v229, vcc
    v_cndmask_b32 v18, 0, v229, vcc
    v_cndmask_b32 v22, 0, v229, vcc
    v_cndmask_b32 v19, 0, v229, vcc
    v_cndmask_b32 v23, 0, v229, vcc
    s_mov_b64 exec, s[52:53]
    ds_read_b128 v[16:19], v226
    s_mov_b64 exec, -1
    s_waitcnt lgkmcnt(2)
    v_mfma_f32_32x32x16_bf16 v[40:55], v[32:35], v[4:7], 0
    v_mfma_f32_32x32x16_bf16 v[56:71], v[32:35], v[8:11], 0
    s_add_u32 m0, s57, s59
    s_mov_b64 exec, s[52:53]
    buffer_load_dwordx4 v114, s[4:7], s55 offen sc1 lds
    s_mov_b64 exec, -1
    s_add_u32 s55, s55, 2048
    s_mov_b32 s54, 0
    s_add_u32 m0, s57, s58
    s_nop 0
    buffer_load_dwordx4 v113, s[20:23], s54 offen lds
    s_add_u32 s54, s54, 128
    s_add_u32 s57, s57, 12288
    s_cmp_eq_u32 s57, 98304
    s_cselect_b32 s57, 0, s57
    s_add_u32 m0, s57, s59
    s_mov_b64 exec, s[52:53]
    buffer_load_dwordx4 v114, s[4:7], s55 offen sc1 lds
    s_mov_b64 exec, -1
    s_add_u32 s55, s55, 2048
    s_mov_b32 s54, 128
    s_add_u32 m0, s57, s58
    s_nop 0
    buffer_load_dwordx4 v113, s[20:23], s54 offen lds
    s_add_u32 s54, s54, 128
    s_add_u32 s57, s57, 12288
    s_cmp_eq_u32 s57, 98304
    s_cselect_b32 s57, 0, s57
    s_add_u32 m0, s57, s59
    s_mov_b64 exec, s[52:53]
    buffer_load_dwordx4 v114, s[4:7], s55 offen sc1 lds
    s_mov_b64 exec, -1
    s_add_u32 s55, s55, 2048
    s_mov_b32 s54, 256
    s_add_u32 m0, s57, s58
    s_nop 0
    buffer_load_dwordx4 v113, s[20:23], s54 offen lds
    s_add_u32 s54, s54, 128
    s_add_u32 s57, s57, 12288
    s_cmp_eq_u32 s57, 98304
    s_cselect_b32 s57, 0, s57
    v_max3_f32 v230, v40, v41, v42
    v_max3_f32 v230, v230, v43, v44
    v_max3_f32 v230, v230, v45, v46
    v_max3_f32 v230, v230, v47, v48
    v_max3_f32 v230, v230, v49, v50
    v_max3_f32 v230, v230, v51, v52
    v_max3_f32 v230, v230, v53, v54
    v_max_f32 v230, v230, v55
    v_mov_b32 v231, v230
    s_nop 1
    v_permlane32_swap_b32 v230, v231
    s_nop 1
    v_max_f32 v230, v230, v231
    v_sub_f32 v128, 0, v230
    v_sub_f32 v129, 0, v230
    v_sub_f32 v130, 0, v230
    v_sub_f32 v131, 0, v230
    v_sub_f32 v132, 0, v230
    v_sub_f32 v133, 0, v230
    v_sub_f32 v134, 0, v230
    v_sub_f32 v135, 0, v230
    v_sub_f32 v136, 0, v230
    v_sub_f32 v137, 0, v230
    v_sub_f32 v138, 0, v230
    v_sub_f32 v139, 0, v230
    v_sub_f32 v140, 0, v230
    v_sub_f32 v141, 0, v230
    v_sub_f32 v142, 0, v230
    v_sub_f32 v143, 0, v230
    s_waitcnt lgkmcnt(0)
    s_nop 0
    v_mfma_f32_32x32x16_bf16 v[40:55], v[12:15], v[4:7], v[128:143]
    v_max3_f32 v230, v56, v57, v58
    v_max3_f32 v230, v230, v59, v60
    v_max3_f32 v230, v230, v61, v62
    v_max3_f32 v230, v230, v63, v64
    v_max3_f32 v230, v230, v65, v66
    v_max3_f32 v230, v230, v67, v68
    v_max3_f32 v230, v230, v69, v70
    v_max_f32 v230, v230, v71
    v_mov_b32 v231, v230
    s_nop 1
    v_permlane32_swap_b32 v230, v231
    s_nop 1
    v_max_f32 v230, v230, v231
    v_sub_f32 v144, 0, v230
    v_sub_f32 v145, 0, v230
    v_sub_f32 v146, 0, v230
    v_sub_f32 v147, 0, v230
    v_sub_f32 v148, 0, v230
    v_sub_f32 v149, 0, v230
    v_sub_f32 v150, 0, v230
    v_sub_f32 v151, 0, v230
    v_sub_f32 v152, 0, v230
    v_sub_f32 v153, 0, v230
    v_sub_f32 v154, 0, v230
    v_sub_f32 v155, 0, v230
    v_sub_f32 v156, 0, v230
    v_sub_f32 v157, 0, v230
    v_sub_f32 v158, 0, v230
    v_sub_f32 v159, 0, v230
    s_cmp_eq_u32 s48, 0
    s_cbranch_scc0 parallel_sum__grouped_kv_mqa__mixer_gmlp__prompt_kernel_a2_za
    v_lshlrev_b32 v236, 10, v3
    s_lshl_b32 s62, s47, 7
    s_add_u32 s62, s62, 15466500
    v_add_u32 v236, s62, v236
    buffer_load_dword v237, v236, s[4:7], 0 offen sc1
parallel_sum__grouped_kv_mqa__mixer_gmlp__prompt_kernel_a2_za:
    s_add_u32 m0, s57, s59
    s_mov_b64 exec, s[52:53]
    buffer_load_dwordx4 v114, s[4:7], s55 offen sc1 lds
    s_mov_b64 exec, -1
    s_add_u32 s55, s55, 2048
    s_mov_b32 s54, 384
    s_add_u32 m0, s57, s58
    s_nop 0
    buffer_load_dwordx4 v113, s[20:23], s54 offen lds
    s_add_u32 s54, s54, 128
    s_add_u32 s57, s57, 12288
    s_cmp_eq_u32 s57, 98304
    s_cselect_b32 s57, 0, s57
    s_add_u32 m0, s57, s59
    s_mov_b64 exec, s[52:53]
    buffer_load_dwordx4 v114, s[4:7], s55 offen sc1 lds
    s_mov_b64 exec, -1
    s_add_u32 s55, s55, 2048
    s_mov_b32 s54, 512
    s_add_u32 m0, s57, s58
    s_nop 0
    buffer_load_dwordx4 v113, s[20:23], s54 offen lds
    s_add_u32 s54, s54, 128
    s_add_u32 s57, s57, 12288
    s_cmp_eq_u32 s57, 98304
    s_cselect_b32 s57, 0, s57
    s_add_u32 m0, s57, s59
    s_mov_b64 exec, s[52:53]
    buffer_load_dwordx4 v114, s[4:7], s55 offen sc1 lds
    s_mov_b64 exec, -1
    s_add_u32 s55, s55, 2048
    s_mov_b32 s54, 640
    s_add_u32 m0, s57, s58
    s_nop 0
    buffer_load_dwordx4 v113, s[20:23], s54 offen lds
    s_add_u32 s54, s54, 128
    s_add_u32 s57, s57, 12288
    s_cmp_eq_u32 s57, 98304
    s_cselect_b32 s57, 0, s57
    s_mov_b32 s71, 3184710632
    v_mul_f32 v232, v80, v80
    v_mul_f32 v233, v81, v81
    v_mul_f32 v234, v82, v82
    v_mul_f32 v235, v83, v83
    v_fma_f32 v232, v232, s71, v112
    v_fma_f32 v233, v233, s71, v112
    v_fma_f32 v234, v234, s71, v112
    v_fma_f32 v235, v235, s71, v112
    v_mul_f32 v232, v232, v80
    v_mul_f32 v233, v233, v81
    v_mul_f32 v234, v234, v82
    v_mul_f32 v235, v235, v83
    v_exp_f32 v232, v232
    v_exp_f32 v233, v233
    v_exp_f32 v234, v234
    v_exp_f32 v235, v235
    v_add_f32 v232, 1.0, v232
    v_add_f32 v233, 1.0, v233
    v_add_f32 v234, 1.0, v234
    v_add_f32 v235, 1.0, v235
    v_rcp_f32 v232, v232
    v_rcp_f32 v233, v233
    v_rcp_f32 v234, v234
    v_rcp_f32 v235, v235
    v_mul_f32 v80, v80, v232
    v_mul_f32 v81, v81, v233
    v_mul_f32 v82, v82, v234
    v_mul_f32 v83, v83, v235
    v_mul_f32 v232, v84, v84
    v_mul_f32 v233, v85, v85
    v_mul_f32 v234, v86, v86
    v_mul_f32 v235, v87, v87
    v_fma_f32 v232, v232, s71, v112
    v_fma_f32 v233, v233, s71, v112
    v_fma_f32 v234, v234, s71, v112
    v_fma_f32 v235, v235, s71, v112
    v_mul_f32 v232, v232, v84
    v_mul_f32 v233, v233, v85
    v_mul_f32 v234, v234, v86
    v_mul_f32 v235, v235, v87
    v_exp_f32 v232, v232
    v_exp_f32 v233, v233
    v_exp_f32 v234, v234
    v_exp_f32 v235, v235
    v_add_f32 v232, 1.0, v232
    v_add_f32 v233, 1.0, v233
    v_add_f32 v234, 1.0, v234
    v_add_f32 v235, 1.0, v235
    v_rcp_f32 v232, v232
    v_rcp_f32 v233, v233
    v_rcp_f32 v234, v234
    v_rcp_f32 v235, v235
    v_mul_f32 v84, v84, v232
    v_mul_f32 v85, v85, v233
    v_mul_f32 v86, v86, v234
    v_mul_f32 v87, v87, v235
    v_mul_f32 v232, v88, v88
    v_mul_f32 v233, v89, v89
    v_mul_f32 v234, v90, v90
    v_mul_f32 v235, v91, v91
    v_fma_f32 v232, v232, s71, v112
    v_fma_f32 v233, v233, s71, v112
    v_fma_f32 v234, v234, s71, v112
    v_fma_f32 v235, v235, s71, v112
    v_mul_f32 v232, v232, v88
    v_mul_f32 v233, v233, v89
    v_mul_f32 v234, v234, v90
    v_mul_f32 v235, v235, v91
    v_exp_f32 v232, v232
    v_exp_f32 v233, v233
    v_exp_f32 v234, v234
    v_exp_f32 v235, v235
    v_add_f32 v232, 1.0, v232
    v_add_f32 v233, 1.0, v233
    v_add_f32 v234, 1.0, v234
    v_add_f32 v235, 1.0, v235
    v_rcp_f32 v232, v232
    v_rcp_f32 v233, v233
    v_rcp_f32 v234, v234
    v_rcp_f32 v235, v235
    v_mul_f32 v88, v88, v232
    v_mul_f32 v89, v89, v233
    v_mul_f32 v90, v90, v234
    v_mul_f32 v91, v91, v235
    v_mul_f32 v232, v92, v92
    v_mul_f32 v233, v93, v93
    v_mul_f32 v234, v94, v94
    v_mul_f32 v235, v95, v95
    v_fma_f32 v232, v232, s71, v112
    v_fma_f32 v233, v233, s71, v112
    v_fma_f32 v234, v234, s71, v112
    v_fma_f32 v235, v235, s71, v112
    v_mul_f32 v232, v232, v92
    v_mul_f32 v233, v233, v93
    v_mul_f32 v234, v234, v94
    v_mul_f32 v235, v235, v95
    v_exp_f32 v232, v232
    v_exp_f32 v233, v233
    v_exp_f32 v234, v234
    v_exp_f32 v235, v235
    v_add_f32 v232, 1.0, v232
    v_add_f32 v233, 1.0, v233
    v_add_f32 v234, 1.0, v234
    v_add_f32 v235, 1.0, v235
    v_rcp_f32 v232, v232
    v_rcp_f32 v233, v233
    v_rcp_f32 v234, v234
    v_rcp_f32 v235, v235
    v_mul_f32 v92, v92, v232
    v_mul_f32 v93, v93, v233
    v_mul_f32 v94, v94, v234
    v_mul_f32 v95, v95, v235
    v_cvt_pk_bf16_f32 v120, v80, v81
    v_cvt_pk_bf16_f32 v121, v82, v83
    v_cvt_pk_bf16_f32 v122, v84, v85
    v_cvt_pk_bf16_f32 v123, v86, v87
    v_cvt_pk_bf16_f32 v124, v88, v89
    v_cvt_pk_bf16_f32 v125, v90, v91
    v_cvt_pk_bf16_f32 v126, v92, v93
    v_cvt_pk_bf16_f32 v127, v94, v95
    s_cmp_eq_u32 s48, 0
    s_cbranch_scc0 parallel_sum__grouped_kv_mqa__mixer_gmlp__prompt_kernel_a2_pw
    v_lshlrev_b32 v224, 10, v3
    s_lshl_b32 s62, s47, 7
    s_add_u32 s62, s62, 15466500
    v_add_u32 v224, s62, v224
    s_waitcnt vmcnt(6)
    v_cmp_ne_u32 vcc, 0, v237
    s_nop 1
    s_cmp_eq_u64 vcc, exec
    s_cbranch_scc1 parallel_sum__grouped_kv_mqa__mixer_gmlp__prompt_kernel_a2_pw
    s_mov_b32 s63, 0
    s_mov_b64 s[64:65], -1
parallel_sum__grouped_kv_mqa__mixer_gmlp__prompt_kernel_a2_z_poll:
    buffer_load_dword v225, v224, s[4:7], 0 offen sc1
    s_waitcnt vmcnt(0)
    v_cmp_ne_u32 vcc, 0, v225
    s_nop 1
    s_and_b64 vcc, vcc, s[64:65]
    s_cmp_eq_u64 vcc, s[64:65]
    s_cbranch_scc1 parallel_sum__grouped_kv_mqa__mixer_gmlp__prompt_kernel_a2_z_done
    s_add_u32 s63, s63, 1
    s_cmp_lt_u32 s63, 100000
    s_cbranch_scc1 parallel_sum__grouped_kv_mqa__mixer_gmlp__prompt_kernel_a2_z_poll
parallel_sum__grouped_kv_mqa__mixer_gmlp__prompt_kernel_a2_z_done:
parallel_sum__grouped_kv_mqa__mixer_gmlp__prompt_kernel_a2_pw:
    s_barrier
    buffer_load_dwordx4 v[192:195], v115, s[4:7], s56 offen sc1
    buffer_load_dwordx4 v[196:199], v115, s[4:7], s56 offen offset:1024 sc1
    s_add_u32 s56, s56, 4096
    buffer_load_dwordx4 v[200:203], v115, s[4:7], s56 offen sc1
    buffer_load_dwordx4 v[204:207], v115, s[4:7], s56 offen offset:1024 sc1
    s_add_u32 s56, s56, 4096
    buffer_load_dwordx4 v[208:211], v115, s[4:7], s56 offen sc1
    buffer_load_dwordx4 v[212:215], v115, s[4:7], s56 offen offset:1024 sc1
    s_add_u32 s56, s56, 4096
    buffer_load_dwordx4 v[216:219], v115, s[4:7], s56 offen sc1
    buffer_load_dwordx4 v[220:223], v115, s[4:7], s56 offen offset:1024 sc1
    s_add_u32 s56, s56, 4096
    s_waitcnt vmcnt(18)
    s_barrier
    v_mfma_f32_32x32x16_bf16 v[56:71], v[12:15], v[8:11], v[144:159]
    v_exp_f32 v40, v40
    ds_read_b128 v[12:15], v116 offset:0
    v_exp_f32 v41, v41
    ds_read_b128 v[32:35], v118 offset:0
    v_exp_f32 v42, v42
    s_add_u32 m0, s57, s58
    v_exp_f32 v43, v43
    buffer_load_dwordx4 v113, s[20:23], s54 offen lds
    s_add_u32 s54, s54, 128
    s_add_u32 m0, s57, s59
    v_exp_f32 v44, v44
    s_mov_b64 exec, s[52:53]
    ds_read_b128 v[20:23], v117 offset:1024
    buffer_load_dwordx4 v114, s[4:7], s55 offen sc1 lds
    s_mov_b64 exec, -1
    v_exp_f32 v45, v45
    s_add_u32 s55, s55, 2048
    s_add_u32 s57, s57, 12288
    s_cmp_eq_u32 s57, 98304
    s_cselect_b32 s57, 0, s57
    v_cvt_pk_bf16_f32 v24, v40, v41
    v_cvt_pk_bf16_f32 v25, v42, v43
    ds_read_b128 v[36:39], v118 offset:4096
    v_exp_f32 v46, v46
    s_waitcnt vmcnt(9) lgkmcnt(2)
    v_mfma_f32_32x32x16_bf16 v[160:175], v[192:195], v[32:35], 0
    v_exp_f32 v47, v47
    ds_read_b128 v[32:35], v119 offset:0
    v_cvt_pk_bf16_f32 v26, v44, v45
    v_cvt_pk_bf16_f32 v27, v46, v47
    v_exp_f32 v48, v48
    v_exp_f32 v49, v49
    v_mfma_f32_32x32x16_bf16 v[72:87], v[16:19], v[24:27], 0
    v_exp_f32 v50, v50
    v_exp_f32 v51, v51
    v_cvt_pk_bf16_f32 v28, v48, v49
    v_cvt_pk_bf16_f32 v29, v50, v51
    v_exp_f32 v52, v52
    s_waitcnt lgkmcnt(1)
    v_mfma_f32_32x32x16_bf16 v[176:191], v[192:195], v[36:39], 0
    v_exp_f32 v53, v53
    buffer_load_dwordx4 v[192:195], v115, s[4:7], s56 offen offset:0 sc1
    v_exp_f32 v54, v54
    ds_read_b128 v[36:39], v119 offset:4096
    v_exp_f32 v55, v55
    v_cvt_pk_bf16_f32 v30, v52, v53
    v_cvt_pk_bf16_f32 v31, v54, v55
    v_mfma_f32_32x32x16_bf16 v[40:55], v[12:15], v[4:7], v[128:143]
    v_exp_f32 v56, v56
    v_exp_f32 v57, v57
    v_exp_f32 v58, v58
    v_exp_f32 v59, v59
    v_mfma_f32_32x32x16_bf16 v[72:87], v[20:23], v[28:31], v[72:87]
    v_exp_f32 v60, v60
    v_exp_f32 v61, v61
    v_cvt_pk_bf16_f32 v24, v56, v57
    v_cvt_pk_bf16_f32 v25, v58, v59
    v_exp_f32 v62, v62
    s_waitcnt vmcnt(9) lgkmcnt(1)
    v_mfma_f32_32x32x16_bf16 v[160:175], v[196:199], v[32:35], v[160:175]
    v_exp_f32 v63, v63
    v_cvt_pk_bf16_f32 v26, v60, v61
    v_cvt_pk_bf16_f32 v27, v62, v63
    v_exp_f32 v64, v64
    v_exp_f32 v65, v65
    v_mfma_f32_32x32x16_bf16 v[88:103], v[16:19], v[24:27], 0
    v_exp_f32 v66, v66
    s_mov_b64 exec, s[52:53]
    ds_read_b128 v[16:19], v117 offset:0
    s_mov_b64 exec, -1
    v_exp_f32 v67, v67
    v_cvt_pk_bf16_f32 v28, v64, v65
    v_cvt_pk_bf16_f32 v29, v66, v67
    v_exp_f32 v68, v68
    s_waitcnt lgkmcnt(1)
    v_mfma_f32_32x32x16_bf16 v[176:191], v[196:199], v[36:39], v[176:191]
    v_exp_f32 v69, v69
    buffer_load_dwordx4 v[196:199], v115, s[4:7], s56 offen offset:1024 sc1
    s_add_u32 s56, s56, 4096
    v_exp_f32 v70, v70
    v_exp_f32 v71, v71
    v_cvt_pk_bf16_f32 v30, v68, v69
    v_cvt_pk_bf16_f32 v31, v70, v71
    s_barrier
    v_mfma_f32_32x32x16_bf16 v[56:71], v[12:15], v[8:11], v[144:159]
    v_exp_f32 v40, v40
    ds_read_b128 v[12:15], v116 offset:12288
    v_exp_f32 v41, v41
    ds_read_b128 v[32:35], v118 offset:12288
    v_exp_f32 v42, v42
    s_add_u32 m0, s57, s58
    v_exp_f32 v43, v43
    buffer_load_dwordx4 v113, s[20:23], s54 offen lds
    s_add_u32 s54, s54, 128
    v_mfma_f32_32x32x16_bf16 v[88:103], v[20:23], v[28:31], v[88:103]
    s_add_u32 m0, s57, s59
    v_exp_f32 v44, v44
    s_mov_b64 exec, s[52:53]
    ds_read_b128 v[20:23], v117 offset:13312
    buffer_load_dwordx4 v114, s[4:7], s55 offen sc1 lds
    s_mov_b64 exec, -1
    v_exp_f32 v45, v45
    s_add_u32 s55, s55, 2048
    s_add_u32 s57, s57, 12288
    s_cmp_eq_u32 s57, 98304
    s_cselect_b32 s57, 0, s57
    v_cvt_pk_bf16_f32 v24, v40, v41
    v_cvt_pk_bf16_f32 v25, v42, v43
    ds_read_b128 v[36:39], v118 offset:16384
    v_exp_f32 v46, v46
    s_waitcnt vmcnt(11) lgkmcnt(2)
    v_mfma_f32_32x32x16_bf16 v[160:175], v[200:203], v[32:35], v[160:175]
    v_exp_f32 v47, v47
    ds_read_b128 v[32:35], v119 offset:12288
    v_cvt_pk_bf16_f32 v26, v44, v45
    v_cvt_pk_bf16_f32 v27, v46, v47
    v_exp_f32 v48, v48
    v_exp_f32 v49, v49
    v_mfma_f32_32x32x16_bf16 v[72:87], v[16:19], v[24:27], v[72:87]
    v_exp_f32 v50, v50
    v_exp_f32 v51, v51
    v_cvt_pk_bf16_f32 v28, v48, v49
    v_cvt_pk_bf16_f32 v29, v50, v51
    v_exp_f32 v52, v52
    s_waitcnt lgkmcnt(1)
    v_mfma_f32_32x32x16_bf16 v[176:191], v[200:203], v[36:39], v[176:191]
    v_exp_f32 v53, v53
    buffer_load_dwordx4 v[200:203], v115, s[4:7], s56 offen offset:0 sc1
    v_exp_f32 v54, v54
    ds_read_b128 v[36:39], v119 offset:16384
    v_exp_f32 v55, v55
    v_cvt_pk_bf16_f32 v30, v52, v53
    v_cvt_pk_bf16_f32 v31, v54, v55
    v_mfma_f32_32x32x16_bf16 v[40:55], v[12:15], v[4:7], v[128:143]
    v_exp_f32 v56, v56
    v_exp_f32 v57, v57
    v_exp_f32 v58, v58
    v_exp_f32 v59, v59
    v_mfma_f32_32x32x16_bf16 v[72:87], v[20:23], v[28:31], v[72:87]
    v_exp_f32 v60, v60
    v_exp_f32 v61, v61
    v_cvt_pk_bf16_f32 v24, v56, v57
    v_cvt_pk_bf16_f32 v25, v58, v59
    v_exp_f32 v62, v62
    s_waitcnt vmcnt(11) lgkmcnt(1)
    v_mfma_f32_32x32x16_bf16 v[160:175], v[204:207], v[32:35], v[160:175]
    v_exp_f32 v63, v63
    v_cvt_pk_bf16_f32 v26, v60, v61
    v_cvt_pk_bf16_f32 v27, v62, v63
    v_exp_f32 v64, v64
    v_exp_f32 v65, v65
    v_mfma_f32_32x32x16_bf16 v[88:103], v[16:19], v[24:27], v[88:103]
    v_exp_f32 v66, v66
    s_mov_b64 exec, s[52:53]
    ds_read_b128 v[16:19], v117 offset:12288
    s_mov_b64 exec, -1
    v_exp_f32 v67, v67
    v_cvt_pk_bf16_f32 v28, v64, v65
    v_cvt_pk_bf16_f32 v29, v66, v67
    v_exp_f32 v68, v68
    s_waitcnt lgkmcnt(1)
    v_mfma_f32_32x32x16_bf16 v[176:191], v[204:207], v[36:39], v[176:191]
    v_exp_f32 v69, v69
    buffer_load_dwordx4 v[204:207], v115, s[4:7], s56 offen offset:1024 sc1
    s_add_u32 s56, s56, 4096
    v_exp_f32 v70, v70
    v_exp_f32 v71, v71
    v_cvt_pk_bf16_f32 v30, v68, v69
    v_cvt_pk_bf16_f32 v31, v70, v71
    s_barrier
    v_mfma_f32_32x32x16_bf16 v[56:71], v[12:15], v[8:11], v[144:159]
    v_exp_f32 v40, v40
    ds_read_b128 v[12:15], v116 offset:24576
    v_exp_f32 v41, v41
    ds_read_b128 v[32:35], v118 offset:24576
    v_exp_f32 v42, v42
    s_add_u32 m0, s57, s58
    v_exp_f32 v43, v43
    buffer_load_dwordx4 v113, s[20:23], s54 offen lds
    s_add_u32 s54, s54, 128
    v_mfma_f32_32x32x16_bf16 v[88:103], v[20:23], v[28:31], v[88:103]
    s_add_u32 m0, s57, s59
    v_exp_f32 v44, v44
    s_mov_b64 exec, s[52:53]
    ds_read_b128 v[20:23], v117 offset:25600
    buffer_load_dwordx4 v114, s[4:7], s55 offen sc1 lds
    s_mov_b64 exec, -1
    v_exp_f32 v45, v45
    s_add_u32 s55, s55, 2048
    s_add_u32 s57, s57, 12288
    s_cmp_eq_u32 s57, 98304
    s_cselect_b32 s57, 0, s57
    v_cvt_pk_bf16_f32 v24, v40, v41
    v_cvt_pk_bf16_f32 v25, v42, v43
    ds_read_b128 v[36:39], v118 offset:28672
    v_exp_f32 v46, v46
    s_waitcnt vmcnt(13) lgkmcnt(2)
    v_mfma_f32_32x32x16_bf16 v[160:175], v[208:211], v[32:35], v[160:175]
    v_exp_f32 v47, v47
    ds_read_b128 v[32:35], v119 offset:24576
    v_cvt_pk_bf16_f32 v26, v44, v45
    v_cvt_pk_bf16_f32 v27, v46, v47
    v_exp_f32 v48, v48
    v_exp_f32 v49, v49
    v_mfma_f32_32x32x16_bf16 v[72:87], v[16:19], v[24:27], v[72:87]
    v_exp_f32 v50, v50
    v_exp_f32 v51, v51
    v_cvt_pk_bf16_f32 v28, v48, v49
    v_cvt_pk_bf16_f32 v29, v50, v51
    v_exp_f32 v52, v52
    s_waitcnt lgkmcnt(1)
    v_mfma_f32_32x32x16_bf16 v[176:191], v[208:211], v[36:39], v[176:191]
    v_exp_f32 v53, v53
    buffer_load_dwordx4 v[208:211], v115, s[4:7], s56 offen offset:0 sc1
    v_exp_f32 v54, v54
    ds_read_b128 v[36:39], v119 offset:28672
    v_exp_f32 v55, v55
    v_cvt_pk_bf16_f32 v30, v52, v53
    v_cvt_pk_bf16_f32 v31, v54, v55
    v_mfma_f32_32x32x16_bf16 v[40:55], v[12:15], v[4:7], v[128:143]
    v_exp_f32 v56, v56
    v_exp_f32 v57, v57
    v_exp_f32 v58, v58
    v_exp_f32 v59, v59
    v_mfma_f32_32x32x16_bf16 v[72:87], v[20:23], v[28:31], v[72:87]
    v_exp_f32 v60, v60
    v_exp_f32 v61, v61
    v_cvt_pk_bf16_f32 v24, v56, v57
    v_cvt_pk_bf16_f32 v25, v58, v59
    v_exp_f32 v62, v62
    s_waitcnt vmcnt(13) lgkmcnt(1)
    v_mfma_f32_32x32x16_bf16 v[160:175], v[212:215], v[32:35], v[160:175]
    v_exp_f32 v63, v63
    v_cvt_pk_bf16_f32 v26, v60, v61
    v_cvt_pk_bf16_f32 v27, v62, v63
    v_exp_f32 v64, v64
    v_exp_f32 v65, v65
    v_mfma_f32_32x32x16_bf16 v[88:103], v[16:19], v[24:27], v[88:103]
    v_exp_f32 v66, v66
    s_mov_b64 exec, s[52:53]
    ds_read_b128 v[16:19], v117 offset:24576
    s_mov_b64 exec, -1
    v_exp_f32 v67, v67
    v_cvt_pk_bf16_f32 v28, v64, v65
    v_cvt_pk_bf16_f32 v29, v66, v67
    v_exp_f32 v68, v68
    s_waitcnt lgkmcnt(1)
    v_mfma_f32_32x32x16_bf16 v[176:191], v[212:215], v[36:39], v[176:191]
    v_exp_f32 v69, v69
    buffer_load_dwordx4 v[212:215], v115, s[4:7], s56 offen offset:1024 sc1
    s_add_u32 s56, s56, 4096
    v_exp_f32 v70, v70
    v_exp_f32 v71, v71
    v_cvt_pk_bf16_f32 v30, v68, v69
    v_cvt_pk_bf16_f32 v31, v70, v71
    s_barrier
    v_mfma_f32_32x32x16_bf16 v[56:71], v[12:15], v[8:11], v[144:159]
    v_exp_f32 v40, v40
    ds_read_b128 v[12:15], v116 offset:36864
    v_exp_f32 v41, v41
    ds_read_b128 v[32:35], v118 offset:36864
    v_exp_f32 v42, v42
    s_add_u32 m0, s57, s58
    v_exp_f32 v43, v43
    buffer_load_dwordx4 v113, s[20:23], s54 offen lds
    s_add_u32 s54, s54, 128
    v_mfma_f32_32x32x16_bf16 v[88:103], v[20:23], v[28:31], v[88:103]
    s_add_u32 m0, s57, s59
    v_exp_f32 v44, v44
    s_mov_b64 exec, s[52:53]
    ds_read_b128 v[20:23], v117 offset:37888
    buffer_load_dwordx4 v114, s[4:7], s55 offen sc1 lds
    s_mov_b64 exec, -1
    v_exp_f32 v45, v45
    s_add_u32 s55, s55, 2048
    s_add_u32 s57, s57, 12288
    s_cmp_eq_u32 s57, 98304
    s_cselect_b32 s57, 0, s57
    v_cvt_pk_bf16_f32 v24, v40, v41
    v_cvt_pk_bf16_f32 v25, v42, v43
    ds_read_b128 v[36:39], v118 offset:40960
    v_exp_f32 v46, v46
    s_waitcnt vmcnt(15) lgkmcnt(2)
    v_mfma_f32_32x32x16_bf16 v[160:175], v[216:219], v[32:35], v[160:175]
    v_exp_f32 v47, v47
    ds_read_b128 v[32:35], v119 offset:36864
    v_cvt_pk_bf16_f32 v26, v44, v45
    v_cvt_pk_bf16_f32 v27, v46, v47
    v_exp_f32 v48, v48
    v_exp_f32 v49, v49
    v_mfma_f32_32x32x16_bf16 v[72:87], v[16:19], v[24:27], v[72:87]
    v_exp_f32 v50, v50
    v_exp_f32 v51, v51
    v_cvt_pk_bf16_f32 v28, v48, v49
    v_cvt_pk_bf16_f32 v29, v50, v51
    v_exp_f32 v52, v52
    s_waitcnt lgkmcnt(1)
    v_mfma_f32_32x32x16_bf16 v[176:191], v[216:219], v[36:39], v[176:191]
    v_exp_f32 v53, v53
    buffer_load_dwordx4 v[216:219], v115, s[4:7], s56 offen offset:0 sc1
    v_exp_f32 v54, v54
    ds_read_b128 v[36:39], v119 offset:40960
    v_exp_f32 v55, v55
    v_cvt_pk_bf16_f32 v30, v52, v53
    v_cvt_pk_bf16_f32 v31, v54, v55
    v_mfma_f32_32x32x16_bf16 v[40:55], v[12:15], v[4:7], v[128:143]
    v_exp_f32 v56, v56
    v_exp_f32 v57, v57
    v_exp_f32 v58, v58
    v_exp_f32 v59, v59
    v_mfma_f32_32x32x16_bf16 v[72:87], v[20:23], v[28:31], v[72:87]
    v_exp_f32 v60, v60
    v_exp_f32 v61, v61
    v_cvt_pk_bf16_f32 v24, v56, v57
    v_cvt_pk_bf16_f32 v25, v58, v59
    v_exp_f32 v62, v62
    s_waitcnt vmcnt(15) lgkmcnt(1)
    v_mfma_f32_32x32x16_bf16 v[160:175], v[220:223], v[32:35], v[160:175]
    v_exp_f32 v63, v63
    v_cvt_pk_bf16_f32 v26, v60, v61
    v_cvt_pk_bf16_f32 v27, v62, v63
    v_exp_f32 v64, v64
    v_exp_f32 v65, v65
    v_mfma_f32_32x32x16_bf16 v[88:103], v[16:19], v[24:27], v[88:103]
    v_exp_f32 v66, v66
    s_mov_b64 exec, s[52:53]
    ds_read_b128 v[16:19], v117 offset:36864
    s_mov_b64 exec, -1
    v_exp_f32 v67, v67
    v_cvt_pk_bf16_f32 v28, v64, v65
    v_cvt_pk_bf16_f32 v29, v66, v67
    v_exp_f32 v68, v68
    s_waitcnt lgkmcnt(1)
    v_mfma_f32_32x32x16_bf16 v[176:191], v[220:223], v[36:39], v[176:191]
    v_exp_f32 v69, v69
    buffer_load_dwordx4 v[220:223], v115, s[4:7], s56 offen offset:1024 sc1
    s_add_u32 s56, s56, 4096
    v_exp_f32 v70, v70
    v_exp_f32 v71, v71
    v_cvt_pk_bf16_f32 v30, v68, v69
    v_cvt_pk_bf16_f32 v31, v70, v71
    s_waitcnt lgkmcnt(0)
    v_add_u32 v116, s60, v116
    v_add_u32 v117, s60, v117
    v_add_u32 v118, s60, v118
    v_add_u32 v119, s60, v119
    s_sub_u32 s60, 0, s60
    s_mov_b32 s61, 5
parallel_sum__grouped_kv_mqa__mixer_gmlp__prompt_kernel_a2_loop:
    s_barrier
    v_mfma_f32_32x32x16_bf16 v[56:71], v[12:15], v[8:11], v[144:159]
    v_exp_f32 v40, v40
    ds_read_b128 v[12:15], v116 offset:0
    v_exp_f32 v41, v41
    ds_read_b128 v[32:35], v118 offset:0
    v_exp_f32 v42, v42
    s_add_u32 m0, s57, s58
    v_exp_f32 v43, v43
    buffer_load_dwordx4 v113, s[20:23], s54 offen lds
    s_add_u32 s54, s54, 128
    v_mfma_f32_32x32x16_bf16 v[88:103], v[20:23], v[28:31], v[88:103]
    s_add_u32 m0, s57, s59
    v_exp_f32 v44, v44
    s_mov_b64 exec, s[52:53]
    ds_read_b128 v[20:23], v117 offset:1024
    buffer_load_dwordx4 v114, s[4:7], s55 offen sc1 lds
    s_mov_b64 exec, -1
    v_exp_f32 v45, v45
    s_add_u32 s55, s55, 2048
    s_add_u32 s57, s57, 12288
    s_cmp_eq_u32 s57, 98304
    s_cselect_b32 s57, 0, s57
    v_cvt_pk_bf16_f32 v24, v40, v41
    v_cvt_pk_bf16_f32 v25, v42, v43
    ds_read_b128 v[36:39], v118 offset:4096
    v_exp_f32 v46, v46
    s_waitcnt vmcnt(15) lgkmcnt(2)
    v_mfma_f32_32x32x16_bf16 v[160:175], v[192:195], v[32:35], v[160:175]
    v_exp_f32 v47, v47
    ds_read_b128 v[32:35], v119 offset:0
    v_cvt_pk_bf16_f32 v26, v44, v45
    v_cvt_pk_bf16_f32 v27, v46, v47
    v_exp_f32 v48, v48
    v_exp_f32 v49, v49
    v_mfma_f32_32x32x16_bf16 v[72:87], v[16:19], v[24:27], v[72:87]
    v_exp_f32 v50, v50
    v_exp_f32 v51, v51
    v_cvt_pk_bf16_f32 v28, v48, v49
    v_cvt_pk_bf16_f32 v29, v50, v51
    v_exp_f32 v52, v52
    s_waitcnt lgkmcnt(1)
    v_mfma_f32_32x32x16_bf16 v[176:191], v[192:195], v[36:39], v[176:191]
    v_exp_f32 v53, v53
    buffer_load_dwordx4 v[192:195], v115, s[4:7], s56 offen offset:0 sc1
    v_exp_f32 v54, v54
    ds_read_b128 v[36:39], v119 offset:4096
    v_exp_f32 v55, v55
    v_cvt_pk_bf16_f32 v30, v52, v53
    v_cvt_pk_bf16_f32 v31, v54, v55
    v_mfma_f32_32x32x16_bf16 v[40:55], v[12:15], v[4:7], v[128:143]
    v_exp_f32 v56, v56
    v_exp_f32 v57, v57
    v_exp_f32 v58, v58
    v_exp_f32 v59, v59
    v_mfma_f32_32x32x16_bf16 v[72:87], v[20:23], v[28:31], v[72:87]
    v_exp_f32 v60, v60
    v_exp_f32 v61, v61
    v_cvt_pk_bf16_f32 v24, v56, v57
    v_cvt_pk_bf16_f32 v25, v58, v59
    v_exp_f32 v62, v62
    s_waitcnt vmcnt(15) lgkmcnt(1)
    v_mfma_f32_32x32x16_bf16 v[160:175], v[196:199], v[32:35], v[160:175]
    v_exp_f32 v63, v63
    v_cvt_pk_bf16_f32 v26, v60, v61
    v_cvt_pk_bf16_f32 v27, v62, v63
    v_exp_f32 v64, v64
    v_exp_f32 v65, v65
    v_mfma_f32_32x32x16_bf16 v[88:103], v[16:19], v[24:27], v[88:103]
    v_exp_f32 v66, v66
    s_mov_b64 exec, s[52:53]
    ds_read_b128 v[16:19], v117 offset:0
    s_mov_b64 exec, -1
    v_exp_f32 v67, v67
    v_cvt_pk_bf16_f32 v28, v64, v65
    v_cvt_pk_bf16_f32 v29, v66, v67
    v_exp_f32 v68, v68
    s_waitcnt lgkmcnt(1)
    v_mfma_f32_32x32x16_bf16 v[176:191], v[196:199], v[36:39], v[176:191]
    v_exp_f32 v69, v69
    buffer_load_dwordx4 v[196:199], v115, s[4:7], s56 offen offset:1024 sc1
    s_add_u32 s56, s56, 4096
    v_exp_f32 v70, v70
    v_exp_f32 v71, v71
    v_cvt_pk_bf16_f32 v30, v68, v69
    v_cvt_pk_bf16_f32 v31, v70, v71
    v_mfma_f32_32x32x16_bf16 v[56:71], v[12:15], v[8:11], v[144:159]
    v_exp_f32 v40, v40
    ds_read_b128 v[12:15], v116 offset:12288
    v_exp_f32 v41, v41
    ds_read_b128 v[32:35], v118 offset:12288
    v_exp_f32 v42, v42
    s_add_u32 m0, s57, s58
    v_exp_f32 v43, v43
    buffer_load_dwordx4 v113, s[20:23], s54 offen lds
    s_add_u32 s54, s54, 128
    v_mfma_f32_32x32x16_bf16 v[88:103], v[20:23], v[28:31], v[88:103]
    s_add_u32 m0, s57, s59
    v_exp_f32 v44, v44
    s_mov_b64 exec, s[52:53]
    ds_read_b128 v[20:23], v117 offset:13312
    buffer_load_dwordx4 v114, s[4:7], s55 offen sc1 lds
    s_mov_b64 exec, -1
    v_exp_f32 v45, v45
    s_add_u32 s55, s55, 2048
    s_add_u32 s57, s57, 12288
    s_cmp_eq_u32 s57, 98304
    s_cselect_b32 s57, 0, s57
    v_cvt_pk_bf16_f32 v24, v40, v41
    v_cvt_pk_bf16_f32 v25, v42, v43
    ds_read_b128 v[36:39], v118 offset:16384
    v_exp_f32 v46, v46
    s_waitcnt vmcnt(15) lgkmcnt(2)
    v_mfma_f32_32x32x16_bf16 v[160:175], v[200:203], v[32:35], v[160:175]
    v_exp_f32 v47, v47
    ds_read_b128 v[32:35], v119 offset:12288
    v_cvt_pk_bf16_f32 v26, v44, v45
    v_cvt_pk_bf16_f32 v27, v46, v47
    v_exp_f32 v48, v48
    v_exp_f32 v49, v49
    v_mfma_f32_32x32x16_bf16 v[72:87], v[16:19], v[24:27], v[72:87]
    v_exp_f32 v50, v50
    v_exp_f32 v51, v51
    v_cvt_pk_bf16_f32 v28, v48, v49
    v_cvt_pk_bf16_f32 v29, v50, v51
    v_exp_f32 v52, v52
    s_waitcnt lgkmcnt(1)
    v_mfma_f32_32x32x16_bf16 v[176:191], v[200:203], v[36:39], v[176:191]
    v_exp_f32 v53, v53
    buffer_load_dwordx4 v[200:203], v115, s[4:7], s56 offen offset:0 sc1
    v_exp_f32 v54, v54
    ds_read_b128 v[36:39], v119 offset:16384
    v_exp_f32 v55, v55
    v_cvt_pk_bf16_f32 v30, v52, v53
    v_cvt_pk_bf16_f32 v31, v54, v55
    v_mfma_f32_32x32x16_bf16 v[40:55], v[12:15], v[4:7], v[128:143]
    v_exp_f32 v56, v56
    v_exp_f32 v57, v57
    v_exp_f32 v58, v58
    v_exp_f32 v59, v59
    v_mfma_f32_32x32x16_bf16 v[72:87], v[20:23], v[28:31], v[72:87]
    v_exp_f32 v60, v60
    v_exp_f32 v61, v61
    v_cvt_pk_bf16_f32 v24, v56, v57
    v_cvt_pk_bf16_f32 v25, v58, v59
    v_exp_f32 v62, v62
    s_waitcnt vmcnt(15) lgkmcnt(1)
    v_mfma_f32_32x32x16_bf16 v[160:175], v[204:207], v[32:35], v[160:175]
    v_exp_f32 v63, v63
    v_cvt_pk_bf16_f32 v26, v60, v61
    v_cvt_pk_bf16_f32 v27, v62, v63
    v_exp_f32 v64, v64
    v_exp_f32 v65, v65
    v_mfma_f32_32x32x16_bf16 v[88:103], v[16:19], v[24:27], v[88:103]
    v_exp_f32 v66, v66
    s_mov_b64 exec, s[52:53]
    ds_read_b128 v[16:19], v117 offset:12288
    s_mov_b64 exec, -1
    v_exp_f32 v67, v67
    v_cvt_pk_bf16_f32 v28, v64, v65
    v_cvt_pk_bf16_f32 v29, v66, v67
    v_exp_f32 v68, v68
    s_waitcnt lgkmcnt(1)
    v_mfma_f32_32x32x16_bf16 v[176:191], v[204:207], v[36:39], v[176:191]
    v_exp_f32 v69, v69
    buffer_load_dwordx4 v[204:207], v115, s[4:7], s56 offen offset:1024 sc1
    s_add_u32 s56, s56, 4096
    v_exp_f32 v70, v70
    v_exp_f32 v71, v71
    v_cvt_pk_bf16_f32 v30, v68, v69
    v_cvt_pk_bf16_f32 v31, v70, v71
    s_waitcnt lgkmcnt(0)
    s_barrier
    v_mfma_f32_32x32x16_bf16 v[56:71], v[12:15], v[8:11], v[144:159]
    v_exp_f32 v40, v40
    ds_read_b128 v[12:15], v116 offset:24576
    v_exp_f32 v41, v41
    ds_read_b128 v[32:35], v118 offset:24576
    v_exp_f32 v42, v42
    s_add_u32 m0, s57, s58
    v_exp_f32 v43, v43
    buffer_load_dwordx4 v113, s[20:23], s54 offen lds
    s_add_u32 s54, s54, 128
    v_mfma_f32_32x32x16_bf16 v[88:103], v[20:23], v[28:31], v[88:103]
    s_add_u32 m0, s57, s59
    v_exp_f32 v44, v44
    s_mov_b64 exec, s[52:53]
    ds_read_b128 v[20:23], v117 offset:25600
    buffer_load_dwordx4 v114, s[4:7], s55 offen sc1 lds
    s_mov_b64 exec, -1
    v_exp_f32 v45, v45
    s_add_u32 s55, s55, 2048
    s_add_u32 s57, s57, 12288
    s_cmp_eq_u32 s57, 98304
    s_cselect_b32 s57, 0, s57
    v_cvt_pk_bf16_f32 v24, v40, v41
    v_cvt_pk_bf16_f32 v25, v42, v43
    ds_read_b128 v[36:39], v118 offset:28672
    v_exp_f32 v46, v46
    s_waitcnt vmcnt(15) lgkmcnt(2)
    v_mfma_f32_32x32x16_bf16 v[160:175], v[208:211], v[32:35], v[160:175]
    v_exp_f32 v47, v47
    ds_read_b128 v[32:35], v119 offset:24576
    v_cvt_pk_bf16_f32 v26, v44, v45
    v_cvt_pk_bf16_f32 v27, v46, v47
    v_exp_f32 v48, v48
    v_exp_f32 v49, v49
    v_mfma_f32_32x32x16_bf16 v[72:87], v[16:19], v[24:27], v[72:87]
    v_exp_f32 v50, v50
    v_exp_f32 v51, v51
    v_cvt_pk_bf16_f32 v28, v48, v49
    v_cvt_pk_bf16_f32 v29, v50, v51
    v_exp_f32 v52, v52
    s_waitcnt lgkmcnt(1)
    v_mfma_f32_32x32x16_bf16 v[176:191], v[208:211], v[36:39], v[176:191]
    v_exp_f32 v53, v53
    buffer_load_dwordx4 v[208:211], v115, s[4:7], s56 offen offset:0 sc1
    v_exp_f32 v54, v54
    ds_read_b128 v[36:39], v119 offset:28672
    v_exp_f32 v55, v55
    v_cvt_pk_bf16_f32 v30, v52, v53
    v_cvt_pk_bf16_f32 v31, v54, v55
    v_mfma_f32_32x32x16_bf16 v[40:55], v[12:15], v[4:7], v[128:143]
    v_exp_f32 v56, v56
    v_exp_f32 v57, v57
    v_exp_f32 v58, v58
    v_exp_f32 v59, v59
    v_mfma_f32_32x32x16_bf16 v[72:87], v[20:23], v[28:31], v[72:87]
    v_exp_f32 v60, v60
    v_exp_f32 v61, v61
    v_cvt_pk_bf16_f32 v24, v56, v57
    v_cvt_pk_bf16_f32 v25, v58, v59
    v_exp_f32 v62, v62
    s_waitcnt vmcnt(15) lgkmcnt(1)
    v_mfma_f32_32x32x16_bf16 v[160:175], v[212:215], v[32:35], v[160:175]
    v_exp_f32 v63, v63
    v_cvt_pk_bf16_f32 v26, v60, v61
    v_cvt_pk_bf16_f32 v27, v62, v63
    v_exp_f32 v64, v64
    v_exp_f32 v65, v65
    v_mfma_f32_32x32x16_bf16 v[88:103], v[16:19], v[24:27], v[88:103]
    v_exp_f32 v66, v66
    s_mov_b64 exec, s[52:53]
    ds_read_b128 v[16:19], v117 offset:24576
    s_mov_b64 exec, -1
    v_exp_f32 v67, v67
    v_cvt_pk_bf16_f32 v28, v64, v65
    v_cvt_pk_bf16_f32 v29, v66, v67
    v_exp_f32 v68, v68
    s_waitcnt lgkmcnt(1)
    v_mfma_f32_32x32x16_bf16 v[176:191], v[212:215], v[36:39], v[176:191]
    v_exp_f32 v69, v69
    buffer_load_dwordx4 v[212:215], v115, s[4:7], s56 offen offset:1024 sc1
    s_add_u32 s56, s56, 4096
    v_exp_f32 v70, v70
    v_exp_f32 v71, v71
    v_cvt_pk_bf16_f32 v30, v68, v69
    v_cvt_pk_bf16_f32 v31, v70, v71
    v_mfma_f32_32x32x16_bf16 v[56:71], v[12:15], v[8:11], v[144:159]
    v_exp_f32 v40, v40
    ds_read_b128 v[12:15], v116 offset:36864
    v_exp_f32 v41, v41
    ds_read_b128 v[32:35], v118 offset:36864
    v_exp_f32 v42, v42
    s_add_u32 m0, s57, s58
    v_exp_f32 v43, v43
    buffer_load_dwordx4 v113, s[20:23], s54 offen lds
    s_add_u32 s54, s54, 128
    v_mfma_f32_32x32x16_bf16 v[88:103], v[20:23], v[28:31], v[88:103]
    s_add_u32 m0, s57, s59
    v_exp_f32 v44, v44
    s_mov_b64 exec, s[52:53]
    ds_read_b128 v[20:23], v117 offset:37888
    buffer_load_dwordx4 v114, s[4:7], s55 offen sc1 lds
    s_mov_b64 exec, -1
    v_exp_f32 v45, v45
    s_add_u32 s55, s55, 2048
    s_add_u32 s57, s57, 12288
    s_cmp_eq_u32 s57, 98304
    s_cselect_b32 s57, 0, s57
    v_cvt_pk_bf16_f32 v24, v40, v41
    v_cvt_pk_bf16_f32 v25, v42, v43
    ds_read_b128 v[36:39], v118 offset:40960
    v_exp_f32 v46, v46
    s_waitcnt vmcnt(15) lgkmcnt(2)
    v_mfma_f32_32x32x16_bf16 v[160:175], v[216:219], v[32:35], v[160:175]
    v_exp_f32 v47, v47
    ds_read_b128 v[32:35], v119 offset:36864
    v_cvt_pk_bf16_f32 v26, v44, v45
    v_cvt_pk_bf16_f32 v27, v46, v47
    v_exp_f32 v48, v48
    v_exp_f32 v49, v49
    v_mfma_f32_32x32x16_bf16 v[72:87], v[16:19], v[24:27], v[72:87]
    v_exp_f32 v50, v50
    v_exp_f32 v51, v51
    v_cvt_pk_bf16_f32 v28, v48, v49
    v_cvt_pk_bf16_f32 v29, v50, v51
    v_exp_f32 v52, v52
    s_waitcnt lgkmcnt(1)
    v_mfma_f32_32x32x16_bf16 v[176:191], v[216:219], v[36:39], v[176:191]
    v_exp_f32 v53, v53
    buffer_load_dwordx4 v[216:219], v115, s[4:7], s56 offen offset:0 sc1
    v_exp_f32 v54, v54
    ds_read_b128 v[36:39], v119 offset:40960
    v_exp_f32 v55, v55
    v_cvt_pk_bf16_f32 v30, v52, v53
    v_cvt_pk_bf16_f32 v31, v54, v55
    v_mfma_f32_32x32x16_bf16 v[40:55], v[12:15], v[4:7], v[128:143]
    v_exp_f32 v56, v56
    v_exp_f32 v57, v57
    v_exp_f32 v58, v58
    v_exp_f32 v59, v59
    v_mfma_f32_32x32x16_bf16 v[72:87], v[20:23], v[28:31], v[72:87]
    v_exp_f32 v60, v60
    v_exp_f32 v61, v61
    v_cvt_pk_bf16_f32 v24, v56, v57
    v_cvt_pk_bf16_f32 v25, v58, v59
    v_exp_f32 v62, v62
    s_waitcnt vmcnt(15) lgkmcnt(1)
    v_mfma_f32_32x32x16_bf16 v[160:175], v[220:223], v[32:35], v[160:175]
    v_exp_f32 v63, v63
    v_cvt_pk_bf16_f32 v26, v60, v61
    v_cvt_pk_bf16_f32 v27, v62, v63
    v_exp_f32 v64, v64
    v_exp_f32 v65, v65
    v_mfma_f32_32x32x16_bf16 v[88:103], v[16:19], v[24:27], v[88:103]
    v_exp_f32 v66, v66
    s_mov_b64 exec, s[52:53]
    ds_read_b128 v[16:19], v117 offset:36864
    s_mov_b64 exec, -1
    v_exp_f32 v67, v67
    v_cvt_pk_bf16_f32 v28, v64, v65
    v_cvt_pk_bf16_f32 v29, v66, v67
    v_exp_f32 v68, v68
    s_waitcnt lgkmcnt(1)
    v_mfma_f32_32x32x16_bf16 v[176:191], v[220:223], v[36:39], v[176:191]
    v_exp_f32 v69, v69
    buffer_load_dwordx4 v[220:223], v115, s[4:7], s56 offen offset:1024 sc1
    s_add_u32 s56, s56, 4096
    v_exp_f32 v70, v70
    v_exp_f32 v71, v71
    v_cvt_pk_bf16_f32 v30, v68, v69
    v_cvt_pk_bf16_f32 v31, v70, v71
    s_waitcnt lgkmcnt(0)
    v_add_u32 v116, s60, v116
    v_add_u32 v117, s60, v117
    v_add_u32 v118, s60, v118
    v_add_u32 v119, s60, v119
    s_sub_u32 s60, 0, s60
    s_sub_u32 s61, s61, 1
    s_cmp_lg_u32 s61, 0
    s_cbranch_scc1 parallel_sum__grouped_kv_mqa__mixer_gmlp__prompt_kernel_a2_loop
    s_barrier
    v_mfma_f32_32x32x16_bf16 v[56:71], v[12:15], v[8:11], v[144:159]
    v_exp_f32 v40, v40
    ds_read_b128 v[12:15], v116 offset:0
    v_exp_f32 v41, v41
    ds_read_b128 v[32:35], v118 offset:0
    v_exp_f32 v42, v42
    s_add_u32 m0, s57, s58
    v_exp_f32 v43, v43
    buffer_load_dwordx4 v113, s[20:23], s54 offen lds
    s_add_u32 s54, s54, 128
    v_mfma_f32_32x32x16_bf16 v[88:103], v[20:23], v[28:31], v[88:103]
    s_add_u32 m0, s57, s59
    v_exp_f32 v44, v44
    s_mov_b64 exec, s[52:53]
    ds_read_b128 v[20:23], v117 offset:1024
    buffer_load_dwordx4 v114, s[4:7], s55 offen sc1 lds
    s_mov_b64 exec, -1
    v_exp_f32 v45, v45
    s_add_u32 s55, s55, 2048
    s_add_u32 s57, s57, 12288
    s_cmp_eq_u32 s57, 98304
    s_cselect_b32 s57, 0, s57
    v_cvt_pk_bf16_f32 v24, v40, v41
    v_cvt_pk_bf16_f32 v25, v42, v43
    ds_read_b128 v[36:39], v118 offset:4096
    v_exp_f32 v46, v46
    s_waitcnt vmcnt(15) lgkmcnt(2)
    v_mfma_f32_32x32x16_bf16 v[160:175], v[192:195], v[32:35], v[160:175]
    v_exp_f32 v47, v47
    ds_read_b128 v[32:35], v119 offset:0
    v_cvt_pk_bf16_f32 v26, v44, v45
    v_cvt_pk_bf16_f32 v27, v46, v47
    v_exp_f32 v48, v48
    v_exp_f32 v49, v49
    v_mfma_f32_32x32x16_bf16 v[72:87], v[16:19], v[24:27], v[72:87]
    v_exp_f32 v50, v50
    v_exp_f32 v51, v51
    v_cvt_pk_bf16_f32 v28, v48, v49
    v_cvt_pk_bf16_f32 v29, v50, v51
    v_exp_f32 v52, v52
    s_waitcnt lgkmcnt(1)
    v_mfma_f32_32x32x16_bf16 v[176:191], v[192:195], v[36:39], v[176:191]
    v_exp_f32 v53, v53
    buffer_load_dwordx4 v[192:195], v115, s[4:7], s56 offen offset:0 sc1
    v_exp_f32 v54, v54
    ds_read_b128 v[36:39], v119 offset:4096
    v_exp_f32 v55, v55
    v_cvt_pk_bf16_f32 v30, v52, v53
    v_cvt_pk_bf16_f32 v31, v54, v55
    v_mfma_f32_32x32x16_bf16 v[40:55], v[12:15], v[4:7], v[128:143]
    v_exp_f32 v56, v56
    v_bfe_u32 v225, v1, 2, 2
    v_and_b32 v226, 3, v1
    v_lshrrev_b32 v227, 4, v1
    v_lshrrev_b32 v224, 1, v227
    v_lshl_add_u32 v224, v224, 2, v225
    s_lshl_b32 s62, s49, 3
    v_add_u32 v224, s62, v224
    v_lshlrev_b32 v105, 10, v224
    v_and_b32 v224, 1, v227
    v_lshl_add_u32 v105, v224, 6, v105
    v_lshl_add_u32 v105, v226, 4, v105
    s_lshl_b32 s62, s47, 7
    v_add_u32 v105, s62, v105
    v_lshlrev_b32 v106, 9, v2
    v_lshl_add_u32 v106, v225, 6, v106
    v_lshl_add_u32 v106, v224, 5, v106
    v_lshl_add_u32 v106, v226, 3, v106
    s_lshl_b32 s62, s50, 14
    s_add_u32 s62, s62, 98304
    v_add_u32 v107, s62, v106
    s_lshl_b32 s62, s50, 11
    s_add_u32 s62, s62, 0
    v_add_u32 v106, s62, v106
    v_add_u32 v108, 65536, v106
    s_lshl_b32 s62, s49, 10
    s_lshl_b32 s63, s50, 14
    s_add_u32 s96, s62, s63
    s_add_u32 s96, s96, 98304
    s_lshl_b32 s97, s50, 17
    s_lshl_b32 s63, s50, 11
    s_add_u32 s98, s62, s63
    s_mul_i32 s99, s50, 229376
    v_exp_f32 v57, v57
    v_exp_f32 v58, v58
    v_exp_f32 v59, v59
    v_mfma_f32_32x32x16_bf16 v[72:87], v[20:23], v[28:31], v[72:87]
    v_exp_f32 v60, v60
    s_add_u32 m0, s96, 0
    s_add_u32 s62, s97, 0
    buffer_load_dwordx4 v105, s[28:31], s62 offen lds
    v_exp_f32 v61, v61
    v_cvt_pk_bf16_f32 v24, v56, v57
    v_cvt_pk_bf16_f32 v25, v58, v59
    v_exp_f32 v62, v62
    s_waitcnt vmcnt(16) lgkmcnt(1)
    v_mfma_f32_32x32x16_bf16 v[160:175], v[196:199], v[32:35], v[160:175]
    v_exp_f32 v63, v63
    v_cvt_pk_bf16_f32 v26, v60, v61
    v_cvt_pk_bf16_f32 v27, v62, v63
    v_exp_f32 v64, v64
    v_exp_f32 v65, v65
    v_mfma_f32_32x32x16_bf16 v[88:103], v[16:19], v[24:27], v[88:103]
    v_exp_f32 v66, v66
    s_mov_b64 exec, s[52:53]
    ds_read_b128 v[16:19], v117 offset:0
    s_mov_b64 exec, -1
    v_exp_f32 v67, v67
    v_cvt_pk_bf16_f32 v28, v64, v65
    v_cvt_pk_bf16_f32 v29, v66, v67
    v_exp_f32 v68, v68
    s_waitcnt lgkmcnt(1)
    v_mfma_f32_32x32x16_bf16 v[176:191], v[196:199], v[36:39], v[176:191]
    v_exp_f32 v69, v69
    buffer_load_dwordx4 v[196:199], v115, s[4:7], s56 offen offset:1024 sc1
    s_add_u32 s56, s56, 4096
    v_exp_f32 v70, v70
    v_exp_f32 v71, v71
    v_cvt_pk_bf16_f32 v30, v68, v69
    v_cvt_pk_bf16_f32 v31, v70, v71
    s_barrier
    v_mfma_f32_32x32x16_bf16 v[56:71], v[12:15], v[8:11], v[144:159]
    v_exp_f32 v40, v40
    ds_read_b128 v[12:15], v116 offset:12288
    v_exp_f32 v41, v41
    ds_read_b128 v[32:35], v118 offset:12288
    v_exp_f32 v42, v42
    s_add_u32 m0, s57, s58
    v_exp_f32 v43, v43
    buffer_load_dwordx4 v113, s[20:23], s54 offen lds
    s_add_u32 s54, s54, 128
    v_mfma_f32_32x32x16_bf16 v[88:103], v[20:23], v[28:31], v[88:103]
    s_add_u32 m0, s57, s59
    v_exp_f32 v44, v44
    s_mov_b64 exec, s[52:53]
    ds_read_b128 v[20:23], v117 offset:13312
    buffer_load_dwordx4 v114, s[4:7], s55 offen sc1 lds
    s_mov_b64 exec, -1
    v_exp_f32 v45, v45
    s_add_u32 s55, s55, 2048
    s_add_u32 s57, s57, 12288
    s_cmp_eq_u32 s57, 98304
    s_cselect_b32 s57, 0, s57
    v_cvt_pk_bf16_f32 v24, v40, v41
    v_cvt_pk_bf16_f32 v25, v42, v43
    ds_read_b128 v[36:39], v118 offset:16384
    v_exp_f32 v46, v46
    s_waitcnt vmcnt(16) lgkmcnt(2)
    v_mfma_f32_32x32x16_bf16 v[160:175], v[200:203], v[32:35], v[160:175]
    v_exp_f32 v47, v47
    ds_read_b128 v[32:35], v119 offset:12288
    v_cvt_pk_bf16_f32 v26, v44, v45
    v_cvt_pk_bf16_f32 v27, v46, v47
    v_exp_f32 v48, v48
    v_exp_f32 v49, v49
    v_mfma_f32_32x32x16_bf16 v[72:87], v[16:19], v[24:27], v[72:87]
    v_exp_f32 v50, v50
    v_exp_f32 v51, v51
    v_cvt_pk_bf16_f32 v28, v48, v49
    v_cvt_pk_bf16_f32 v29, v50, v51
    v_exp_f32 v52, v52
    s_waitcnt lgkmcnt(1)
    v_mfma_f32_32x32x16_bf16 v[176:191], v[200:203], v[36:39], v[176:191]
    v_exp_f32 v53, v53
    buffer_load_dwordx4 v[200:203], v115, s[4:7], s56 offen offset:0 sc1
    v_exp_f32 v54, v54
    ds_read_b128 v[36:39], v119 offset:16384
    v_exp_f32 v55, v55
    v_cvt_pk_bf16_f32 v30, v52, v53
    v_cvt_pk_bf16_f32 v31, v54, v55
    v_mfma_f32_32x32x16_bf16 v[40:55], v[12:15], v[4:7], v[128:143]
    v_exp_f32 v56, v56
    s_add_u32 m0, s96, 2048
    s_add_u32 s62, s97, 16384
    buffer_load_dwordx4 v105, s[28:31], s62 offen lds
    v_exp_f32 v57, v57
    v_exp_f32 v58, v58
    v_exp_f32 v59, v59
    v_mfma_f32_32x32x16_bf16 v[72:87], v[20:23], v[28:31], v[72:87]
    v_exp_f32 v60, v60
    v_exp_f32 v61, v61
    v_cvt_pk_bf16_f32 v24, v56, v57
    v_cvt_pk_bf16_f32 v25, v58, v59
    v_exp_f32 v62, v62
    s_waitcnt vmcnt(17) lgkmcnt(1)
    v_mfma_f32_32x32x16_bf16 v[160:175], v[204:207], v[32:35], v[160:175]
    v_exp_f32 v63, v63
    v_cvt_pk_bf16_f32 v26, v60, v61
    v_cvt_pk_bf16_f32 v27, v62, v63
    v_exp_f32 v64, v64
    v_exp_f32 v65, v65
    v_mfma_f32_32x32x16_bf16 v[88:103], v[16:19], v[24:27], v[88:103]
    v_exp_f32 v66, v66
    s_mov_b64 exec, s[52:53]
    ds_read_b128 v[16:19], v117 offset:12288
    s_mov_b64 exec, -1
    v_exp_f32 v67, v67
    v_cvt_pk_bf16_f32 v28, v64, v65
    v_cvt_pk_bf16_f32 v29, v66, v67
    v_exp_f32 v68, v68
    s_waitcnt lgkmcnt(1)
    v_mfma_f32_32x32x16_bf16 v[176:191], v[204:207], v[36:39], v[176:191]
    v_exp_f32 v69, v69
    buffer_load_dwordx4 v[204:207], v115, s[4:7], s56 offen offset:1024 sc1
    s_add_u32 s56, s56, 4096
    v_exp_f32 v70, v70
    v_exp_f32 v71, v71
    v_cvt_pk_bf16_f32 v30, v68, v69
    v_cvt_pk_bf16_f32 v31, v70, v71
    s_barrier
    v_mfma_f32_32x32x16_bf16 v[56:71], v[12:15], v[8:11], v[144:159]
    v_exp_f32 v40, v40
    ds_read_b128 v[12:15], v116 offset:24576
    v_exp_f32 v41, v41
    ds_read_b128 v[32:35], v118 offset:24576
    v_exp_f32 v42, v42
    v_exp_f32 v43, v43
    v_mfma_f32_32x32x16_bf16 v[88:103], v[20:23], v[28:31], v[88:103]
    v_exp_f32 v44, v44
    s_mov_b64 exec, s[52:53]
    ds_read_b128 v[20:23], v117 offset:25600
    s_mov_b64 exec, -1
    v_exp_f32 v45, v45
    v_cvt_pk_bf16_f32 v24, v40, v41
    v_cvt_pk_bf16_f32 v25, v42, v43
    ds_read_b128 v[36:39], v118 offset:28672
    v_exp_f32 v46, v46
    s_waitcnt vmcnt(15) lgkmcnt(2)
    v_mfma_f32_32x32x16_bf16 v[160:175], v[208:211], v[32:35], v[160:175]
    v_exp_f32 v47, v47
    ds_read_b128 v[32:35], v119 offset:24576
    v_cvt_pk_bf16_f32 v26, v44, v45
    v_cvt_pk_bf16_f32 v27, v46, v47
    v_exp_f32 v48, v48
    v_exp_f32 v49, v49
    v_mfma_f32_32x32x16_bf16 v[72:87], v[16:19], v[24:27], v[72:87]
    v_exp_f32 v50, v50
    v_exp_f32 v51, v51
    v_cvt_pk_bf16_f32 v28, v48, v49
    v_cvt_pk_bf16_f32 v29, v50, v51
    v_exp_f32 v52, v52
    s_waitcnt lgkmcnt(1)
    v_mfma_f32_32x32x16_bf16 v[176:191], v[208:211], v[36:39], v[176:191]
    v_exp_f32 v53, v53
    buffer_load_dwordx4 v[208:211], v115, s[4:7], s56 offen offset:0 sc1
    v_exp_f32 v54, v54
    ds_read_b128 v[36:39], v119 offset:28672
    v_exp_f32 v55, v55
    v_cvt_pk_bf16_f32 v30, v52, v53
    v_cvt_pk_bf16_f32 v31, v54, v55
    v_mfma_f32_32x32x16_bf16 v[40:55], v[12:15], v[4:7], v[128:143]
    v_exp_f32 v56, v56
    s_add_u32 m0, s96, 4096
    s_add_u32 s62, s97, 32768
    buffer_load_dwordx4 v105, s[28:31], s62 offen lds
    v_exp_f32 v57, v57
    v_exp_f32 v58, v58
    v_exp_f32 v59, v59
    v_mfma_f32_32x32x16_bf16 v[72:87], v[20:23], v[28:31], v[72:87]
    v_exp_f32 v60, v60
    s_add_u32 m0, s98, 0
    s_add_u32 s62, s99, 196608
    buffer_load_dwordx4 v105, s[32:35], s62 offen lds
    v_exp_f32 v61, v61
    v_cvt_pk_bf16_f32 v24, v56, v57
    v_cvt_pk_bf16_f32 v25, v58, v59
    v_exp_f32 v62, v62
    s_waitcnt vmcnt(17) lgkmcnt(1)
    v_mfma_f32_32x32x16_bf16 v[160:175], v[212:215], v[32:35], v[160:175]
    v_exp_f32 v63, v63
    v_cvt_pk_bf16_f32 v26, v60, v61
    v_cvt_pk_bf16_f32 v27, v62, v63
    v_exp_f32 v64, v64
    v_exp_f32 v65, v65
    v_mfma_f32_32x32x16_bf16 v[88:103], v[16:19], v[24:27], v[88:103]
    v_exp_f32 v66, v66
    s_mov_b64 exec, s[52:53]
    ds_read_b128 v[16:19], v117 offset:24576
    s_mov_b64 exec, -1
    v_exp_f32 v67, v67
    v_cvt_pk_bf16_f32 v28, v64, v65
    v_cvt_pk_bf16_f32 v29, v66, v67
    v_exp_f32 v68, v68
    s_waitcnt lgkmcnt(1)
    v_mfma_f32_32x32x16_bf16 v[176:191], v[212:215], v[36:39], v[176:191]
    v_exp_f32 v69, v69
    buffer_load_dwordx4 v[212:215], v115, s[4:7], s56 offen offset:1024 sc1
    s_add_u32 s56, s56, 4096
    v_exp_f32 v70, v70
    v_exp_f32 v71, v71
    v_cvt_pk_bf16_f32 v30, v68, v69
    v_cvt_pk_bf16_f32 v31, v70, v71
    s_barrier
    v_mfma_f32_32x32x16_bf16 v[56:71], v[12:15], v[8:11], v[144:159]
    v_exp_f32 v40, v40
    ds_read_b128 v[12:15], v116 offset:36864
    v_exp_f32 v41, v41
    ds_read_b128 v[32:35], v118 offset:36864
    v_exp_f32 v42, v42
    v_exp_f32 v43, v43
    v_mfma_f32_32x32x16_bf16 v[88:103], v[20:23], v[28:31], v[88:103]
    v_exp_f32 v44, v44
    s_mov_b64 exec, s[52:53]
    ds_read_b128 v[20:23], v117 offset:37888
    s_mov_b64 exec, -1
    v_exp_f32 v45, v45
    v_cvt_pk_bf16_f32 v24, v40, v41
    v_cvt_pk_bf16_f32 v25, v42, v43
    ds_read_b128 v[36:39], v118 offset:40960
    v_exp_f32 v46, v46
    s_waitcnt vmcnt(15) lgkmcnt(2)
    v_mfma_f32_32x32x16_bf16 v[160:175], v[216:219], v[32:35], v[160:175]
    v_exp_f32 v47, v47
    ds_read_b128 v[32:35], v119 offset:36864
    v_cvt_pk_bf16_f32 v26, v44, v45
    v_cvt_pk_bf16_f32 v27, v46, v47
    v_exp_f32 v48, v48
    v_exp_f32 v49, v49
    v_mfma_f32_32x32x16_bf16 v[72:87], v[16:19], v[24:27], v[72:87]
    v_exp_f32 v50, v50
    v_exp_f32 v51, v51
    v_cvt_pk_bf16_f32 v28, v48, v49
    v_cvt_pk_bf16_f32 v29, v50, v51
    v_exp_f32 v52, v52
    s_waitcnt lgkmcnt(1)
    v_mfma_f32_32x32x16_bf16 v[176:191], v[216:219], v[36:39], v[176:191]
    v_exp_f32 v53, v53
    buffer_load_dwordx4 v[216:219], v115, s[4:7], s56 offen offset:0 sc1
    v_exp_f32 v54, v54
    ds_read_b128 v[36:39], v119 offset:40960
    v_exp_f32 v55, v55
    v_cvt_pk_bf16_f32 v30, v52, v53
    v_cvt_pk_bf16_f32 v31, v54, v55
    v_mfma_f32_32x32x16_bf16 v[40:55], v[12:15], v[4:7], v[128:143]
    v_exp_f32 v56, v56
    s_add_u32 m0, s96, 6144
    s_add_u32 s62, s97, 49152
    buffer_load_dwordx4 v105, s[28:31], s62 offen lds
    v_exp_f32 v57, v57
    v_exp_f32 v58, v58
    v_exp_f32 v59, v59
    v_mfma_f32_32x32x16_bf16 v[72:87], v[20:23], v[28:31], v[72:87]
    v_exp_f32 v60, v60
    s_add_u32 m0, s98, 8192
    s_add_u32 s62, s99, 212992
    buffer_load_dwordx4 v105, s[32:35], s62 offen lds
    v_exp_f32 v61, v61
    v_cvt_pk_bf16_f32 v24, v56, v57
    v_cvt_pk_bf16_f32 v25, v58, v59
    v_exp_f32 v62, v62
    s_waitcnt vmcnt(17) lgkmcnt(1)
    v_mfma_f32_32x32x16_bf16 v[160:175], v[220:223], v[32:35], v[160:175]
    v_exp_f32 v63, v63
    v_cvt_pk_bf16_f32 v26, v60, v61
    v_cvt_pk_bf16_f32 v27, v62, v63
    v_exp_f32 v64, v64
    v_exp_f32 v65, v65
    v_mfma_f32_32x32x16_bf16 v[88:103], v[16:19], v[24:27], v[88:103]
    v_exp_f32 v66, v66
    s_mov_b64 exec, s[52:53]
    ds_read_b128 v[16:19], v117 offset:36864
    s_mov_b64 exec, -1
    v_exp_f32 v67, v67
    v_cvt_pk_bf16_f32 v28, v64, v65
    v_cvt_pk_bf16_f32 v29, v66, v67
    v_exp_f32 v68, v68
    s_waitcnt lgkmcnt(1)
    v_mfma_f32_32x32x16_bf16 v[176:191], v[220:223], v[36:39], v[176:191]
    v_exp_f32 v69, v69
    buffer_load_dwordx4 v[220:223], v115, s[4:7], s56 offen offset:1024 sc1
    s_add_u32 s56, s56, 4096
    v_exp_f32 v70, v70
    v_exp_f32 v71, v71
    v_cvt_pk_bf16_f32 v30, v68, v69
    v_cvt_pk_bf16_f32 v31, v70, v71
    v_add_u32 v116, s60, v116
    v_add_u32 v117, s60, v117
    v_add_u32 v118, s60, v118
    v_add_u32 v119, s60, v119
    s_sub_u32 s60, 0, s60
    s_barrier
    v_mfma_f32_32x32x16_bf16 v[56:71], v[12:15], v[8:11], v[144:159]
    v_exp_f32 v40, v40
    ds_read_b128 v[12:15], v116 offset:0
    v_exp_f32 v41, v41
    ds_read_b128 v[32:35], v118 offset:0
    v_exp_f32 v42, v42
    v_exp_f32 v43, v43
    v_mfma_f32_32x32x16_bf16 v[88:103], v[20:23], v[28:31], v[88:103]
    v_exp_f32 v44, v44
    s_mov_b64 exec, s[52:53]
    ds_read_b128 v[20:23], v117 offset:1024
    s_mov_b64 exec, -1
    v_exp_f32 v45, v45
    v_cvt_pk_bf16_f32 v24, v40, v41
    v_cvt_pk_bf16_f32 v25, v42, v43
    ds_read_b128 v[36:39], v118 offset:4096
    v_exp_f32 v46, v46
    s_waitcnt vmcnt(15) lgkmcnt(2)
    v_mfma_f32_32x32x16_bf16 v[160:175], v[192:195], v[32:35], v[160:175]
    v_exp_f32 v47, v47
    ds_read_b128 v[32:35], v119 offset:0
    v_cvt_pk_bf16_f32 v26, v44, v45
    v_cvt_pk_bf16_f32 v27, v46, v47
    v_exp_f32 v48, v48
    v_exp_f32 v49, v49
    v_mfma_f32_32x32x16_bf16 v[72:87], v[16:19], v[24:27], v[72:87]
    v_exp_f32 v50, v50
    v_exp_f32 v51, v51
    v_cvt_pk_bf16_f32 v28, v48, v49
    v_cvt_pk_bf16_f32 v29, v50, v51
    v_exp_f32 v52, v52
    s_waitcnt lgkmcnt(1)
    v_mfma_f32_32x32x16_bf16 v[176:191], v[192:195], v[36:39], v[176:191]
    v_exp_f32 v53, v53
    v_exp_f32 v54, v54
    ds_read_b128 v[36:39], v119 offset:4096
    v_exp_f32 v55, v55
    v_cvt_pk_bf16_f32 v30, v52, v53
    v_cvt_pk_bf16_f32 v31, v54, v55
    v_mfma_f32_32x32x16_bf16 v[40:55], v[12:15], v[4:7], v[128:143]
    v_exp_f32 v56, v56
    s_add_u32 m0, s96, 8192
    s_add_u32 s62, s97, 65536
    buffer_load_dwordx4 v105, s[28:31], s62 offen lds
    v_exp_f32 v57, v57
    v_exp_f32 v58, v58
    v_exp_f32 v59, v59
    v_mfma_f32_32x32x16_bf16 v[72:87], v[20:23], v[28:31], v[72:87]
    v_exp_f32 v60, v60
    v_exp_f32 v61, v61
    v_cvt_pk_bf16_f32 v24, v56, v57
    v_cvt_pk_bf16_f32 v25, v58, v59
    v_exp_f32 v62, v62
    s_waitcnt vmcnt(14) lgkmcnt(1)
    v_mfma_f32_32x32x16_bf16 v[160:175], v[196:199], v[32:35], v[160:175]
    v_exp_f32 v63, v63
    v_cvt_pk_bf16_f32 v26, v60, v61
    v_cvt_pk_bf16_f32 v27, v62, v63
    v_exp_f32 v64, v64
    v_exp_f32 v65, v65
    v_mfma_f32_32x32x16_bf16 v[88:103], v[16:19], v[24:27], v[88:103]
    v_exp_f32 v66, v66
    s_mov_b64 exec, s[52:53]
    ds_read_b128 v[16:19], v117 offset:0
    s_mov_b64 exec, -1
    v_exp_f32 v67, v67
    v_cvt_pk_bf16_f32 v28, v64, v65
    v_cvt_pk_bf16_f32 v29, v66, v67
    v_exp_f32 v68, v68
    s_waitcnt lgkmcnt(1)
    v_mfma_f32_32x32x16_bf16 v[176:191], v[196:199], v[36:39], v[176:191]
    v_exp_f32 v69, v69
    v_exp_f32 v70, v70
    v_exp_f32 v71, v71
    v_cvt_pk_bf16_f32 v30, v68, v69
    v_cvt_pk_bf16_f32 v31, v70, v71
    s_barrier
    v_mfma_f32_32x32x16_bf16 v[56:71], v[12:15], v[8:11], v[144:159]
    v_exp_f32 v40, v40
    ds_read_b128 v[12:15], v116 offset:12288
    v_exp_f32 v41, v41
    ds_read_b128 v[32:35], v118 offset:12288
    v_exp_f32 v42, v42
    v_exp_f32 v43, v43
    v_mfma_f32_32x32x16_bf16 v[88:103], v[20:23], v[28:31], v[88:103]
    v_exp_f32 v44, v44
    s_mov_b64 exec, s[52:53]
    ds_read_b128 v[20:23], v117 offset:13312
    s_mov_b64 exec, -1
    v_exp_f32 v45, v45
    v_cvt_pk_bf16_f32 v24, v40, v41
    v_cvt_pk_bf16_f32 v25, v42, v43
    ds_read_b128 v[36:39], v118 offset:16384
    v_exp_f32 v46, v46
    s_waitcnt vmcnt(11) lgkmcnt(2)
    v_mfma_f32_32x32x16_bf16 v[160:175], v[200:203], v[32:35], v[160:175]
    v_exp_f32 v47, v47
    ds_read_b128 v[32:35], v119 offset:12288
    v_cvt_pk_bf16_f32 v26, v44, v45
    v_cvt_pk_bf16_f32 v27, v46, v47
    v_exp_f32 v48, v48
    v_exp_f32 v49, v49
    v_mfma_f32_32x32x16_bf16 v[72:87], v[16:19], v[24:27], v[72:87]
    v_exp_f32 v50, v50
    v_exp_f32 v51, v51
    v_cvt_pk_bf16_f32 v28, v48, v49
    v_cvt_pk_bf16_f32 v29, v50, v51
    v_exp_f32 v52, v52
    s_waitcnt lgkmcnt(1)
    v_mfma_f32_32x32x16_bf16 v[176:191], v[200:203], v[36:39], v[176:191]
    v_exp_f32 v53, v53
    v_exp_f32 v54, v54
    ds_read_b128 v[36:39], v119 offset:16384
    v_exp_f32 v55, v55
    v_cvt_pk_bf16_f32 v30, v52, v53
    v_cvt_pk_bf16_f32 v31, v54, v55
    v_mfma_f32_32x32x16_bf16 v[40:55], v[12:15], v[4:7], v[128:143]
    v_exp_f32 v56, v56
    s_add_u32 m0, s96, 10240
    s_add_u32 s62, s97, 81920
    buffer_load_dwordx4 v105, s[28:31], s62 offen lds
    v_exp_f32 v57, v57
    v_exp_f32 v58, v58
    v_exp_f32 v59, v59
    v_mfma_f32_32x32x16_bf16 v[72:87], v[20:23], v[28:31], v[72:87]
    v_exp_f32 v60, v60
    s_add_u32 m0, s98, 16384
    s_add_u32 s62, s99, 32768
    buffer_load_dwordx4 v105, s[32:35], s62 offen lds
    v_exp_f32 v61, v61
    v_cvt_pk_bf16_f32 v24, v56, v57
    v_cvt_pk_bf16_f32 v25, v58, v59
    v_exp_f32 v62, v62
    s_waitcnt vmcnt(11) lgkmcnt(1)
    v_mfma_f32_32x32x16_bf16 v[160:175], v[204:207], v[32:35], v[160:175]
    v_exp_f32 v63, v63
    v_cvt_pk_bf16_f32 v26, v60, v61
    v_cvt_pk_bf16_f32 v27, v62, v63
    v_exp_f32 v64, v64
    v_exp_f32 v65, v65
    v_mfma_f32_32x32x16_bf16 v[88:103], v[16:19], v[24:27], v[88:103]
    v_exp_f32 v66, v66
    s_mov_b64 exec, s[52:53]
    ds_read_b128 v[16:19], v117 offset:12288
    s_mov_b64 exec, -1
    v_exp_f32 v67, v67
    v_cvt_pk_bf16_f32 v28, v64, v65
    v_cvt_pk_bf16_f32 v29, v66, v67
    v_exp_f32 v68, v68
    s_waitcnt lgkmcnt(1)
    v_mfma_f32_32x32x16_bf16 v[176:191], v[204:207], v[36:39], v[176:191]
    v_exp_f32 v69, v69
    v_exp_f32 v70, v70
    v_exp_f32 v71, v71
    v_cvt_pk_bf16_f32 v30, v68, v69
    v_cvt_pk_bf16_f32 v31, v70, v71
    s_barrier
    v_mfma_f32_32x32x16_bf16 v[56:71], v[12:15], v[8:11], v[144:159]
    v_exp_f32 v40, v40
    ds_read_b128 v[12:15], v116 offset:24576
    v_exp_f32 v41, v41
    ds_read_b128 v[32:35], v118 offset:24576
    v_exp_f32 v42, v42
    v_exp_f32 v43, v43
    v_mfma_f32_32x32x16_bf16 v[88:103], v[20:23], v[28:31], v[88:103]
    v_exp_f32 v44, v44
    s_mov_b64 exec, s[52:53]
    ds_read_b128 v[20:23], v117 offset:25600
    s_mov_b64 exec, -1
    v_exp_f32 v45, v45
    v_cvt_pk_bf16_f32 v24, v40, v41
    v_cvt_pk_bf16_f32 v25, v42, v43
    ds_read_b128 v[36:39], v118 offset:28672
    v_exp_f32 v46, v46
    s_waitcnt vmcnt(10) lgkmcnt(2)
    v_mfma_f32_32x32x16_bf16 v[160:175], v[208:211], v[32:35], v[160:175]
    v_exp_f32 v47, v47
    ds_read_b128 v[32:35], v119 offset:24576
    v_cvt_pk_bf16_f32 v26, v44, v45
    v_cvt_pk_bf16_f32 v27, v46, v47
    v_exp_f32 v48, v48
    v_exp_f32 v49, v49
    v_mfma_f32_32x32x16_bf16 v[72:87], v[16:19], v[24:27], v[72:87]
    v_exp_f32 v50, v50
    v_exp_f32 v51, v51
    v_cvt_pk_bf16_f32 v28, v48, v49
    v_cvt_pk_bf16_f32 v29, v50, v51
    v_exp_f32 v52, v52
    s_waitcnt lgkmcnt(1)
    v_mfma_f32_32x32x16_bf16 v[176:191], v[208:211], v[36:39], v[176:191]
    v_exp_f32 v53, v53
    v_exp_f32 v54, v54
    ds_read_b128 v[36:39], v119 offset:28672
    v_exp_f32 v55, v55
    v_cvt_pk_bf16_f32 v30, v52, v53
    v_cvt_pk_bf16_f32 v31, v54, v55
    v_mfma_f32_32x32x16_bf16 v[40:55], v[12:15], v[4:7], v[128:143]
    v_exp_f32 v56, v56
    s_add_u32 m0, s96, 12288
    s_add_u32 s62, s97, 98304
    buffer_load_dwordx4 v105, s[28:31], s62 offen lds
    v_exp_f32 v57, v57
    v_exp_f32 v58, v58
    v_exp_f32 v59, v59
    v_mfma_f32_32x32x16_bf16 v[72:87], v[20:23], v[28:31], v[72:87]
    v_exp_f32 v60, v60
    s_add_u32 m0, s98, 24576
    s_add_u32 s62, s99, 49152
    buffer_load_dwordx4 v105, s[32:35], s62 offen lds
    v_exp_f32 v61, v61
    v_cvt_pk_bf16_f32 v24, v56, v57
    v_cvt_pk_bf16_f32 v25, v58, v59
    v_exp_f32 v62, v62
    s_waitcnt vmcnt(9) lgkmcnt(1)
    v_mfma_f32_32x32x16_bf16 v[160:175], v[212:215], v[32:35], v[160:175]
    v_exp_f32 v63, v63
    v_cvt_pk_bf16_f32 v26, v60, v61
    v_cvt_pk_bf16_f32 v27, v62, v63
    v_exp_f32 v64, v64
    v_exp_f32 v65, v65
    v_mfma_f32_32x32x16_bf16 v[88:103], v[16:19], v[24:27], v[88:103]
    v_exp_f32 v66, v66
    s_mov_b64 exec, s[52:53]
    ds_read_b128 v[16:19], v117 offset:24576
    s_mov_b64 exec, -1
    v_exp_f32 v67, v67
    v_cvt_pk_bf16_f32 v28, v64, v65
    v_cvt_pk_bf16_f32 v29, v66, v67
    v_exp_f32 v68, v68
    s_waitcnt lgkmcnt(1)
    v_mfma_f32_32x32x16_bf16 v[176:191], v[212:215], v[36:39], v[176:191]
    v_exp_f32 v69, v69
    v_exp_f32 v70, v70
    v_exp_f32 v71, v71
    v_cvt_pk_bf16_f32 v30, v68, v69
    v_cvt_pk_bf16_f32 v31, v70, v71
    s_waitcnt vmcnt(6)
    s_barrier
    v_mfma_f32_32x32x16_bf16 v[56:71], v[12:15], v[8:11], v[144:159]
    v_exp_f32 v40, v40
    v_exp_f32 v41, v41
    ds_read_b128 v[32:35], v118 offset:36864
    v_exp_f32 v42, v42
    v_exp_f32 v43, v43
    v_mfma_f32_32x32x16_bf16 v[88:103], v[20:23], v[28:31], v[88:103]
    v_exp_f32 v44, v44
    s_mov_b64 exec, s[52:53]
    ds_read_b128 v[20:23], v117 offset:37888
    s_mov_b64 exec, -1
    v_exp_f32 v45, v45
    v_cvt_pk_bf16_f32 v24, v40, v41
    v_cvt_pk_bf16_f32 v25, v42, v43
    ds_read_b128 v[36:39], v118 offset:40960
    v_exp_f32 v46, v46
    s_waitcnt lgkmcnt(2)
    v_mfma_f32_32x32x16_bf16 v[160:175], v[216:219], v[32:35], v[160:175]
    v_exp_f32 v47, v47
    ds_read_b128 v[32:35], v119 offset:36864
    v_cvt_pk_bf16_f32 v26, v44, v45
    v_cvt_pk_bf16_f32 v27, v46, v47
    v_exp_f32 v48, v48
    v_exp_f32 v49, v49
    v_mfma_f32_32x32x16_bf16 v[72:87], v[16:19], v[24:27], v[72:87]
    v_exp_f32 v50, v50
    v_exp_f32 v51, v51
    v_cvt_pk_bf16_f32 v28, v48, v49
    v_cvt_pk_bf16_f32 v29, v50, v51
    v_exp_f32 v52, v52
    s_waitcnt lgkmcnt(1)
    v_mfma_f32_32x32x16_bf16 v[176:191], v[216:219], v[36:39], v[176:191]
    v_exp_f32 v53, v53
    v_exp_f32 v54, v54
    ds_read_b128 v[36:39], v119 offset:40960
    v_exp_f32 v55, v55
    v_cvt_pk_bf16_f32 v30, v52, v53
    v_cvt_pk_bf16_f32 v31, v54, v55
    v_exp_f32 v56, v56
    s_add_u32 m0, s96, 14336
    s_add_u32 s62, s97, 114688
    buffer_load_dwordx4 v105, s[28:31], s62 offen lds
    v_exp_f32 v57, v57
    v_exp_f32 v58, v58
    v_exp_f32 v59, v59
    v_mfma_f32_32x32x16_bf16 v[72:87], v[20:23], v[28:31], v[72:87]
    v_exp_f32 v60, v60
    s_add_u32 m0, s98, 32768
    s_add_u32 s62, s99, 65536
    buffer_load_dwordx4 v105, s[32:35], s62 offen lds
    v_subrev_u32 v110, 0, v106
    ds_read_b64_tr_b16 v[240:241], v110 offset:0
    ds_read_b64_tr_b16 v[242:243], v110 offset:1024
    ds_read_b64_tr_b16 v[244:245], v110 offset:256
    ds_read_b64_tr_b16 v[246:247], v110 offset:1280
    ds_read_b64_tr_b16 v[248:249], v110 offset:8192
    ds_read_b64_tr_b16 v[250:251], v110 offset:9216
    ds_read_b64_tr_b16 v[252:253], v110 offset:8448
    ds_read_b64_tr_b16 v[254:255], v110 offset:9472
    v_exp_f32 v61, v61
    v_cvt_pk_bf16_f32 v24, v56, v57
    v_cvt_pk_bf16_f32 v25, v58, v59
    v_exp_f32 v62, v62
    s_waitcnt vmcnt(7) lgkmcnt(9)
    v_mfma_f32_32x32x16_bf16 v[160:175], v[220:223], v[32:35], v[160:175]
    v_exp_f32 v63, v63
    v_cvt_pk_bf16_f32 v26, v60, v61
    v_cvt_pk_bf16_f32 v27, v62, v63
    v_exp_f32 v64, v64
    v_exp_f32 v65, v65
    v_mfma_f32_32x32x16_bf16 v[88:103], v[16:19], v[24:27], v[88:103]
    v_exp_f32 v66, v66
    v_exp_f32 v67, v67
    v_cvt_pk_bf16_f32 v28, v64, v65
    v_cvt_pk_bf16_f32 v29, v66, v67
    v_exp_f32 v68, v68
    s_waitcnt lgkmcnt(8)
    v_mfma_f32_32x32x16_bf16 v[176:191], v[220:223], v[36:39], v[176:191]
    v_exp_f32 v69, v69
    v_exp_f32 v70, v70
    v_exp_f32 v71, v71
    v_cvt_pk_bf16_f32 v30, v68, v69
    v_cvt_pk_bf16_f32 v31, v70, v71
    s_nop 1
    v_mfma_f32_32x32x16_bf16 v[88:103], v[20:23], v[28:31], v[88:103]
    s_waitcnt lgkmcnt(0)
    s_barrier
    s_lshl_b32 s70, s46, 1
    s_add_u32 s70, s70, s49
    v_lshlrev_b32 v225, 4, v1
    s_mul_i32 s64, s48, 7168
    s_add_u32 s64, s64, 40960
    v_add_u32 v228, s64, v225
    s_xor_b32 s65, s48, 4
    s_mul_i32 s65, s65, 7168
    s_add_u32 s65, s65, 40960
    v_add_u32 v229, s65, v225
    s_mul_i32 s63, s70, 88
    s_lshl_b32 s64, s47, 2
    s_add_u32 s64, s64, s50
    s_add_u32 s68, s63, s64
    s_lshl_b32 s68, s68, 10
    s_add_u32 s68, s68, 9699328
    s_lshl_b32 s64, s64, 1
    s_add_u32 s69, s63, s64
    s_add_u32 s69, s69, 32
    s_lshl_b32 s69, s69, 10
    s_add_u32 s69, s69, 9699328
    s_nop 7
    s_cmp_eq_u32 s49, 0
    s_cbranch_scc0 parallel_sum__grouped_kv_mqa__mixer_gmlp__prompt_kernel_a2_x1
    ds_write_b128 v228, v[88:91] offset:0
    ds_write_b128 v228, v[92:95] offset:1024
    ds_write_b128 v228, v[96:99] offset:2048
    ds_write_b128 v228, v[176:179] offset:3072
    ds_write_b128 v228, v[180:183] offset:4096
    ds_write_b128 v228, v[184:187] offset:5120
    ds_write_b128 v228, v[188:191] offset:6144
    s_waitcnt lgkmcnt(0)
    s_barrier
    ds_read_b128 v[88:91], v229 offset:0
    ds_read_b128 v[92:95], v229 offset:1024
    ds_read_b128 v[96:99], v229 offset:2048
    ds_read_b128 v[176:179], v229 offset:3072
    ds_read_b128 v[180:183], v229 offset:4096
    ds_read_b128 v[184:187], v229 offset:5120
    ds_read_b128 v[188:191], v229 offset:6144
    s_waitcnt lgkmcnt(4)
    v_add_f32 v72, v72, v88
    v_add_f32 v73, v73, v89
    v_add_f32 v74, v74, v90
    v_add_f32 v75, v75, v91
    v_add_f32 v76, v76, v92
    v_add_f32 v77, v77, v93
    v_add_f32 v78, v78, v94
    v_add_f32 v79, v79, v95
    v_add_f32 v80, v80, v96
    v_mul_f32 v230, 0, v72
    v_fma_f32 v230, v73, 0, v230
    v_fma_f32 v230, v74, 0, v230
    v_fma_f32 v230, v75, 0, v230
    v_fma_f32 v230, v76, 0, v230
    v_fma_f32 v230, v77, 0, v230
    v_fma_f32 v230, v78, 0, v230
    v_fma_f32 v230, v79, 0, v230
    s_mov_b32 s64, 0x5f800000
    v_cmp_u_f32 vcc, v230, v230
    v_cmp_nle_f32 s[66:67], v80, s64
    s_nop 1
    s_or_b64 vcc, vcc, s[66:67]
    s_cbranch_vccnz parallel_sum__grouped_kv_mqa__mixer_gmlp__prompt_kernel_a2_v0_fb
parallel_sum__grouped_kv_mqa__mixer_gmlp__prompt_kernel_a2_v0_ok:
    v_rcp_f32 v230, v80
    s_waitcnt lgkmcnt(0)
    v_lshlrev_b32 v227, 16, v104
    v_add_f32 v160, v160, v176
    v_add_f32 v161, v161, v177
    v_add_f32 v162, v162, v178
    v_add_f32 v163, v163, v179
    v_add_f32 v164, v164, v180
    v_add_f32 v165, v165, v181
    v_add_f32 v166, v166, v182
    v_add_f32 v167, v167, v183
    v_add_f32 v168, v168, v184
    v_add_f32 v169, v169, v185
    v_add_f32 v170, v170, v186
    v_add_f32 v171, v171, v187
    v_add_f32 v172, v172, v188
    v_add_f32 v173, v173, v189
    v_add_f32 v174, v174, v190
    v_add_f32 v175, v175, v191
    v_mul_f32 v72, v72, v230
    v_mul_f32 v73, v73, v230
    v_mul_f32 v74, v74, v230
    v_mul_f32 v75, v75, v230
    v_mul_f32 v76, v76, v230
    v_mul_f32 v77, v77, v230
    v_mul_f32 v78, v78, v230
    v_mul_f32 v79, v79, v230
    v_cvt_pk_bf16_f32 v24, v72, v73
    v_cvt_pk_bf16_f32 v25, v74, v75
    v_cvt_pk_bf16_f32 v26, v76, v77
    v_cvt_pk_bf16_f32 v27, v78, v79
    buffer_store_dwordx4 v[24:27], v225, s[4:7], s68 offen sc1
    v_add_f32 v160, v160, v227
    v_add_f32 v161, v161, v227
    v_add_f32 v162, v162, v227
    v_add_f32 v163, v163, v227
    v_add_f32 v164, v164, v227
    v_add_f32 v165, v165, v227
    v_add_f32 v166, v166, v227
    v_add_f32 v167, v167, v227
    v_add_f32 v168, v168, v227
    v_add_f32 v169, v169, v227
    v_add_f32 v170, v170, v227
    v_add_f32 v171, v171, v227
    v_add_f32 v172, v172, v227
    v_add_f32 v173, v173, v227
    v_add_f32 v174, v174, v227
    v_add_f32 v175, v175, v227
    v_lshlrev_b32 v230, 16, v120
    v_and_b32 v231, 0xffff0000, v120
    v_mul_f32 v160, v160, v230
    v_mul_f32 v161, v161, v231
    v_cvt_pk_bf16_f32 v32, v160, v161
    v_lshlrev_b32 v232, 16, v121
    v_and_b32 v233, 0xffff0000, v121
    v_mul_f32 v162, v162, v232
    v_mul_f32 v163, v163, v233
    v_cvt_pk_bf16_f32 v33, v162, v163
    v_lshlrev_b32 v230, 16, v122
    v_and_b32 v231, 0xffff0000, v122
    v_mul_f32 v164, v164, v230
    v_mul_f32 v165, v165, v231
    v_cvt_pk_bf16_f32 v34, v164, v165
    v_lshlrev_b32 v232, 16, v123
    v_and_b32 v233, 0xffff0000, v123
    v_mul_f32 v166, v166, v232
    v_mul_f32 v167, v167, v233
    v_cvt_pk_bf16_f32 v35, v166, v167
    v_lshlrev_b32 v230, 16, v124
    v_and_b32 v231, 0xffff0000, v124
    v_mul_f32 v168, v168, v230
    v_mul_f32 v169, v169, v231
    v_cvt_pk_bf16_f32 v36, v168, v169
    v_lshlrev_b32 v232, 16, v125
    v_and_b32 v233, 0xffff0000, v125
    v_mul_f32 v170, v170, v232
    v_mul_f32 v171, v171, v233
    v_cvt_pk_bf16_f32 v37, v170, v171
    v_lshlrev_b32 v230, 16, v126
    v_and_b32 v231, 0xffff0000, v126
    v_mul_f32 v172, v172, v230
    v_mul_f32 v173, v173, v231
    v_cvt_pk_bf16_f32 v38, v172, v173
    v_lshlrev_b32 v232, 16, v127
    v_and_b32 v233, 0xffff0000, v127
    v_mul_f32 v174, v174, v232
    v_mul_f32 v175, v175, v233
    v_cvt_pk_bf16_f32 v39, v174, v175
    buffer_store_dwordx4 v[32:35], v225, s[4:7], s69 offen sc1
    buffer_store_dwordx4 v[36:39], v225, s[4:7], s69 offen offset:1024 sc1
    s_branch parallel_sum__grouped_kv_mqa__mixer_gmlp__prompt_kernel_a2_x2
parallel_sum__grouped_kv_mqa__mixer_gmlp__prompt_kernel_a2_x1:
    ds_write_b128 v228, v[72:75] offset:0
    ds_write_b128 v228, v[76:79] offset:1024
    ds_write_b128 v228, v[80:83] offset:2048
    ds_write_b128 v228, v[160:163] offset:3072
    ds_write_b128 v228, v[164:167] offset:4096
    ds_write_b128 v228, v[168:171] offset:5120
    ds_write_b128 v228, v[172:175] offset:6144
    s_waitcnt lgkmcnt(0)
    s_barrier
    ds_read_b128 v[72:75], v229 offset:0
    ds_read_b128 v[76:79], v229 offset:1024
    ds_read_b128 v[80:83], v229 offset:2048
    ds_read_b128 v[160:163], v229 offset:3072
    ds_read_b128 v[164:167], v229 offset:4096
    ds_read_b128 v[168:171], v229 offset:5120
    ds_read_b128 v[172:175], v229 offset:6144
    s_waitcnt lgkmcnt(4)
    v_add_f32 v88, v88, v72
    v_add_f32 v89, v89, v73
    v_add_f32 v90, v90, v74
    v_add_f32 v91, v91, v75
    v_add_f32 v92, v92, v76
    v_add_f32 v93, v93, v77
    v_add_f32 v94, v94, v78
    v_add_f32 v95, v95, v79
    v_add_f32 v96, v96, v80
    v_mul_f32 v230, 0, v88
    v_fma_f32 v230, v89, 0, v230
    v_fma_f32 v230, v90, 0, v230
    v_fma_f32 v230, v91, 0, v230
    v_fma_f32 v230, v92, 0, v230
    v_fma_f32 v230, v93, 0, v230
    v_fma_f32 v230, v94, 0, v230
    v_fma_f32 v230, v95, 0, v230
    s_mov_b32 s64, 0x5f800000
    v_cmp_u_f32 vcc, v230, v230
    v_cmp_nle_f32 s[66:67], v96, s64
    s_nop 1
    s_or_b64 vcc, vcc, s[66:67]
    s_cbranch_vccnz parallel_sum__grouped_kv_mqa__mixer_gmlp__prompt_kernel_a2_v1_fb
parallel_sum__grouped_kv_mqa__mixer_gmlp__prompt_kernel_a2_v1_ok:
    v_rcp_f32 v230, v96
    s_waitcnt lgkmcnt(0)
    v_lshlrev_b32 v227, 16, v104
    v_add_f32 v176, v176, v160
    v_add_f32 v177, v177, v161
    v_add_f32 v178, v178, v162
    v_add_f32 v179, v179, v163
    v_add_f32 v180, v180, v164
    v_add_f32 v181, v181, v165
    v_add_f32 v182, v182, v166
    v_add_f32 v183, v183, v167
    v_add_f32 v184, v184, v168
    v_add_f32 v185, v185, v169
    v_add_f32 v186, v186, v170
    v_add_f32 v187, v187, v171
    v_add_f32 v188, v188, v172
    v_add_f32 v189, v189, v173
    v_add_f32 v190, v190, v174
    v_add_f32 v191, v191, v175
    v_mul_f32 v88, v88, v230
    v_mul_f32 v89, v89, v230
    v_mul_f32 v90, v90, v230
    v_mul_f32 v91, v91, v230
    v_mul_f32 v92, v92, v230
    v_mul_f32 v93, v93, v230
    v_mul_f32 v94, v94, v230
    v_mul_f32 v95, v95, v230
    v_cvt_pk_bf16_f32 v24, v88, v89
    v_cvt_pk_bf16_f32 v25, v90, v91
    v_cvt_pk_bf16_f32 v26, v92, v93
    v_cvt_pk_bf16_f32 v27, v94, v95
    buffer_store_dwordx4 v[24:27], v225, s[4:7], s68 offen sc1
    v_add_f32 v176, v176, v227
    v_add_f32 v177, v177, v227
    v_add_f32 v178, v178, v227
    v_add_f32 v179, v179, v227
    v_add_f32 v180, v180, v227
    v_add_f32 v181, v181, v227
    v_add_f32 v182, v182, v227
    v_add_f32 v183, v183, v227
    v_add_f32 v184, v184, v227
    v_add_f32 v185, v185, v227
    v_add_f32 v186, v186, v227
    v_add_f32 v187, v187, v227
    v_add_f32 v188, v188, v227
    v_add_f32 v189, v189, v227
    v_add_f32 v190, v190, v227
    v_add_f32 v191, v191, v227
    v_lshlrev_b32 v230, 16, v120
    v_and_b32 v231, 0xffff0000, v120
    v_mul_f32 v176, v176, v230
    v_mul_f32 v177, v177, v231
    v_cvt_pk_bf16_f32 v32, v176, v177
    v_lshlrev_b32 v232, 16, v121
    v_and_b32 v233, 0xffff0000, v121
    v_mul_f32 v178, v178, v232
    v_mul_f32 v179, v179, v233
    v_cvt_pk_bf16_f32 v33, v178, v179
    v_lshlrev_b32 v230, 16, v122
    v_and_b32 v231, 0xffff0000, v122
    v_mul_f32 v180, v180, v230
    v_mul_f32 v181, v181, v231
    v_cvt_pk_bf16_f32 v34, v180, v181
    v_lshlrev_b32 v232, 16, v123
    v_and_b32 v233, 0xffff0000, v123
    v_mul_f32 v182, v182, v232
    v_mul_f32 v183, v183, v233
    v_cvt_pk_bf16_f32 v35, v182, v183
    v_lshlrev_b32 v230, 16, v124
    v_and_b32 v231, 0xffff0000, v124
    v_mul_f32 v184, v184, v230
    v_mul_f32 v185, v185, v231
    v_cvt_pk_bf16_f32 v36, v184, v185
    v_lshlrev_b32 v232, 16, v125
    v_and_b32 v233, 0xffff0000, v125
    v_mul_f32 v186, v186, v232
    v_mul_f32 v187, v187, v233
    v_cvt_pk_bf16_f32 v37, v186, v187
    v_lshlrev_b32 v230, 16, v126
    v_and_b32 v231, 0xffff0000, v126
    v_mul_f32 v188, v188, v230
    v_mul_f32 v189, v189, v231
    v_cvt_pk_bf16_f32 v38, v188, v189
    v_lshlrev_b32 v232, 16, v127
    v_and_b32 v233, 0xffff0000, v127
    v_mul_f32 v190, v190, v232
    v_mul_f32 v191, v191, v233
    v_cvt_pk_bf16_f32 v39, v190, v191
    buffer_store_dwordx4 v[32:35], v225, s[4:7], s69 offen sc1
    buffer_store_dwordx4 v[36:39], v225, s[4:7], s69 offen offset:1024 sc1
parallel_sum__grouped_kv_mqa__mixer_gmlp__prompt_kernel_a2_x2:
parallel_sum__grouped_kv_mqa__mixer_gmlp__prompt_kernel_p3:
    s_waitcnt vmcnt(0)
    s_barrier
    s_cmp_eq_u32 s48, 0
    s_cbranch_scc0 parallel_sum__grouped_kv_mqa__mixer_gmlp__prompt_kernel_p3_nf
    s_lshl_b32 s62, s46, 3
    s_add_u32 s62, s62, s47
    s_lshl_b32 s62, s62, 7
    s_add_u32 s62, s62, 15466504
    v_mov_b32 v8, 0
    v_mov_b32 v9, 1
    s_mov_b64 exec, 1
    buffer_store_dword v9, v8, s[4:7], s62 offen sc1
    s_mov_b64 exec, -1
parallel_sum__grouped_kv_mqa__mixer_gmlp__prompt_kernel_p3_nf:
    s_add_u32 m0, s98, 0
    s_add_u32 s62, s99, 0
    buffer_load_dwordx4 v105, s[32:35], s62 offen lds
    s_add_u32 m0, s98, 8192
    s_add_u32 s62, s99, 16384
    buffer_load_dwordx4 v105, s[32:35], s62 offen lds
    s_add_u32 m0, s98, 40960
    s_add_u32 s62, s99, 81920
    buffer_load_dwordx4 v105, s[32:35], s62 offen lds
    s_add_u32 m0, s98, 49152
    s_add_u32 s62, s99, 98304
    buffer_load_dwordx4 v105, s[32:35], s62 offen lds
    s_add_u32 m0, s98, 57344
    s_add_u32 s62, s99, 114688
    buffer_load_dwordx4 v105, s[32:35], s62 offen lds
    s_add_u32 m0, s98, 65536
    s_add_u32 s62, s99, 131072
    buffer_load_dwordx4 v105, s[32:35], s62 offen lds
    s_add_u32 m0, s98, 73728
    s_add_u32 s62, s99, 147456
    buffer_load_dwordx4 v105, s[32:35], s62 offen lds
    s_add_u32 m0, s98, 81920
    s_add_u32 s62, s99, 163840
    buffer_load_dwordx4 v105, s[32:35], s62 offen lds
    s_add_u32 m0, s98, 90112
    s_add_u32 s62, s99, 180224
    buffer_load_dwordx4 v105, s[32:35], s62 offen lds
    v_lshlrev_b32 v109, 4, v1
    s_lshl_b32 s62, s46, 1
    s_add_u32 s62, s62, s49
    s_mul_i32 s70, s62, 88
    s_lshl_b32 s63, s50, 3
    s_add_u32 s71, s70, s63
    s_lshl_b32 s71, s71, 10
    s_add_u32 s71, s71, 9699328
    s_mul_i32 s63, s50, 14
    s_add_u32 s70, s70, s63
    s_add_u32 s70, s70, 32
    s_lshl_b32 s70, s70, 10
    s_add_u32 s70, s70, 9699328
    s_cmp_eq_u32 s48, 0
    s_cbranch_scc0 parallel_sum__grouped_kv_mqa__mixer_gmlp__prompt_kernel_p3_hw
    s_lshl_b32 s62, s46, 10
    s_add_u32 s62, s62, 15466504
    v_lshlrev_b32 v8, 7, v1
    v_add_u32 v8, s62, v8
    v_min_u32 v8, 15499260, v8
    s_mov_b32 s63, 0
    v_cmp_gt_u32 s[64:65], 8, v1
parallel_sum__grouped_kv_mqa__mixer_gmlp__prompt_kernel_p3_ho_poll:
    buffer_load_dword v9, v8, s[4:7], 0 offen sc1
    s_waitcnt vmcnt(0)
    v_cmp_ne_u32 vcc, 0, v9
    s_nop 1
    s_and_b64 vcc, vcc, s[64:65]
    s_cmp_eq_u64 vcc, s[64:65]
    s_cbranch_scc1 parallel_sum__grouped_kv_mqa__mixer_gmlp__prompt_kernel_p3_ho_done
    s_add_u32 s63, s63, 1
    s_cmp_lt_u32 s63, 100000
    s_cbranch_scc1 parallel_sum__grouped_kv_mqa__mixer_gmlp__prompt_kernel_p3_ho_poll
parallel_sum__grouped_kv_mqa__mixer_gmlp__prompt_kernel_p3_ho_done:
parallel_sum__grouped_kv_mqa__mixer_gmlp__prompt_kernel_p3_hw:
    s_waitcnt vmcnt(0)
    s_barrier
    s_add_u32 s63, s71, 0
    buffer_load_dwordx4 v[128:131], v109, s[4:7], s63 offen offset:0 sc1
    s_add_u32 s63, s71, 0
    buffer_load_dwordx4 v[132:135], v109, s[4:7], s63 offen offset:1024 sc1
    s_add_u32 s63, s71, 0
    buffer_load_dwordx4 v[136:139], v109, s[4:7], s63 offen offset:2048 sc1
    s_add_u32 s63, s71, 0
    buffer_load_dwordx4 v[140:143], v109, s[4:7], s63 offen offset:3072 sc1
    s_add_u32 s63, s71, 4096
    buffer_load_dwordx4 v[144:147], v109, s[4:7], s63 offen offset:0 sc1
    s_add_u32 s63, s71, 4096
    buffer_load_dwordx4 v[148:151], v109, s[4:7], s63 offen offset:1024 sc1
    s_add_u32 s63, s71, 4096
    buffer_load_dwordx4 v[152:155], v109, s[4:7], s63 offen offset:2048 sc1
    s_add_u32 s63, s71, 4096
    buffer_load_dwordx4 v[156:159], v109, s[4:7], s63 offen offset:3072 sc1
    s_add_u32 s63, s70, 0
    buffer_load_dwordx4 v[160:163], v109, s[4:7], s63 offen offset:0 sc1
    s_add_u32 s63, s70, 0
    buffer_load_dwordx4 v[164:167], v109, s[4:7], s63 offen offset:1024 sc1
    s_add_u32 s63, s70, 0
    buffer_load_dwordx4 v[168:171], v109, s[4:7], s63 offen offset:2048 sc1
    s_add_u32 s63, s70, 0
    buffer_load_dwordx4 v[172:175], v109, s[4:7], s63 offen offset:3072 sc1
    s_add_u32 s63, s70, 4096
    buffer_load_dwordx4 v[176:179], v109, s[4:7], s63 offen offset:0 sc1
    s_add_u32 s63, s70, 4096
    buffer_load_dwordx4 v[180:183], v109, s[4:7], s63 offen offset:1024 sc1
    s_add_u32 s63, s70, 4096
    buffer_load_dwordx4 v[184:187], v109, s[4:7], s63 offen offset:2048 sc1
    s_add_u32 s63, s70, 4096
    buffer_load_dwordx4 v[188:191], v109, s[4:7], s63 offen offset:3072 sc1
    s_add_u32 s63, s70, 8192
    buffer_load_dwordx4 v[192:195], v109, s[4:7], s63 offen offset:0 sc1
    s_add_u32 s63, s70, 8192
    buffer_load_dwordx4 v[196:199], v109, s[4:7], s63 offen offset:1024 sc1
    s_add_u32 s63, s70, 8192
    buffer_load_dwordx4 v[200:203], v109, s[4:7], s63 offen offset:2048 sc1
    s_add_u32 s63, s70, 8192
    buffer_load_dwordx4 v[204:207], v109, s[4:7], s63 offen offset:3072 sc1
    s_add_u32 s63, s70, 12288
    buffer_load_dwordx4 v[208:211], v109, s[4:7], s63 offen offset:0 sc1
    s_add_u32 s63, s70, 12288
    buffer_load_dwordx4 v[212:215], v109, s[4:7], s63 offen offset:1024 sc1
    s_lshl_b32 s62, s46, 6
    s_lshl_b32 s63, s49, 5
    s_add_u32 s62, s62, s63
    v_add_u32 v16, s62, v3
    v_lshlrev_b32 v16, 10, v16
    v_lshl_add_u32 v16, v2, 3, v16
    s_lshl_b32 s62, s47, 7
    s_lshl_b32 s63, s50, 5
    s_add_u32 s62, s62, s63
    v_add_u32 v16, s62, v16
    buffer_load_dwordx2 v[18:19], v16, s[8:11], 0 offen
    buffer_load_dwordx2 v[20:21], v16, s[8:11], 0 offen offset:16
    ds_read_b64_tr_b16 v[24:25], v107 offset:0
    ds_read_b64_tr_b16 v[26:27], v107 offset:1024
    ds_read_b64_tr_b16 v[28:29], v107 offset:256
    ds_read_b64_tr_b16 v[30:31], v107 offset:1280
    ds_read_b64_tr_b16 v[32:33], v107 offset:2048
    ds_read_b64_tr_b16 v[34:35], v107 offset:3072
    ds_read_b64_tr_b16 v[36:37], v107 offset:2304
    ds_read_b64_tr_b16 v[38:39], v107 offset:3328
    s_waitcnt vmcnt(23) lgkmcnt(4)
    v_mfma_f32_32x32x16_bf16 v[40:55], v[24:27], v[128:131], 0
    v_mfma_f32_32x32x16_bf16 v[56:71], v[28:31], v[128:131], 0
    ds_read_b64_tr_b16 v[24:25], v107 offset:4096
    ds_read_b64_tr_b16 v[26:27], v107 offset:5120
    ds_read_b64_tr_b16 v[28:29], v107 offset:4352
    ds_read_b64_tr_b16 v[30:31], v107 offset:5376
    s_waitcnt vmcnt(22) lgkmcnt(4)
    v_mfma_f32_32x32x16_bf16 v[40:55], v[32:35], v[132:135], v[40:55]
    v_mfma_f32_32x32x16_bf16 v[56:71], v[36:39], v[132:135], v[56:71]
    ds_read_b64_tr_b16 v[32:33], v107 offset:6144
    ds_read_b64_tr_b16 v[34:35], v107 offset:7168
    ds_read_b64_tr_b16 v[36:37], v107 offset:6400
    ds_read_b64_tr_b16 v[38:39], v107 offset:7424
    s_waitcnt vmcnt(21) lgkmcnt(4)
    v_mfma_f32_32x32x16_bf16 v[40:55], v[24:27], v[136:139], v[40:55]
    v_mfma_f32_32x32x16_bf16 v[56:71], v[28:31], v[136:139], v[56:71]
    ds_read_b64_tr_b16 v[24:25], v107 offset:8192
    ds_read_b64_tr_b16 v[26:27], v107 offset:9216
    ds_read_b64_tr_b16 v[28:29], v107 offset:8448
    ds_read_b64_tr_b16 v[30:31], v107 offset:9472
    s_waitcnt vmcnt(20) lgkmcnt(4)
    v_mfma_f32_32x32x16_bf16 v[40:55], v[32:35], v[140:143], v[40:55]
    v_mfma_f32_32x32x16_bf16 v[56:71], v[36:39], v[140:143], v[56:71]
    ds_read_b64_tr_b16 v[32:33], v107 offset:10240
    ds_read_b64_tr_b16 v[34:35], v107 offset:11264
    ds_read_b64_tr_b16 v[36:37], v107 offset:10496
    ds_read_b64_tr_b16 v[38:39], v107 offset:11520
    s_waitcnt vmcnt(19) lgkmcnt(4)
    v_mfma_f32_32x32x16_bf16 v[40:55], v[24:27], v[144:147], v[40:55]
    v_mfma_f32_32x32x16_bf16 v[56:71], v[28:31], v[144:147], v[56:71]
    ds_read_b64_tr_b16 v[24:25], v107 offset:12288
    ds_read_b64_tr_b16 v[26:27], v107 offset:13312
    ds_read_b64_tr_b16 v[28:29], v107 offset:12544
    ds_read_b64_tr_b16 v[30:31], v107 offset:13568
    s_waitcnt vmcnt(18) lgkmcnt(4)
    v_mfma_f32_32x32x16_bf16 v[40:55], v[32:35], v[148:151], v[40:55]
    v_mfma_f32_32x32x16_bf16 v[56:71], v[36:39], v[148:151], v[56:71]
    ds_read_b64_tr_b16 v[32:33], v107 offset:14336
    ds_read_b64_tr_b16 v[34:35], v107 offset:15360
    ds_read_b64_tr_b16 v[36:37], v107 offset:14592
    ds_read_b64_tr_b16 v[38:39], v107 offset:15616
    s_waitcnt vmcnt(17) lgkmcnt(4)
    v_mfma_f32_32x32x16_bf16 v[40:55], v[24:27], v[152:155], v[40:55]
    v_mfma_f32_32x32x16_bf16 v[56:71], v[28:31], v[152:155], v[56:71]
    ds_read_b64_tr_b16 v[24:25], v106 offset:0
    ds_read_b64_tr_b16 v[26:27], v106 offset:1024
    ds_read_b64_tr_b16 v[28:29], v106 offset:256
    ds_read_b64_tr_b16 v[30:31], v106 offset:1280
    s_waitcnt vmcnt(16) lgkmcnt(4)
    v_mfma_f32_32x32x16_bf16 v[40:55], v[32:35], v[156:159], v[40:55]
    v_mfma_f32_32x32x16_bf16 v[56:71], v[36:39], v[156:159], v[56:71]
    ds_read_b64_tr_b16 v[32:33], v106 offset:8192
    ds_read_b64_tr_b16 v[34:35], v106 offset:9216
    ds_read_b64_tr_b16 v[36:37], v106 offset:8448
    ds_read_b64_tr_b16 v[38:39], v106 offset:9472
    s_waitcnt vmcnt(15) lgkmcnt(4)
    v_mfma_f32_32x32x16_bf16 v[40:55], v[24:27], v[160:163], v[40:55]
    v_mfma_f32_32x32x16_bf16 v[56:71], v[28:31], v[160:163], v[56:71]
    ds_read_b64_tr_b16 v[24:25], v106 offset:16384
    ds_read_b64_tr_b16 v[26:27], v106 offset:17408
    ds_read_b64_tr_b16 v[28:29], v106 offset:16640
    ds_read_b64_tr_b16 v[30:31], v106 offset:17664
    s_waitcnt vmcnt(14) lgkmcnt(4)
    v_mfma_f32_32x32x16_bf16 v[40:55], v[32:35], v[164:167], v[40:55]
    v_mfma_f32_32x32x16_bf16 v[56:71], v[36:39], v[164:167], v[56:71]
    ds_read_b64_tr_b16 v[32:33], v106 offset:24576
    ds_read_b64_tr_b16 v[34:35], v106 offset:25600
    ds_read_b64_tr_b16 v[36:37], v106 offset:24832
    ds_read_b64_tr_b16 v[38:39], v106 offset:25856
    s_waitcnt vmcnt(13) lgkmcnt(4)
    v_mfma_f32_32x32x16_bf16 v[40:55], v[24:27], v[168:171], v[40:55]
    v_mfma_f32_32x32x16_bf16 v[56:71], v[28:31], v[168:171], v[56:71]
    ds_read_b64_tr_b16 v[24:25], v106 offset:32768
    ds_read_b64_tr_b16 v[26:27], v106 offset:33792
    ds_read_b64_tr_b16 v[28:29], v106 offset:33024
    ds_read_b64_tr_b16 v[30:31], v106 offset:34048
    s_waitcnt vmcnt(12) lgkmcnt(4)
    v_mfma_f32_32x32x16_bf16 v[40:55], v[32:35], v[172:175], v[40:55]
    v_mfma_f32_32x32x16_bf16 v[56:71], v[36:39], v[172:175], v[56:71]
    ds_read_b64_tr_b16 v[32:33], v106 offset:40960
    ds_read_b64_tr_b16 v[34:35], v106 offset:41984
    ds_read_b64_tr_b16 v[36:37], v106 offset:41216
    ds_read_b64_tr_b16 v[38:39], v106 offset:42240
    s_waitcnt vmcnt(11) lgkmcnt(4)
    v_mfma_f32_32x32x16_bf16 v[40:55], v[24:27], v[176:179], v[40:55]
    v_mfma_f32_32x32x16_bf16 v[56:71], v[28:31], v[176:179], v[56:71]
    ds_read_b64_tr_b16 v[24:25], v106 offset:49152
    ds_read_b64_tr_b16 v[26:27], v106 offset:50176
    ds_read_b64_tr_b16 v[28:29], v106 offset:49408
    ds_read_b64_tr_b16 v[30:31], v106 offset:50432
    s_waitcnt vmcnt(10) lgkmcnt(4)
    v_mfma_f32_32x32x16_bf16 v[40:55], v[32:35], v[180:183], v[40:55]
    v_mfma_f32_32x32x16_bf16 v[56:71], v[36:39], v[180:183], v[56:71]
    ds_read_b64_tr_b16 v[32:33], v106 offset:57344
    ds_read_b64_tr_b16 v[34:35], v106 offset:58368
    ds_read_b64_tr_b16 v[36:37], v106 offset:57600
    ds_read_b64_tr_b16 v[38:39], v106 offset:58624
    s_waitcnt vmcnt(9) lgkmcnt(4)
    v_mfma_f32_32x32x16_bf16 v[40:55], v[24:27], v[184:187], v[40:55]
    v_mfma_f32_32x32x16_bf16 v[56:71], v[28:31], v[184:187], v[56:71]
    ds_read_b64_tr_b16 v[24:25], v108 offset:0
    ds_read_b64_tr_b16 v[26:27], v108 offset:1024
    ds_read_b64_tr_b16 v[28:29], v108 offset:256
    ds_read_b64_tr_b16 v[30:31], v108 offset:1280
    s_waitcnt vmcnt(8) lgkmcnt(4)
    v_mfma_f32_32x32x16_bf16 v[40:55], v[32:35], v[188:191], v[40:55]
    v_mfma_f32_32x32x16_bf16 v[56:71], v[36:39], v[188:191], v[56:71]
    ds_read_b64_tr_b16 v[32:33], v108 offset:8192
    ds_read_b64_tr_b16 v[34:35], v108 offset:9216
    ds_read_b64_tr_b16 v[36:37], v108 offset:8448
    ds_read_b64_tr_b16 v[38:39], v108 offset:9472
    s_waitcnt vmcnt(7) lgkmcnt(4)
    v_mfma_f32_32x32x16_bf16 v[40:55], v[24:27], v[192:195], v[40:55]
    v_mfma_f32_32x32x16_bf16 v[56:71], v[28:31], v[192:195], v[56:71]
    ds_read_b64_tr_b16 v[24:25], v108 offset:16384
    ds_read_b64_tr_b16 v[26:27], v108 offset:17408
    ds_read_b64_tr_b16 v[28:29], v108 offset:16640
    ds_read_b64_tr_b16 v[30:31], v108 offset:17664
    s_waitcnt vmcnt(6) lgkmcnt(4)
    v_mfma_f32_32x32x16_bf16 v[40:55], v[32:35], v[196:199], v[40:55]
    v_mfma_f32_32x32x16_bf16 v[56:71], v[36:39], v[196:199], v[56:71]
    ds_read_b64_tr_b16 v[32:33], v108 offset:24576
    ds_read_b64_tr_b16 v[34:35], v108 offset:25600
    ds_read_b64_tr_b16 v[36:37], v108 offset:24832
    ds_read_b64_tr_b16 v[38:39], v108 offset:25856
    s_waitcnt vmcnt(5) lgkmcnt(4)
    v_mfma_f32_32x32x16_bf16 v[40:55], v[24:27], v[200:203], v[40:55]
    v_mfma_f32_32x32x16_bf16 v[56:71], v[28:31], v[200:203], v[56:71]
    s_waitcnt vmcnt(4) lgkmcnt(0)
    v_mfma_f32_32x32x16_bf16 v[40:55], v[32:35], v[204:207], v[40:55]
    v_mfma_f32_32x32x16_bf16 v[56:71], v[36:39], v[204:207], v[56:71]
    s_waitcnt vmcnt(3)
    v_mfma_f32_32x32x16_bf16 v[40:55], v[240:243], v[208:211], v[40:55]
    v_mfma_f32_32x32x16_bf16 v[56:71], v[244:247], v[208:211], v[56:71]
    s_waitcnt vmcnt(2)
    v_mfma_f32_32x32x16_bf16 v[40:55], v[248:251], v[212:215], v[40:55]
    v_mfma_f32_32x32x16_bf16 v[56:71], v[252:255], v[212:215], v[56:71]
    s_nop 7
    s_nop 7
    s_waitcnt lgkmcnt(0)
    s_barrier
    v_lshlrev_b32 v14, 4, v1
    s_lshl_b32 s62, s49, 15
    s_lshl_b32 s63, s50, 11
    s_add_u32 s63, s63, s62
    v_add_u32 v15, s63, v14
    s_cmp_eq_u32 s50, 0
    s_cbranch_scc0 R3_4184_1
    ds_write_b128 v15, v[48:51] offset:8192
    ds_write_b128 v15, v[52:55] offset:9216
    ds_write_b128 v15, v[56:59] offset:16384
    ds_write_b128 v15, v[60:63] offset:17408
    ds_write_b128 v15, v[64:67] offset:24576
    ds_write_b128 v15, v[68:71] offset:25600
    v_mov_b32 v152, v40
    v_mov_b32 v153, v41
    v_mov_b32 v154, v42
    v_mov_b32 v155, v43
    v_mov_b32 v156, v44
    v_mov_b32 v157, v45
    v_mov_b32 v158, v46
    v_mov_b32 v159, v47
    s_branch R3_4184_e
R3_4184_1:
    s_cmp_eq_u32 s50, 1
    s_cbranch_scc0 R3_4184_2
    ds_write_b128 v15, v[40:43] offset:0
    ds_write_b128 v15, v[44:47] offset:1024
    ds_write_b128 v15, v[56:59] offset:16384
    ds_write_b128 v15, v[60:63] offset:17408
    ds_write_b128 v15, v[64:67] offset:24576
    ds_write_b128 v15, v[68:71] offset:25600
    v_mov_b32 v152, v48
    v_mov_b32 v153, v49
    v_mov_b32 v154, v50
    v_mov_b32 v155, v51
    v_mov_b32 v156, v52
    v_mov_b32 v157, v53
    v_mov_b32 v158, v54
    v_mov_b32 v159, v55
    s_branch R3_4184_e
R3_4184_2:
    s_cmp_eq_u32 s50, 2
    s_cbranch_scc0 R3_4184_3
    ds_write_b128 v15, v[40:43] offset:0
    ds_write_b128 v15, v[44:47] offset:1024
    ds_write_b128 v15, v[48:51] offset:8192
    ds_write_b128 v15, v[52:55] offset:9216
    ds_write_b128 v15, v[64:67] offset:24576
    ds_write_b128 v15, v[68:71] offset:25600
    v_mov_b32 v152, v56
    v_mov_b32 v153, v57
    v_mov_b32 v154, v58
    v_mov_b32 v155, v59
    v_mov_b32 v156, v60
    v_mov_b32 v157, v61
    v_mov_b32 v158, v62
    v_mov_b32 v159, v63
    s_branch R3_4184_e
R3_4184_3:
    ds_write_b128 v15, v[40:43] offset:0
    ds_write_b128 v15, v[44:47] offset:1024
    ds_write_b128 v15, v[48:51] offset:8192
    ds_write_b128 v15, v[52:55] offset:9216
    ds_write_b128 v15, v[56:59] offset:16384
    ds_write_b128 v15, v[60:63] offset:17408
    v_mov_b32 v152, v64
    v_mov_b32 v153, v65
    v_mov_b32 v154, v66
    v_mov_b32 v155, v67
    v_mov_b32 v156, v68
    v_mov_b32 v157, v69
    v_mov_b32 v158, v70
    v_mov_b32 v159, v71
R3_4184_e:
    s_lshl_b32 s63, s50, 13
    s_add_u32 s63, s63, s62
    v_add_u32 v15, s63, v14
    s_xor_b32 s64, s50, 1
    s_lshl_b32 s64, s64, 11
    v_add_u32 v8, s64, v15
    s_xor_b32 s64, s50, 2
    s_lshl_b32 s64, s64, 11
    v_add_u32 v9, s64, v15
    s_xor_b32 s64, s50, 3
    s_lshl_b32 s64, s64, 11
    v_add_u32 v10, s64, v15
    s_waitcnt lgkmcnt(0)
    s_barrier
    ds_read_b128 v[128:131], v8
    ds_read_b128 v[132:135], v8 offset:1024
    ds_read_b128 v[136:139], v9
    ds_read_b128 v[140:143], v9 offset:1024
    ds_read_b128 v[144:147], v10
    ds_read_b128 v[148:151], v10 offset:1024
    s_waitcnt lgkmcnt(0)
    v_add_f32 v128, v128, v136
    v_add_f32 v144, v144, v152
    v_add_f32 v129, v129, v137
    v_add_f32 v145, v145, v153
    v_add_f32 v130, v130, v138
    v_add_f32 v146, v146, v154
    v_add_f32 v131, v131, v139
    v_add_f32 v147, v147, v155
    v_add_f32 v132, v132, v140
    v_add_f32 v148, v148, v156
    v_add_f32 v133, v133, v141
    v_add_f32 v149, v149, v157
    v_add_f32 v134, v134, v142
    v_add_f32 v150, v150, v158
    v_add_f32 v135, v135, v143
    v_add_f32 v151, v151, v159
    v_add_f32 v128, v128, v144
    v_add_f32 v129, v129, v145
    v_add_f32 v130, v130, v146
    v_add_f32 v131, v131, v147
    v_add_f32 v132, v132, v148
    v_add_f32 v133, v133, v149
    v_add_f32 v134, v134, v150
    v_add_f32 v135, v135, v151
    s_waitcnt vmcnt(0)
    v_lshlrev_b32 v22, 16, v18
    v_and_b32 v23, 0xffff0000, v18
    v_add_f32 v128, v128, v22
    v_add_f32 v129, v129, v23
    v_cvt_pk_bf16_f32 v144, v128, v129
    v_lshlrev_b32 v22, 16, v19
    v_and_b32 v23, 0xffff0000, v19
    v_add_f32 v130, v130, v22
    v_add_f32 v131, v131, v23
    v_cvt_pk_bf16_f32 v145, v130, v131
    v_lshlrev_b32 v22, 16, v20
    v_and_b32 v23, 0xffff0000, v20
    v_add_f32 v132, v132, v22
    v_add_f32 v133, v133, v23
    v_cvt_pk_bf16_f32 v146, v132, v133
    v_lshlrev_b32 v22, 16, v21
    v_and_b32 v23, 0xffff0000, v21
    v_add_f32 v134, v134, v22
    v_add_f32 v135, v135, v23
    v_cvt_pk_bf16_f32 v147, v134, v135
    buffer_store_dwordx2 v[144:145], v16, s[36:39], 0 offen
    buffer_store_dwordx2 v[146:147], v16, s[36:39], 0 offen offset:16
parallel_sum__grouped_kv_mqa__mixer_gmlp__prompt_kernel_exit:
    s_endpgm
parallel_sum__grouped_kv_mqa__mixer_gmlp__prompt_kernel_j7:
    v_lshlrev_b32 v6, 9, v2
    v_add_u32 v6, v6, v25
    v_add_u32 v7, 131072, v6
    v_lshl_add_u32 v30, v24, 2, v22
    s_lshl_b32 s62, s48, 5
    v_add_u32 v30, s62, v30
    v_lshlrev_b32 v30, 5, v30
    v_and_b32 v31, 1, v23
    v_lshl_add_u32 v30, v31, 4, v30
    v_cmp_gt_u32 vcc, 2, v23
    v_mov_b32 v26, s42
    v_mov_b32 v27, s43
    v_mov_b32 v28, s40
    v_mov_b32 v29, s41
    v_cndmask_b32 v26, v26, v28, vcc
    v_cndmask_b32 v27, v27, v29, vcc
    v_add_co_u32 v26, vcc, v26, v30
    s_nop 1
    v_addc_co_u32 v27, vcc, 0, v27, vcc
    s_add_u32 m0, s60, 0
    v_add_co_u32 v28, vcc, 0, v26
    s_nop 1
    v_addc_co_u32 v29, vcc, 0, v27, vcc
    global_load_lds_dwordx4 v[28:29], off
    s_add_u32 m0, s60, 1024
    v_add_co_u32 v28, vcc, 512, v26
    s_nop 1
    v_addc_co_u32 v29, vcc, 0, v27, vcc
    global_load_lds_dwordx4 v[28:29], off
    s_add_u32 m0, s60, 16384
    v_add_co_u32 v28, vcc, 8192, v26
    s_nop 1
    v_addc_co_u32 v29, vcc, 0, v27, vcc
    global_load_lds_dwordx4 v[28:29], off
    s_add_u32 m0, s60, 17408
    v_add_co_u32 v28, vcc, 8704, v26
    s_nop 1
    v_addc_co_u32 v29, vcc, 0, v27, vcc
    global_load_lds_dwordx4 v[28:29], off
    s_add_u32 s57, s59, 0
    s_add_u32 m0, s60, 32768
    s_nop 0
    buffer_load_dwordx4 v5, s[12:15], s57 offen lds
    s_add_u32 s57, s59, 8192
    s_add_u32 m0, s60, 33792
    s_nop 0
    buffer_load_dwordx4 v5, s[12:15], s57 offen lds
    s_add_u32 s57, s59, 131072
    s_add_u32 m0, s60, 49152
    s_nop 0
    buffer_load_dwordx4 v5, s[12:15], s57 offen lds
    s_add_u32 s57, s59, 139264
    s_add_u32 m0, s60, 50176
    s_nop 0
    buffer_load_dwordx4 v5, s[12:15], s57 offen lds
    v_lshrrev_b32 v31, 3, v1
    s_lshl_b32 s62, s46, 6
    s_lshl_b32 s63, s48, 3
    s_add_u32 s62, s62, s63
    v_add_u32 v31, s62, v31
    v_lshlrev_b32 v113, 12, v31
    s_and_b32 s62, s48, 1
    s_lshl_b32 s62, s62, 2
    v_lshrrev_b32 v31, 4, v1
    v_add_u32 v31, s62, v31
    v_xor_b32 v31, v31, v1
    v_and_b32 v31, 7, v31
    v_lshl_add_u32 v113, v31, 4, v113
    v_and_b32 v31, 15, v1
    v_lshlrev_b32 v31, 4, v31
    s_and_b32 s62, s48, 1
    s_lshl_b32 s62, s62, 8
    v_add_u32 v31, s62, v31
    s_lshr_b32 s63, s48, 1
    s_cmp_lt_u32 s63, 2
    s_cselect_b32 s64, 9, 10
    v_lshlrev_b32 v114, s64, v2
    v_add_u32 v114, v114, v31
    s_lshl_b32 s64, s63, 10
    s_add_u32 s64, s64, 2097152
    s_mov_b32 s65, 2162688
    s_cmp_eq_u32 s63, 2
    s_cselect_b32 s64, s65, s64
    s_mov_b32 s65, 2161152
    s_cmp_eq_u32 s63, 3
    s_cselect_b32 s64, s65, s64
    v_add_u32 v114, s64, v114
    s_lshl_b32 s62, s47, 2
    s_add_u32 s62, s62, s50
    s_lshl_b32 s62, s62, 7
    s_lshl_b32 s63, s49, 1
    s_add_u32 s62, s62, s63
    s_lshl_b32 s62, s62, 10
    s_add_u32 s62, s62, 6029312
    v_lshlrev_b32 v31, 4, v1
    v_add_u32 v115, s62, v31
    s_lshl_b32 s62, s49, 10
    s_add_u32 s62, s62, 8192
    v_add_u32 v116, s62, v31
    v_and_b32 v31, 15, v1
    v_lshlrev_b32 v31, 4, v31
    v_lshl_add_u32 v117, v2, 8, v31
    s_lshl_b32 s62, s49, 9
    s_add_u32 s62, s62, 10240
    v_add_u32 v117, s62, v117
    v_lshrrev_b32 v31, 1, v3
    s_lshl_b32 s62, s49, 2
    v_add_u32 v118, s62, v2
    v_xor_b32 v118, v118, v31
    v_and_b32 v118, 7, v118
    v_xor_b32 v119, 2, v118
    v_lshlrev_b32 v31, 7, v3
    v_lshl_add_u32 v118, v118, 4, v31
    v_lshl_add_u32 v119, v119, 4, v31
    s_waitcnt vmcnt(8)
    s_cmp_eq_u32 s48, 7
    s_cbranch_scc0 parallel_sum__grouped_kv_mqa__mixer_gmlp__prompt_kernel_b1_nocnt
    s_and_b32 s62, s2, 1
    s_lshl_b32 s62, s62, 7
    v_mov_b32 v26, s62
    v_mov_b32 v27, 1
    s_mov_b64 exec, 1
    global_atomic_add v26, v27, s[44:45] sc1
    s_mov_b64 exec, -1
parallel_sum__grouped_kv_mqa__mixer_gmlp__prompt_kernel_b1_nocnt:
    v_mov_b32 v19, 0x3f803f80
    v_mov_b32 v17, 0
    v_mov_b32 v18, 0
    v_mov_b32 v20, 0
    v_mov_b32 v21, 0
    v_dot2_f32_bf16 v17, v64, v19, v17
    v_dot2_f32_bf16 v18, v64, v64, v18
    v_dot2_f32_bf16 v20, v65, v19, v20
    v_dot2_f32_bf16 v21, v65, v65, v21
    v_dot2_f32_bf16 v17, v66, v19, v17
    v_dot2_f32_bf16 v18, v66, v66, v18
    v_dot2_f32_bf16 v20, v67, v19, v20
    v_dot2_f32_bf16 v21, v67, v67, v21
    v_dot2_f32_bf16 v17, v68, v19, v17
    v_dot2_f32_bf16 v18, v68, v68, v18
    v_dot2_f32_bf16 v20, v69, v19, v20
    v_dot2_f32_bf16 v21, v69, v69, v21
    v_dot2_f32_bf16 v17, v70, v19, v17
    v_dot2_f32_bf16 v18, v70, v70, v18
    v_dot2_f32_bf16 v20, v71, v19, v20
    v_dot2_f32_bf16 v21, v71, v71, v21
    v_dot2_f32_bf16 v17, v72, v19, v17
    v_dot2_f32_bf16 v18, v72, v72, v18
    v_dot2_f32_bf16 v20, v73, v19, v20
    v_dot2_f32_bf16 v21, v73, v73, v21
    v_dot2_f32_bf16 v17, v74, v19, v17
    v_dot2_f32_bf16 v18, v74, v74, v18
    v_dot2_f32_bf16 v20, v75, v19, v20
    v_dot2_f32_bf16 v21, v75, v75, v21
    v_dot2_f32_bf16 v17, v76, v19, v17
    v_dot2_f32_bf16 v18, v76, v76, v18
    v_dot2_f32_bf16 v20, v77, v19, v20
    v_dot2_f32_bf16 v21, v77, v77, v21
    v_dot2_f32_bf16 v17, v78, v19, v17
    v_dot2_f32_bf16 v18, v78, v78, v18
    v_dot2_f32_bf16 v20, v79, v19, v20
    v_dot2_f32_bf16 v21, v79, v79, v21
    v_dot2_f32_bf16 v17, v80, v19, v17
    v_dot2_f32_bf16 v18, v80, v80, v18
    v_dot2_f32_bf16 v20, v81, v19, v20
    v_dot2_f32_bf16 v21, v81, v81, v21
    v_dot2_f32_bf16 v17, v82, v19, v17
    v_dot2_f32_bf16 v18, v82, v82, v18
    v_dot2_f32_bf16 v20, v83, v19, v20
    v_dot2_f32_bf16 v21, v83, v83, v21
    v_dot2_f32_bf16 v17, v84, v19, v17
    v_dot2_f32_bf16 v18, v84, v84, v18
    v_dot2_f32_bf16 v20, v85, v19, v20
    v_dot2_f32_bf16 v21, v85, v85, v21
    v_dot2_f32_bf16 v17, v86, v19, v17
    v_dot2_f32_bf16 v18, v86, v86, v18
    v_dot2_f32_bf16 v20, v87, v19, v20
    v_dot2_f32_bf16 v21, v87, v87, v21
    v_dot2_f32_bf16 v17, v88, v19, v17
    v_dot2_f32_bf16 v18, v88, v88, v18
    v_dot2_f32_bf16 v20, v89, v19, v20
    v_dot2_f32_bf16 v21, v89, v89, v21
    v_dot2_f32_bf16 v17, v90, v19, v17
    v_dot2_f32_bf16 v18, v90, v90, v18
    v_dot2_f32_bf16 v20, v91, v19, v20
    v_dot2_f32_bf16 v21, v91, v91, v21
    v_dot2_f32_bf16 v17, v92, v19, v17
    v_dot2_f32_bf16 v18, v92, v92, v18
    v_dot2_f32_bf16 v20, v93, v19, v20
    v_dot2_f32_bf16 v21, v93, v93, v21
    v_dot2_f32_bf16 v17, v94, v19, v17
    v_dot2_f32_bf16 v18, v94, v94, v18
    v_dot2_f32_bf16 v20, v95, v19, v20
    v_dot2_f32_bf16 v21, v95, v95, v21
    s_nop 1
    v_add_f32 v17, v17, v20
    v_add_f32 v18, v18, v21
    s_nop 1
    v_add_f32_dpp v17, v17, v17 quad_perm:[1,0,3,2] row_mask:0xf bank_mask:0xf
    v_add_f32_dpp v18, v18, v18 quad_perm:[1,0,3,2] row_mask:0xf bank_mask:0xf
    s_nop 1
    v_add_f32_dpp v17, v17, v17 quad_perm:[2,3,0,1] row_mask:0xf bank_mask:0xf
    v_add_f32_dpp v18, v18, v18 quad_perm:[2,3,0,1] row_mask:0xf bank_mask:0xf
    s_nop 1
    v_add_f32_dpp v17, v17, v17 row_half_mirror row_mask:0xf bank_mask:0xf
    v_add_f32_dpp v18, v18, v18 row_half_mirror row_mask:0xf bank_mask:0xf
    s_nop 0
    v_mul_f32 v17, 989855744, v17
    v_mul_f32 v18, 989855744, v18
    v_fma_f32 v18, -v17, v17, v18
    v_max_f32 v18, 0, v18
    v_add_f32 v18, 925353388, v18
    v_rsq_f32 v18, v18
    s_nop 0
    v_mul_f32 v17, v17, v18
    v_sub_f32 v17, 0, v17
    s_and_b32 s62, s48, 3
    s_lshl_b32 s62, s62, 3
    v_add_u32 v22, s62, v15
    v_xor_b32 v22, v22, v14
    v_lshlrev_b32 v22, 4, v22
    v_lshrrev_b32 v23, 1, v14
    v_lshl_add_u32 v22, v23, 10, v22
    v_and_b32 v23, 1, v14
    v_lshl_add_u32 v22, v23, 9, v22
    s_lshl_b32 s62, s49, 15
    s_add_u32 s62, s62, 65536
    v_add_u32 v22, s62, v22
    v_lshlrev_b32 v20, 16, v64
    v_and_b32 v21, 0xffff0000, v64
    v_fma_f32 v20, v20, v18, v17
    v_fma_f32 v21, v21, v18, v17
    v_cvt_pk_bf16_f32 v64, v20, v21
    v_lshlrev_b32 v23, 16, v65
    v_and_b32 v24, 0xffff0000, v65
    v_fma_f32 v23, v23, v18, v17
    v_fma_f32 v24, v24, v18, v17
    v_cvt_pk_bf16_f32 v65, v23, v24
    v_lshlrev_b32 v20, 16, v66
    v_and_b32 v21, 0xffff0000, v66
    v_fma_f32 v20, v20, v18, v17
    v_fma_f32 v21, v21, v18, v17
    v_cvt_pk_bf16_f32 v66, v20, v21
    v_lshlrev_b32 v23, 16, v67
    v_and_b32 v24, 0xffff0000, v67
    v_fma_f32 v23, v23, v18, v17
    v_fma_f32 v24, v24, v18, v17
    v_cvt_pk_bf16_f32 v67, v23, v24
    ds_write_b128 v22, v[64:67] offset:0
    v_lshlrev_b32 v20, 16, v68
    v_and_b32 v21, 0xffff0000, v68
    v_fma_f32 v20, v20, v18, v17
    v_fma_f32 v21, v21, v18, v17
    v_cvt_pk_bf16_f32 v68, v20, v21
    v_lshlrev_b32 v23, 16, v69
    v_and_b32 v24, 0xffff0000, v69
    v_fma_f32 v23, v23, v18, v17
    v_fma_f32 v24, v24, v18, v17
    v_cvt_pk_bf16_f32 v69, v23, v24
    v_lshlrev_b32 v20, 16, v70
    v_and_b32 v21, 0xffff0000, v70
    v_fma_f32 v20, v20, v18, v17
    v_fma_f32 v21, v21, v18, v17
    v_cvt_pk_bf16_f32 v70, v20, v21
    v_lshlrev_b32 v23, 16, v71
    v_and_b32 v24, 0xffff0000, v71
    v_fma_f32 v23, v23, v18, v17
    v_fma_f32 v24, v24, v18, v17
    v_cvt_pk_bf16_f32 v71, v23, v24
    ds_write_b128 v22, v[68:71] offset:4096
    v_lshlrev_b32 v20, 16, v72
    v_and_b32 v21, 0xffff0000, v72
    v_fma_f32 v20, v20, v18, v17
    v_fma_f32 v21, v21, v18, v17
    v_cvt_pk_bf16_f32 v72, v20, v21
    v_lshlrev_b32 v23, 16, v73
    v_and_b32 v24, 0xffff0000, v73
    v_fma_f32 v23, v23, v18, v17
    v_fma_f32 v24, v24, v18, v17
    v_cvt_pk_bf16_f32 v73, v23, v24
    v_lshlrev_b32 v20, 16, v74
    v_and_b32 v21, 0xffff0000, v74
    v_fma_f32 v20, v20, v18, v17
    v_fma_f32 v21, v21, v18, v17
    v_cvt_pk_bf16_f32 v74, v20, v21
    v_lshlrev_b32 v23, 16, v75
    v_and_b32 v24, 0xffff0000, v75
    v_fma_f32 v23, v23, v18, v17
    v_fma_f32 v24, v24, v18, v17
    v_cvt_pk_bf16_f32 v75, v23, v24
    ds_write_b128 v22, v[72:75] offset:8192
    v_lshlrev_b32 v20, 16, v76
    v_and_b32 v21, 0xffff0000, v76
    v_fma_f32 v20, v20, v18, v17
    v_fma_f32 v21, v21, v18, v17
    v_cvt_pk_bf16_f32 v76, v20, v21
    v_lshlrev_b32 v23, 16, v77
    v_and_b32 v24, 0xffff0000, v77
    v_fma_f32 v23, v23, v18, v17
    v_fma_f32 v24, v24, v18, v17
    v_cvt_pk_bf16_f32 v77, v23, v24
    v_lshlrev_b32 v20, 16, v78
    v_and_b32 v21, 0xffff0000, v78
    v_fma_f32 v20, v20, v18, v17
    v_fma_f32 v21, v21, v18, v17
    v_cvt_pk_bf16_f32 v78, v20, v21
    v_lshlrev_b32 v23, 16, v79
    v_and_b32 v24, 0xffff0000, v79
    v_fma_f32 v23, v23, v18, v17
    v_fma_f32 v24, v24, v18, v17
    v_cvt_pk_bf16_f32 v79, v23, v24
    ds_write_b128 v22, v[76:79] offset:12288
    v_lshlrev_b32 v20, 16, v80
    v_and_b32 v21, 0xffff0000, v80
    v_fma_f32 v20, v20, v18, v17
    v_fma_f32 v21, v21, v18, v17
    v_cvt_pk_bf16_f32 v80, v20, v21
    v_lshlrev_b32 v23, 16, v81
    v_and_b32 v24, 0xffff0000, v81
    v_fma_f32 v23, v23, v18, v17
    v_fma_f32 v24, v24, v18, v17
    v_cvt_pk_bf16_f32 v81, v23, v24
    v_lshlrev_b32 v20, 16, v82
    v_and_b32 v21, 0xffff0000, v82
    v_fma_f32 v20, v20, v18, v17
    v_fma_f32 v21, v21, v18, v17
    v_cvt_pk_bf16_f32 v82, v20, v21
    v_lshlrev_b32 v23, 16, v83
    v_and_b32 v24, 0xffff0000, v83
    v_fma_f32 v23, v23, v18, v17
    v_fma_f32 v24, v24, v18, v17
    v_cvt_pk_bf16_f32 v83, v23, v24
    ds_write_b128 v22, v[80:83] offset:16384
    v_lshlrev_b32 v20, 16, v84
    v_and_b32 v21, 0xffff0000, v84
    v_fma_f32 v20, v20, v18, v17
    v_fma_f32 v21, v21, v18, v17
    v_cvt_pk_bf16_f32 v84, v20, v21
    v_lshlrev_b32 v23, 16, v85
    v_and_b32 v24, 0xffff0000, v85
    v_fma_f32 v23, v23, v18, v17
    v_fma_f32 v24, v24, v18, v17
    v_cvt_pk_bf16_f32 v85, v23, v24
    v_lshlrev_b32 v20, 16, v86
    v_and_b32 v21, 0xffff0000, v86
    v_fma_f32 v20, v20, v18, v17
    v_fma_f32 v21, v21, v18, v17
    v_cvt_pk_bf16_f32 v86, v20, v21
    v_lshlrev_b32 v23, 16, v87
    v_and_b32 v24, 0xffff0000, v87
    v_fma_f32 v23, v23, v18, v17
    v_fma_f32 v24, v24, v18, v17
    v_cvt_pk_bf16_f32 v87, v23, v24
    ds_write_b128 v22, v[84:87] offset:20480
    v_lshlrev_b32 v20, 16, v88
    v_and_b32 v21, 0xffff0000, v88
    v_fma_f32 v20, v20, v18, v17
    v_fma_f32 v21, v21, v18, v17
    v_cvt_pk_bf16_f32 v88, v20, v21
    v_lshlrev_b32 v23, 16, v89
    v_and_b32 v24, 0xffff0000, v89
    v_fma_f32 v23, v23, v18, v17
    v_fma_f32 v24, v24, v18, v17
    v_cvt_pk_bf16_f32 v89, v23, v24
    v_lshlrev_b32 v20, 16, v90
    v_and_b32 v21, 0xffff0000, v90
    v_fma_f32 v20, v20, v18, v17
    v_fma_f32 v21, v21, v18, v17
    v_cvt_pk_bf16_f32 v90, v20, v21
    v_lshlrev_b32 v23, 16, v91
    v_and_b32 v24, 0xffff0000, v91
    v_fma_f32 v23, v23, v18, v17
    v_fma_f32 v24, v24, v18, v17
    v_cvt_pk_bf16_f32 v91, v23, v24
    ds_write_b128 v22, v[88:91] offset:24576
    v_lshlrev_b32 v20, 16, v92
    v_and_b32 v21, 0xffff0000, v92
    v_fma_f32 v20, v20, v18, v17
    v_fma_f32 v21, v21, v18, v17
    v_cvt_pk_bf16_f32 v92, v20, v21
    v_lshlrev_b32 v23, 16, v93
    v_and_b32 v24, 0xffff0000, v93
    v_fma_f32 v23, v23, v18, v17
    v_fma_f32 v24, v24, v18, v17
    v_cvt_pk_bf16_f32 v93, v23, v24
    v_lshlrev_b32 v20, 16, v94
    v_and_b32 v21, 0xffff0000, v94
    v_fma_f32 v20, v20, v18, v17
    v_fma_f32 v21, v21, v18, v17
    v_cvt_pk_bf16_f32 v94, v20, v21
    v_lshlrev_b32 v23, 16, v95
    v_and_b32 v24, 0xffff0000, v95
    v_fma_f32 v23, v23, v18, v17
    v_fma_f32 v24, v24, v18, v17
    v_cvt_pk_bf16_f32 v95, v23, v24
    ds_write_b128 v22, v[92:95] offset:28672
    s_sub_u32 s65, s48, 3
    s_cmp_lt_u32 s65, 2
    s_cbranch_scc0 parallel_sum__grouped_kv_mqa__mixer_gmlp__prompt_kernel_b1_pwx
    s_lshl_b32 s62, s46, 1
    s_add_u32 s62, s62, s65
    s_mul_i32 s62, s62, 6
    v_lshlrev_b32 v30, 6, v1
    s_add_u32 s63, s62, 0
    s_cmp_lt_u32 s63, 128
    s_cbranch_scc0 parallel_sum__grouped_kv_mqa__mixer_gmlp__prompt_kernel_b1_pw0
    s_lshl_b32 s64, s63, 12
    buffer_load_dword v31, v30, s[28:31], s64 offen
    s_branch parallel_sum__grouped_kv_mqa__mixer_gmlp__prompt_kernel_b1_pe0
parallel_sum__grouped_kv_mqa__mixer_gmlp__prompt_kernel_b1_pw0:
    s_sub_u32 s64, s63, 128
    s_lshl_b32 s64, s64, 12
    buffer_load_dword v31, v30, s[32:35], s64 offen
parallel_sum__grouped_kv_mqa__mixer_gmlp__prompt_kernel_b1_pe0:
    s_add_u32 s63, s62, 1
    s_cmp_lt_u32 s63, 128
    s_cbranch_scc0 parallel_sum__grouped_kv_mqa__mixer_gmlp__prompt_kernel_b1_pw1
    s_lshl_b32 s64, s63, 12
    buffer_load_dword v31, v30, s[28:31], s64 offen
    s_branch parallel_sum__grouped_kv_mqa__mixer_gmlp__prompt_kernel_b1_pe1
parallel_sum__grouped_kv_mqa__mixer_gmlp__prompt_kernel_b1_pw1:
    s_sub_u32 s64, s63, 128
    s_lshl_b32 s64, s64, 12
    buffer_load_dword v31, v30, s[32:35], s64 offen
parallel_sum__grouped_kv_mqa__mixer_gmlp__prompt_kernel_b1_pe1:
    s_add_u32 s63, s62, 2
    s_cmp_lt_u32 s63, 128
    s_cbranch_scc0 parallel_sum__grouped_kv_mqa__mixer_gmlp__prompt_kernel_b1_pw2
    s_lshl_b32 s64, s63, 12
    buffer_load_dword v31, v30, s[28:31], s64 offen
    s_branch parallel_sum__grouped_kv_mqa__mixer_gmlp__prompt_kernel_b1_pe2
parallel_sum__grouped_kv_mqa__mixer_gmlp__prompt_kernel_b1_pw2:
    s_sub_u32 s64, s63, 128
    s_lshl_b32 s64, s64, 12
    buffer_load_dword v31, v30, s[32:35], s64 offen
parallel_sum__grouped_kv_mqa__mixer_gmlp__prompt_kernel_b1_pe2:
    s_add_u32 s63, s62, 3
    s_cmp_lt_u32 s63, 128
    s_cbranch_scc0 parallel_sum__grouped_kv_mqa__mixer_gmlp__prompt_kernel_b1_pw3
    s_lshl_b32 s64, s63, 12
    buffer_load_dword v31, v30, s[28:31], s64 offen
    s_branch parallel_sum__grouped_kv_mqa__mixer_gmlp__prompt_kernel_b1_pe3
parallel_sum__grouped_kv_mqa__mixer_gmlp__prompt_kernel_b1_pw3:
    s_sub_u32 s64, s63, 128
    s_lshl_b32 s64, s64, 12
    buffer_load_dword v31, v30, s[32:35], s64 offen
parallel_sum__grouped_kv_mqa__mixer_gmlp__prompt_kernel_b1_pe3:
    s_add_u32 s63, s62, 4
    s_cmp_lt_u32 s63, 128
    s_cbranch_scc0 parallel_sum__grouped_kv_mqa__mixer_gmlp__prompt_kernel_b1_pw4
    s_lshl_b32 s64, s63, 12
    buffer_load_dword v31, v30, s[28:31], s64 offen
    s_branch parallel_sum__grouped_kv_mqa__mixer_gmlp__prompt_kernel_b1_pe4
parallel_sum__grouped_kv_mqa__mixer_gmlp__prompt_kernel_b1_pw4:
    s_sub_u32 s64, s63, 128
    s_lshl_b32 s64, s64, 12
    buffer_load_dword v31, v30, s[32:35], s64 offen
parallel_sum__grouped_kv_mqa__mixer_gmlp__prompt_kernel_b1_pe4:
    s_add_u32 s63, s62, 5
    s_cmp_lt_u32 s63, 128
    s_cbranch_scc0 parallel_sum__grouped_kv_mqa__mixer_gmlp__prompt_kernel_b1_pw5
    s_lshl_b32 s64, s63, 12
    buffer_load_dword v31, v30, s[28:31], s64 offen
    s_branch parallel_sum__grouped_kv_mqa__mixer_gmlp__prompt_kernel_b1_pe5
parallel_sum__grouped_kv_mqa__mixer_gmlp__prompt_kernel_b1_pw5:
    s_sub_u32 s64, s63, 128
    s_lshl_b32 s64, s64, 12
    buffer_load_dword v31, v30, s[32:35], s64 offen
parallel_sum__grouped_kv_mqa__mixer_gmlp__prompt_kernel_b1_pe5:
parallel_sum__grouped_kv_mqa__mixer_gmlp__prompt_kernel_b1_pwx:
    s_waitcnt lgkmcnt(0)
    s_waitcnt vmcnt(6)
    s_barrier
    s_cmp_eq_u32 s56, 0
    s_cbranch_scc1 parallel_sum__grouped_kv_mqa__mixer_gmlp__prompt_kernel_b1_n0
    ds_read_b64_tr_b16 v[32:33], v6 offset:0
    ds_read_b64_tr_b16 v[34:35], v6 offset:256
    ds_read_b128 v[128:131], v10 offset:0
    ds_read_b64_tr_b16 v[36:37], v6 offset:1024
    ds_read_b64_tr_b16 v[38:39], v6 offset:1280
    ds_read_b128 v[132:135], v11 offset:1024
    ds_read_b64_tr_b16 v[40:41], v6 offset:2048
    ds_read_b64_tr_b16 v[42:43], v6 offset:2304
    ds_read_b128 v[136:139], v12 offset:2048
    ds_read_b64_tr_b16 v[44:45], v6 offset:3072
    ds_read_b64_tr_b16 v[46:47], v6 offset:3328
    ds_read_b128 v[140:143], v13 offset:3072
    s_add_u32 s57, s59, 262144
    s_add_u32 m0, s60, 131072
    s_nop 0
    buffer_load_dwordx4 v5, s[12:15], s57 offen lds
    s_add_u32 s57, s59, 270336
    s_add_u32 m0, s60, 132096
    s_nop 0
    buffer_load_dwordx4 v5, s[12:15], s57 offen lds
    s_branch parallel_sum__grouped_kv_mqa__mixer_gmlp__prompt_kernel_b1_e0
parallel_sum__grouped_kv_mqa__mixer_gmlp__prompt_kernel_b1_n0:
    s_add_u32 s57, s59, 262144
    s_add_u32 m0, s60, 131072
    s_nop 0
    buffer_load_dwordx4 v5, s[12:15], s57 offen lds
    s_add_u32 s57, s59, 270336
    s_add_u32 m0, s60, 132096
    s_nop 0
    buffer_load_dwordx4 v5, s[12:15], s57 offen lds
parallel_sum__grouped_kv_mqa__mixer_gmlp__prompt_kernel_b1_e0:
    s_waitcnt lgkmcnt(0)
    s_cmp_eq_u32 s56, 0
    s_cbranch_scc1 parallel_sum__grouped_kv_mqa__mixer_gmlp__prompt_kernel_b1_n1
    v_mfma_f32_32x32x16_bf16 v[96:111], v[32:35], v[128:131], 0
    ds_read_b64_tr_b16 v[48:49], v6 offset:4096
    ds_read_b64_tr_b16 v[50:51], v6 offset:4352
    ds_read_b128 v[144:147], v10 offset:4096
    ds_read_b64_tr_b16 v[52:53], v6 offset:5120
    ds_read_b64_tr_b16 v[54:55], v6 offset:5376
    ds_read_b128 v[148:151], v11 offset:5120
    v_mfma_f32_32x32x16_bf16 v[96:111], v[36:39], v[132:135], v[96:111]
    ds_read_b64_tr_b16 v[56:57], v6 offset:6144
    ds_read_b64_tr_b16 v[58:59], v6 offset:6400
    ds_read_b128 v[152:155], v12 offset:6144
    ds_read_b64_tr_b16 v[60:61], v6 offset:7168
    ds_read_b64_tr_b16 v[62:63], v6 offset:7424
    ds_read_b128 v[156:159], v13 offset:7168
    v_mfma_f32_32x32x16_bf16 v[96:111], v[40:43], v[136:139], v[96:111]
    v_mfma_f32_32x32x16_bf16 v[96:111], v[44:47], v[140:143], v[96:111]
    s_branch parallel_sum__grouped_kv_mqa__mixer_gmlp__prompt_kernel_b1_e1
parallel_sum__grouped_kv_mqa__mixer_gmlp__prompt_kernel_b1_n1:
parallel_sum__grouped_kv_mqa__mixer_gmlp__prompt_kernel_b1_e1:
    s_waitcnt lgkmcnt(0)
    s_cmp_eq_u32 s56, 0
    s_cbranch_scc1 parallel_sum__grouped_kv_mqa__mixer_gmlp__prompt_kernel_b1_n2
    v_mfma_f32_32x32x16_bf16 v[96:111], v[48:51], v[144:147], v[96:111]
    ds_read_b64_tr_b16 v[32:33], v6 offset:8192
    ds_read_b64_tr_b16 v[34:35], v6 offset:8448
    ds_read_b128 v[160:163], v10 offset:8192
    ds_read_b64_tr_b16 v[36:37], v6 offset:9216
    ds_read_b64_tr_b16 v[38:39], v6 offset:9472
    ds_read_b128 v[164:167], v11 offset:9216
    v_mfma_f32_32x32x16_bf16 v[96:111], v[52:55], v[148:151], v[96:111]
    ds_read_b64_tr_b16 v[40:41], v6 offset:10240
    ds_read_b64_tr_b16 v[42:43], v6 offset:10496
    ds_read_b128 v[168:171], v12 offset:10240
    ds_read_b64_tr_b16 v[44:45], v6 offset:11264
    ds_read_b64_tr_b16 v[46:47], v6 offset:11520
    ds_read_b128 v[172:175], v13 offset:11264
    v_mfma_f32_32x32x16_bf16 v[96:111], v[56:59], v[152:155], v[96:111]
    v_mfma_f32_32x32x16_bf16 v[96:111], v[60:63], v[156:159], v[96:111]
    s_branch parallel_sum__grouped_kv_mqa__mixer_gmlp__prompt_kernel_b1_e2
parallel_sum__grouped_kv_mqa__mixer_gmlp__prompt_kernel_b1_n2:
parallel_sum__grouped_kv_mqa__mixer_gmlp__prompt_kernel_b1_e2:
    s_waitcnt lgkmcnt(0)
    s_cmp_eq_u32 s56, 0
    s_cbranch_scc1 parallel_sum__grouped_kv_mqa__mixer_gmlp__prompt_kernel_b1_n3
    v_mfma_f32_32x32x16_bf16 v[96:111], v[32:35], v[160:163], v[96:111]
    ds_read_b64_tr_b16 v[48:49], v6 offset:12288
    ds_read_b64_tr_b16 v[50:51], v6 offset:12544
    ds_read_b128 v[176:179], v10 offset:12288
    ds_read_b64_tr_b16 v[52:53], v6 offset:13312
    ds_read_b64_tr_b16 v[54:55], v6 offset:13568
    ds_read_b128 v[180:183], v11 offset:13312
    v_mfma_f32_32x32x16_bf16 v[96:111], v[36:39], v[164:167], v[96:111]
    ds_read_b64_tr_b16 v[56:57], v6 offset:14336
    ds_read_b64_tr_b16 v[58:59], v6 offset:14592
    ds_read_b128 v[184:187], v12 offset:14336
    ds_read_b64_tr_b16 v[60:61], v6 offset:15360
    ds_read_b64_tr_b16 v[62:63], v6 offset:15616
    ds_read_b128 v[188:191], v13 offset:15360
    v_mfma_f32_32x32x16_bf16 v[96:111], v[40:43], v[168:171], v[96:111]
    v_mfma_f32_32x32x16_bf16 v[96:111], v[44:47], v[172:175], v[96:111]
    s_branch parallel_sum__grouped_kv_mqa__mixer_gmlp__prompt_kernel_b1_e3
parallel_sum__grouped_kv_mqa__mixer_gmlp__prompt_kernel_b1_n3:
parallel_sum__grouped_kv_mqa__mixer_gmlp__prompt_kernel_b1_e3:
    s_waitcnt lgkmcnt(0)
    s_waitcnt vmcnt(6)
    s_barrier
    s_cmp_eq_u32 s56, 0
    s_cbranch_scc1 parallel_sum__grouped_kv_mqa__mixer_gmlp__prompt_kernel_b1_n4
    v_mfma_f32_32x32x16_bf16 v[96:111], v[48:51], v[176:179], v[96:111]
    ds_read_b64_tr_b16 v[32:33], v6 offset:16384
    ds_read_b64_tr_b16 v[34:35], v6 offset:16640
    ds_read_b128 v[192:195], v10 offset:16384
    ds_read_b64_tr_b16 v[36:37], v6 offset:17408
    ds_read_b64_tr_b16 v[38:39], v6 offset:17664
    ds_read_b128 v[196:199], v11 offset:17408
    v_mfma_f32_32x32x16_bf16 v[96:111], v[52:55], v[180:183], v[96:111]
    ds_read_b64_tr_b16 v[40:41], v6 offset:18432
    ds_read_b64_tr_b16 v[42:43], v6 offset:18688
    ds_read_b128 v[200:203], v12 offset:18432
    ds_read_b64_tr_b16 v[44:45], v6 offset:19456
    ds_read_b64_tr_b16 v[46:47], v6 offset:19712
    ds_read_b128 v[204:207], v13 offset:19456
    v_mfma_f32_32x32x16_bf16 v[96:111], v[56:59], v[184:187], v[96:111]
    s_add_u32 s57, s59, 393216
    s_add_u32 m0, s60, 0
    s_nop 0
    buffer_load_dwordx4 v5, s[12:15], s57 offen lds
    v_mfma_f32_32x32x16_bf16 v[96:111], v[60:63], v[188:191], v[96:111]
    s_add_u32 s57, s59, 401408
    s_add_u32 m0, s60, 1024
    s_nop 0
    buffer_load_dwordx4 v5, s[12:15], s57 offen lds
    s_branch parallel_sum__grouped_kv_mqa__mixer_gmlp__prompt_kernel_b1_e4
parallel_sum__grouped_kv_mqa__mixer_gmlp__prompt_kernel_b1_n4:
    s_add_u32 s57, s59, 393216
    s_add_u32 m0, s60, 0
    s_nop 0
    buffer_load_dwordx4 v5, s[12:15], s57 offen lds
    s_add_u32 s57, s59, 401408
    s_add_u32 m0, s60, 1024
    s_nop 0
    buffer_load_dwordx4 v5, s[12:15], s57 offen lds
parallel_sum__grouped_kv_mqa__mixer_gmlp__prompt_kernel_b1_e4:
    s_waitcnt lgkmcnt(0)
    s_cmp_eq_u32 s56, 0
    s_cbranch_scc1 parallel_sum__grouped_kv_mqa__mixer_gmlp__prompt_kernel_b1_n5
    v_mfma_f32_32x32x16_bf16 v[96:111], v[32:35], v[192:195], v[96:111]
    ds_read_b64_tr_b16 v[48:49], v6 offset:20480
    ds_read_b64_tr_b16 v[50:51], v6 offset:20736
    ds_read_b128 v[208:211], v10 offset:20480
    ds_read_b64_tr_b16 v[52:53], v6 offset:21504
    ds_read_b64_tr_b16 v[54:55], v6 offset:21760
    ds_read_b128 v[212:215], v11 offset:21504
    v_mfma_f32_32x32x16_bf16 v[96:111], v[36:39], v[196:199], v[96:111]
    ds_read_b64_tr_b16 v[56:57], v6 offset:22528
    ds_read_b64_tr_b16 v[58:59], v6 offset:22784
    ds_read_b128 v[216:219], v12 offset:22528
    ds_read_b64_tr_b16 v[60:61], v6 offset:23552
    ds_read_b64_tr_b16 v[62:63], v6 offset:23808
    ds_read_b128 v[220:223], v13 offset:23552
    v_mfma_f32_32x32x16_bf16 v[96:111], v[40:43], v[200:203], v[96:111]
    v_mfma_f32_32x32x16_bf16 v[96:111], v[44:47], v[204:207], v[96:111]
    s_branch parallel_sum__grouped_kv_mqa__mixer_gmlp__prompt_kernel_b1_e5
parallel_sum__grouped_kv_mqa__mixer_gmlp__prompt_kernel_b1_n5:
parallel_sum__grouped_kv_mqa__mixer_gmlp__prompt_kernel_b1_e5:
    s_waitcnt lgkmcnt(0)
    s_cmp_eq_u32 s56, 0
    s_cbranch_scc1 parallel_sum__grouped_kv_mqa__mixer_gmlp__prompt_kernel_b1_n6
    v_mfma_f32_32x32x16_bf16 v[96:111], v[48:51], v[208:211], v[96:111]
    ds_read_b64_tr_b16 v[32:33], v6 offset:24576
    ds_read_b64_tr_b16 v[34:35], v6 offset:24832
    ds_read_b128 v[224:227], v10 offset:24576
    ds_read_b64_tr_b16 v[36:37], v6 offset:25600
    ds_read_b64_tr_b16 v[38:39], v6 offset:25856
    ds_read_b128 v[228:231], v11 offset:25600
    v_mfma_f32_32x32x16_bf16 v[96:111], v[52:55], v[212:215], v[96:111]
    ds_read_b64_tr_b16 v[40:41], v6 offset:26624
    ds_read_b64_tr_b16 v[42:43], v6 offset:26880
    ds_read_b128 v[232:235], v12 offset:26624
    ds_read_b64_tr_b16 v[44:45], v6 offset:27648
    ds_read_b64_tr_b16 v[46:47], v6 offset:27904
    ds_read_b128 v[236:239], v13 offset:27648
    v_mfma_f32_32x32x16_bf16 v[96:111], v[56:59], v[216:219], v[96:111]
    v_mfma_f32_32x32x16_bf16 v[96:111], v[60:63], v[220:223], v[96:111]
    s_branch parallel_sum__grouped_kv_mqa__mixer_gmlp__prompt_kernel_b1_e6
parallel_sum__grouped_kv_mqa__mixer_gmlp__prompt_kernel_b1_n6:
parallel_sum__grouped_kv_mqa__mixer_gmlp__prompt_kernel_b1_e6:
    s_waitcnt lgkmcnt(0)
    s_cmp_eq_u32 s56, 0
    s_cbranch_scc1 parallel_sum__grouped_kv_mqa__mixer_gmlp__prompt_kernel_b1_n7
    v_mfma_f32_32x32x16_bf16 v[96:111], v[32:35], v[224:227], v[96:111]
    ds_read_b64_tr_b16 v[48:49], v6 offset:28672
    ds_read_b64_tr_b16 v[50:51], v6 offset:28928
    ds_read_b128 v[240:243], v10 offset:28672
    ds_read_b64_tr_b16 v[52:53], v6 offset:29696
    ds_read_b64_tr_b16 v[54:55], v6 offset:29952
    ds_read_b128 v[244:247], v11 offset:29696
    v_mfma_f32_32x32x16_bf16 v[96:111], v[36:39], v[228:231], v[96:111]
    ds_read_b64_tr_b16 v[56:57], v6 offset:30720
    ds_read_b64_tr_b16 v[58:59], v6 offset:30976
    ds_read_b128 v[248:251], v12 offset:30720
    ds_read_b64_tr_b16 v[60:61], v6 offset:31744
    ds_read_b64_tr_b16 v[62:63], v6 offset:32000
    ds_read_b128 v[252:255], v13 offset:31744
    v_mfma_f32_32x32x16_bf16 v[96:111], v[40:43], v[232:235], v[96:111]
    v_mfma_f32_32x32x16_bf16 v[96:111], v[44:47], v[236:239], v[96:111]
    s_branch parallel_sum__grouped_kv_mqa__mixer_gmlp__prompt_kernel_b1_e7
parallel_sum__grouped_kv_mqa__mixer_gmlp__prompt_kernel_b1_n7:
parallel_sum__grouped_kv_mqa__mixer_gmlp__prompt_kernel_b1_e7:
    s_waitcnt lgkmcnt(0)
    s_waitcnt vmcnt(6)
    s_barrier
    s_cmp_eq_u32 s56, 0
    s_cbranch_scc1 parallel_sum__grouped_kv_mqa__mixer_gmlp__prompt_kernel_b1_m8
    v_mfma_f32_32x32x16_bf16 v[96:111], v[48:51], v[240:243], v[96:111]
    v_mfma_f32_32x32x16_bf16 v[96:111], v[52:55], v[244:247], v[96:111]
    v_mfma_f32_32x32x16_bf16 v[96:111], v[56:59], v[248:251], v[96:111]
    v_mfma_f32_32x32x16_bf16 v[96:111], v[60:63], v[252:255], v[96:111]
parallel_sum__grouped_kv_mqa__mixer_gmlp__prompt_kernel_b1_m8:
    s_cmp_eq_u32 s55, 0
    s_cbranch_scc1 parallel_sum__grouped_kv_mqa__mixer_gmlp__prompt_kernel_b1_r8
    ds_read_b64_tr_b16 v[32:33], v8 offset:32768
    ds_read_b64_tr_b16 v[34:35], v8 offset:33280
    ds_read_b128 v[128:131], v10 offset:0
    ds_read_b64_tr_b16 v[36:37], v8 offset:34816
    ds_read_b64_tr_b16 v[38:39], v8 offset:35328
    ds_read_b128 v[132:135], v11 offset:1024
    ds_read_b64_tr_b16 v[40:41], v8 offset:36864
    ds_read_b64_tr_b16 v[42:43], v8 offset:37376
    ds_read_b128 v[136:139], v12 offset:2048
    ds_read_b64_tr_b16 v[44:45], v8 offset:38912
    ds_read_b64_tr_b16 v[46:47], v8 offset:39424
    ds_read_b128 v[140:143], v13 offset:3072
parallel_sum__grouped_kv_mqa__mixer_gmlp__prompt_kernel_b1_r8:
    s_waitcnt lgkmcnt(0)
    s_cmp_eq_u32 s56, 0
    s_cbranch_scc1 parallel_sum__grouped_kv_mqa__mixer_gmlp__prompt_kernel_b1_x8
    s_nop 7
    s_nop 7
    v_cvt_pk_bf16_f32 v14, v96, v97
    v_cvt_pk_bf16_f32 v15, v98, v99
    v_cvt_pk_bf16_f32 v16, v100, v101
    v_cvt_pk_bf16_f32 v17, v102, v103
    v_cvt_pk_bf16_f32 v18, v104, v105
    v_cvt_pk_bf16_f32 v19, v106, v107
    v_cvt_pk_bf16_f32 v20, v108, v109
    v_cvt_pk_bf16_f32 v21, v110, v111
    s_lshl_b32 s62, s46, 1
    s_add_u32 s62, s62, s49
    s_lshl_b32 s62, s62, 10
    s_add_u32 s63, s62, 2097152
    s_add_u32 s64, s62, 2162688
    v_lshlrev_b32 v22, 4, v1
    buffer_store_dwordx4 v[14:17], v22, s[4:7], s63 offen sc1
    s_mul_i32 s65, s49, 1280
    s_add_u32 s65, s65, 150528
    v_mul_u32_u24 v23, 40, v3
    v_lshl_add_u32 v23, v2, 3, v23
    v_add_u32 v23, s65, v23
    ds_write_b64 v23, v[18:19]
    ds_write_b64 v23, v[20:21] offset:16
    v_lshrrev_b32 v24, 4, v1
    v_lshrrev_b32 v25, 1, v24
    v_and_b32 v24, 1, v24
    v_lshlrev_b32 v25, 4, v25
    v_lshl_add_u32 v25, v24, 2, v25
    v_bfe_u32 v24, v1, 2, 2
    v_add_u32 v25, v25, v24
    v_mul_u32_u24 v25, 40, v25
    v_and_b32 v24, 3, v1
    v_lshl_add_u32 v25, v24, 3, v25
    v_add_u32 v25, s65, v25
    s_waitcnt lgkmcnt(0)
    ds_read_b64_tr_b16 v[18:19], v25
    ds_read_b64_tr_b16 v[20:21], v25 offset:320
    s_waitcnt lgkmcnt(0)
    buffer_store_dwordx4 v[18:21], v22, s[4:7], s64 offen sc1
    s_waitcnt vmcnt(0)
parallel_sum__grouped_kv_mqa__mixer_gmlp__prompt_kernel_b1_x8:
    s_cmp_eq_u32 s55, 0
    s_cbranch_scc1 parallel_sum__grouped_kv_mqa__mixer_gmlp__prompt_kernel_b1_n9
    v_mfma_f32_32x32x16_bf16 v[96:111], v[32:35], v[128:131], 0
    ds_read_b64_tr_b16 v[48:49], v8 offset:40960
    ds_read_b64_tr_b16 v[50:51], v8 offset:41472
    ds_read_b128 v[144:147], v10 offset:4096
    ds_read_b64_tr_b16 v[52:53], v8 offset:43008
    ds_read_b64_tr_b16 v[54:55], v8 offset:43520
    ds_read_b128 v[148:151], v11 offset:5120
    v_mfma_f32_32x32x16_bf16 v[96:111], v[36:39], v[132:135], v[96:111]
    ds_read_b64_tr_b16 v[56:57], v8 offset:45056
    ds_read_b64_tr_b16 v[58:59], v8 offset:45568
    ds_read_b128 v[152:155], v12 offset:6144
    ds_read_b64_tr_b16 v[60:61], v8 offset:47104
    ds_read_b64_tr_b16 v[62:63], v8 offset:47616
    ds_read_b128 v[156:159], v13 offset:7168
    v_mfma_f32_32x32x16_bf16 v[96:111], v[40:43], v[136:139], v[96:111]
    v_mfma_f32_32x32x16_bf16 v[96:111], v[44:47], v[140:143], v[96:111]
    s_branch parallel_sum__grouped_kv_mqa__mixer_gmlp__prompt_kernel_b1_e9
parallel_sum__grouped_kv_mqa__mixer_gmlp__prompt_kernel_b1_n9:
parallel_sum__grouped_kv_mqa__mixer_gmlp__prompt_kernel_b1_e9:
    s_waitcnt lgkmcnt(0)
    s_waitcnt vmcnt(4)
    s_barrier
    s_cmp_eq_u32 s55, 0
    s_cbranch_scc1 parallel_sum__grouped_kv_mqa__mixer_gmlp__prompt_kernel_b1_n10
    v_mfma_f32_32x32x16_bf16 v[96:111], v[48:51], v[144:147], v[96:111]
    ds_read_b64_tr_b16 v[32:33], v8 offset:49152
    ds_read_b64_tr_b16 v[34:35], v8 offset:49664
    ds_read_b128 v[160:163], v10 offset:8192
    ds_read_b64_tr_b16 v[36:37], v8 offset:51200
    ds_read_b64_tr_b16 v[38:39], v8 offset:51712
    ds_read_b128 v[164:167], v11 offset:9216
    v_mfma_f32_32x32x16_bf16 v[96:111], v[52:55], v[148:151], v[96:111]
    ds_read_b64_tr_b16 v[40:41], v8 offset:53248
    ds_read_b64_tr_b16 v[42:43], v8 offset:53760
    ds_read_b128 v[168:171], v12 offset:10240
    ds_read_b64_tr_b16 v[44:45], v8 offset:55296
    ds_read_b64_tr_b16 v[46:47], v8 offset:55808
    ds_read_b128 v[172:175], v13 offset:11264
    v_mfma_f32_32x32x16_bf16 v[96:111], v[56:59], v[152:155], v[96:111]
    v_mfma_f32_32x32x16_bf16 v[96:111], v[60:63], v[156:159], v[96:111]
    s_branch parallel_sum__grouped_kv_mqa__mixer_gmlp__prompt_kernel_b1_e10
parallel_sum__grouped_kv_mqa__mixer_gmlp__prompt_kernel_b1_n10:
parallel_sum__grouped_kv_mqa__mixer_gmlp__prompt_kernel_b1_e10:
    s_waitcnt lgkmcnt(0)
    s_cmp_eq_u32 s55, 0
    s_cbranch_scc1 parallel_sum__grouped_kv_mqa__mixer_gmlp__prompt_kernel_b1_n11
    v_mfma_f32_32x32x16_bf16 v[96:111], v[32:35], v[160:163], v[96:111]
    ds_read_b64_tr_b16 v[48:49], v8 offset:57344
    ds_read_b64_tr_b16 v[50:51], v8 offset:57856
    ds_read_b128 v[176:179], v10 offset:12288
    ds_read_b64_tr_b16 v[52:53], v8 offset:59392
    ds_read_b64_tr_b16 v[54:55], v8 offset:59904
    ds_read_b128 v[180:183], v11 offset:13312
    v_mfma_f32_32x32x16_bf16 v[96:111], v[36:39], v[164:167], v[96:111]
    ds_read_b64_tr_b16 v[56:57], v8 offset:61440
    ds_read_b64_tr_b16 v[58:59], v8 offset:61952
    ds_read_b128 v[184:187], v12 offset:14336
    ds_read_b64_tr_b16 v[60:61], v8 offset:63488
    ds_read_b64_tr_b16 v[62:63], v8 offset:64000
    ds_read_b128 v[188:191], v13 offset:15360
    v_mfma_f32_32x32x16_bf16 v[96:111], v[40:43], v[168:171], v[96:111]
    v_mfma_f32_32x32x16_bf16 v[96:111], v[44:47], v[172:175], v[96:111]
    s_branch parallel_sum__grouped_kv_mqa__mixer_gmlp__prompt_kernel_b1_e11
parallel_sum__grouped_kv_mqa__mixer_gmlp__prompt_kernel_b1_n11:
parallel_sum__grouped_kv_mqa__mixer_gmlp__prompt_kernel_b1_e11:
    s_waitcnt lgkmcnt(0)
    s_waitcnt vmcnt(2)
    s_barrier
    s_cmp_eq_u32 s55, 0
    s_cbranch_scc1 parallel_sum__grouped_kv_mqa__mixer_gmlp__prompt_kernel_b1_n12
    v_mfma_f32_32x32x16_bf16 v[96:111], v[48:51], v[176:179], v[96:111]
    ds_read_b64_tr_b16 v[32:33], v9 offset:0
    ds_read_b64_tr_b16 v[34:35], v9 offset:512
    ds_read_b128 v[192:195], v10 offset:16384
    ds_read_b64_tr_b16 v[36:37], v9 offset:2048
    ds_read_b64_tr_b16 v[38:39], v9 offset:2560
    ds_read_b128 v[196:199], v11 offset:17408
    v_mfma_f32_32x32x16_bf16 v[96:111], v[52:55], v[180:183], v[96:111]
    ds_read_b64_tr_b16 v[40:41], v9 offset:4096
    ds_read_b64_tr_b16 v[42:43], v9 offset:4608
    ds_read_b128 v[200:203], v12 offset:18432
    ds_read_b64_tr_b16 v[44:45], v9 offset:6144
    ds_read_b64_tr_b16 v[46:47], v9 offset:6656
    ds_read_b128 v[204:207], v13 offset:19456
    v_mfma_f32_32x32x16_bf16 v[96:111], v[56:59], v[184:187], v[96:111]
    v_mfma_f32_32x32x16_bf16 v[96:111], v[60:63], v[188:191], v[96:111]
    s_branch parallel_sum__grouped_kv_mqa__mixer_gmlp__prompt_kernel_b1_e12
parallel_sum__grouped_kv_mqa__mixer_gmlp__prompt_kernel_b1_n12:
parallel_sum__grouped_kv_mqa__mixer_gmlp__prompt_kernel_b1_e12:
    s_waitcnt lgkmcnt(0)
    s_cmp_eq_u32 s55, 0
    s_cbranch_scc1 parallel_sum__grouped_kv_mqa__mixer_gmlp__prompt_kernel_b1_n13
    v_mfma_f32_32x32x16_bf16 v[96:111], v[32:35], v[192:195], v[96:111]
    ds_read_b64_tr_b16 v[48:49], v9 offset:8192
    ds_read_b64_tr_b16 v[50:51], v9 offset:8704
    ds_read_b128 v[208:211], v10 offset:20480
    ds_read_b64_tr_b16 v[52:53], v9 offset:10240
    ds_read_b64_tr_b16 v[54:55], v9 offset:10752
    ds_read_b128 v[212:215], v11 offset:21504
    v_mfma_f32_32x32x16_bf16 v[96:111], v[36:39], v[196:199], v[96:111]
    ds_read_b64_tr_b16 v[56:57], v9 offset:12288
    ds_read_b64_tr_b16 v[58:59], v9 offset:12800
    ds_read_b128 v[216:219], v12 offset:22528
    ds_read_b64_tr_b16 v[60:61], v9 offset:14336
    ds_read_b64_tr_b16 v[62:63], v9 offset:14848
    ds_read_b128 v[220:223], v13 offset:23552
    v_mfma_f32_32x32x16_bf16 v[96:111], v[40:43], v[200:203], v[96:111]
    v_mfma_f32_32x32x16_bf16 v[96:111], v[44:47], v[204:207], v[96:111]
    s_branch parallel_sum__grouped_kv_mqa__mixer_gmlp__prompt_kernel_b1_e13
parallel_sum__grouped_kv_mqa__mixer_gmlp__prompt_kernel_b1_n13:
parallel_sum__grouped_kv_mqa__mixer_gmlp__prompt_kernel_b1_e13:
    s_waitcnt lgkmcnt(0)
    s_waitcnt vmcnt(0)
    s_barrier
    s_cmp_eq_u32 s55, 0
    s_cbranch_scc1 parallel_sum__grouped_kv_mqa__mixer_gmlp__prompt_kernel_b1_n14
    v_mfma_f32_32x32x16_bf16 v[96:111], v[48:51], v[208:211], v[96:111]
    ds_read_b64_tr_b16 v[32:33], v8 offset:0
    ds_read_b64_tr_b16 v[34:35], v8 offset:512
    ds_read_b128 v[224:227], v10 offset:24576
    ds_read_b64_tr_b16 v[36:37], v8 offset:2048
    ds_read_b64_tr_b16 v[38:39], v8 offset:2560
    ds_read_b128 v[228:231], v11 offset:25600
    v_mfma_f32_32x32x16_bf16 v[96:111], v[52:55], v[212:215], v[96:111]
    ds_read_b64_tr_b16 v[40:41], v8 offset:4096
    ds_read_b64_tr_b16 v[42:43], v8 offset:4608
    ds_read_b128 v[232:235], v12 offset:26624
    ds_read_b64_tr_b16 v[44:45], v8 offset:6144
    ds_read_b64_tr_b16 v[46:47], v8 offset:6656
    ds_read_b128 v[236:239], v13 offset:27648
    v_mfma_f32_32x32x16_bf16 v[96:111], v[56:59], v[216:219], v[96:111]
    v_mfma_f32_32x32x16_bf16 v[96:111], v[60:63], v[220:223], v[96:111]
    s_branch parallel_sum__grouped_kv_mqa__mixer_gmlp__prompt_kernel_b1_e14
parallel_sum__grouped_kv_mqa__mixer_gmlp__prompt_kernel_b1_n14:
parallel_sum__grouped_kv_mqa__mixer_gmlp__prompt_kernel_b1_e14:
    s_waitcnt lgkmcnt(0)
    s_cmp_eq_u32 s55, 0
    s_cbranch_scc1 parallel_sum__grouped_kv_mqa__mixer_gmlp__prompt_kernel_b1_n15
    v_mfma_f32_32x32x16_bf16 v[96:111], v[32:35], v[224:227], v[96:111]
    ds_read_b64_tr_b16 v[48:49], v8 offset:8192
    ds_read_b64_tr_b16 v[50:51], v8 offset:8704
    ds_read_b128 v[240:243], v10 offset:28672
    ds_read_b64_tr_b16 v[52:53], v8 offset:10240
    ds_read_b64_tr_b16 v[54:55], v8 offset:10752
    ds_read_b128 v[244:247], v11 offset:29696
    v_mfma_f32_32x32x16_bf16 v[96:111], v[36:39], v[228:231], v[96:111]
    ds_read_b64_tr_b16 v[56:57], v8 offset:12288
    ds_read_b64_tr_b16 v[58:59], v8 offset:12800
    ds_read_b128 v[248:251], v12 offset:30720
    ds_read_b64_tr_b16 v[60:61], v8 offset:14336
    ds_read_b64_tr_b16 v[62:63], v8 offset:14848
    ds_read_b128 v[252:255], v13 offset:31744
    v_mfma_f32_32x32x16_bf16 v[96:111], v[40:43], v[232:235], v[96:111]
    v_mfma_f32_32x32x16_bf16 v[96:111], v[44:47], v[236:239], v[96:111]
    s_branch parallel_sum__grouped_kv_mqa__mixer_gmlp__prompt_kernel_b1_e15
parallel_sum__grouped_kv_mqa__mixer_gmlp__prompt_kernel_b1_n15:
parallel_sum__grouped_kv_mqa__mixer_gmlp__prompt_kernel_b1_e15:
    s_waitcnt lgkmcnt(0)
    s_cmp_eq_u32 s55, 0
    s_cbranch_scc1 parallel_sum__grouped_kv_mqa__mixer_gmlp__prompt_kernel_b1_m16
    v_mfma_f32_32x32x16_bf16 v[96:111], v[48:51], v[240:243], v[96:111]
    v_mfma_f32_32x32x16_bf16 v[96:111], v[52:55], v[244:247], v[96:111]
    v_mfma_f32_32x32x16_bf16 v[96:111], v[56:59], v[248:251], v[96:111]
    v_mfma_f32_32x32x16_bf16 v[96:111], v[60:63], v[252:255], v[96:111]
parallel_sum__grouped_kv_mqa__mixer_gmlp__prompt_kernel_b1_m16:
    s_waitcnt lgkmcnt(0)
    s_cmp_eq_u32 s55, 0
    s_cbranch_scc1 parallel_sum__grouped_kv_mqa__mixer_gmlp__prompt_kernel_b1_x16
    s_nop 7
    s_nop 7
    s_mov_b32 s62, 1052289595
    v_mul_f32 v96, s62, v96
    v_mul_f32 v97, s62, v97
    v_mul_f32 v98, s62, v98
    v_mul_f32 v99, s62, v99
    v_mul_f32 v100, s62, v100
    v_mul_f32 v101, s62, v101
    v_mul_f32 v102, s62, v102
    v_mul_f32 v103, s62, v103
    v_mul_f32 v104, s62, v104
    v_mul_f32 v105, s62, v105
    v_mul_f32 v106, s62, v106
    v_mul_f32 v107, s62, v107
    v_mul_f32 v108, s62, v108
    v_mul_f32 v109, s62, v109
    v_mul_f32 v110, s62, v110
    v_mul_f32 v111, s62, v111
    v_cvt_pk_bf16_f32 v14, v96, v97
    v_cvt_pk_bf16_f32 v15, v98, v99
    v_cvt_pk_bf16_f32 v16, v100, v101
    v_cvt_pk_bf16_f32 v17, v102, v103
    v_cvt_pk_bf16_f32 v18, v104, v105
    v_cvt_pk_bf16_f32 v19, v106, v107
    v_cvt_pk_bf16_f32 v20, v108, v109
    v_cvt_pk_bf16_f32 v21, v110, v111
    s_lshl_b32 s62, s49, 12
    s_and_b32 s63, s48, 1
    s_lshl_b32 s63, s63, 11
    s_add_u32 s62, s62, s63
    s_add_u32 s62, s62, 155648
    v_lshlrev_b32 v22, 4, v1
    v_add_u32 v22, s62, v22
    ds_write_b128 v22, v[14:17]
    ds_write_b128 v22, v[18:21] offset:1024
    s_waitcnt lgkmcnt(0)
parallel_sum__grouped_kv_mqa__mixer_gmlp__prompt_kernel_b1_x16:
    s_barrier
    s_cmp_eq_u32 s48, 0
    s_cbranch_scc0 parallel_sum__grouped_kv_mqa__mixer_gmlp__prompt_kernel_b1_kvp
    s_lshl_b32 s62, s46, 3
    s_add_u32 s62, s62, s47
    s_lshl_b32 s62, s62, 7
    s_add_u32 s62, s62, 15466500
    v_mov_b32 v14, 0
    v_mov_b32 v15, 1
    s_mov_b64 exec, 1
    buffer_store_dword v15, v14, s[4:7], s62 offen sc1
    s_mov_b64 exec, -1
parallel_sum__grouped_kv_mqa__mixer_gmlp__prompt_kernel_b1_kvp:
    s_cmp_ge_u32 s48, 4
    s_cbranch_scc0 parallel_sum__grouped_kv_mqa__mixer_gmlp__prompt_kernel_b2_nk
    s_cmp_eq_u32 s48, 7
    s_cbranch_scc1 parallel_sum__grouped_kv_mqa__mixer_gmlp__prompt_kernel_b2_nk
    s_mov_b32 s63, 0
    v_and_b32 v224, 1, v1
    v_lshlrev_b32 v224, 7, v224
parallel_sum__grouped_kv_mqa__mixer_gmlp__prompt_kernel_b2_cl:
    global_load_dword v225, v224, s[44:45] sc1
    s_waitcnt vmcnt(0)
    v_cmp_le_u32 vcc, 128, v225
    s_nop 1
    s_cmp_eq_u64 vcc, exec
    s_cbranch_scc1 parallel_sum__grouped_kv_mqa__mixer_gmlp__prompt_kernel_b2_cld
    s_add_u32 s63, s63, 1
    s_cmp_lt_u32 s63, 100000
    s_cbranch_scc1 parallel_sum__grouped_kv_mqa__mixer_gmlp__prompt_kernel_b2_cl
parallel_sum__grouped_kv_mqa__mixer_gmlp__prompt_kernel_b2_cld:
    v_lshlrev_b32 v224, 10, v3
    v_add_u32 v224, 15467396, v224
    s_mov_b32 s63, 0
    s_mov_b64 s[64:65], -1
parallel_sum__grouped_kv_mqa__mixer_gmlp__prompt_kernel_b2_kv_poll:
    buffer_load_dword v225, v224, s[4:7], 0 offen sc1
    s_waitcnt vmcnt(0)
    v_cmp_ne_u32 vcc, 0, v225
    s_nop 1
    s_and_b64 vcc, vcc, s[64:65]
    s_cmp_eq_u64 vcc, s[64:65]
    s_cbranch_scc1 parallel_sum__grouped_kv_mqa__mixer_gmlp__prompt_kernel_b2_kv_done
    s_add_u32 s63, s63, 1
    s_cmp_lt_u32 s63, 100000
    s_cbranch_scc1 parallel_sum__grouped_kv_mqa__mixer_gmlp__prompt_kernel_b2_kv_poll
parallel_sum__grouped_kv_mqa__mixer_gmlp__prompt_kernel_b2_kv_done:
    v_lshlrev_b32 v228, 4, v1
    v_lshlrev_b32 v229, 4, v3
    v_lshl_add_u32 v229, v2, 10, v229
    s_cmp_eq_u32 s50, 2
    s_cselect_b64 vcc, -1, 0
    s_lshl_b32 s62, s50, 10
    s_add_u32 s63, s62, 2097152
    v_cndmask_b32 v228, v228, v229, vcc
    s_cmp_eq_u32 s50, 2
    s_cselect_b32 s63, 2162688, s63
    s_add_u32 m0, s62, 94208
    s_nop 0
    buffer_load_dwordx4 v228, s[4:7], s63 offen sc1 lds
parallel_sum__grouped_kv_mqa__mixer_gmlp__prompt_kernel_b2_nk:
    s_waitcnt vmcnt(0) lgkmcnt(0)
    s_barrier
    s_lshl_b32 s62, s50, 10
    s_add_u32 s62, s62, 155648
    v_lshlrev_b32 v224, 4, v1
    v_add_u32 v227, s62, v224
    ds_read_b128 v[4:7], v227
    ds_read_b128 v[8:11], v227 offset:4096
    v_add_u32 v224, 94208, v224
    v_add_u32 v225, 86016, v116
    v_add_u32 v226, 86016, v117
    ds_read_b128 v[32:35], v224
    ds_read_b128 v[12:15], v225
    v_and_b32 v228, 0x1b, v0
    v_cmp_eq_u32 vcc, 16, v228
    v_mov_b32 v229, 0x3f803f80
    s_mov_b32 s55, 2048
    s_mov_b32 s54, 0
    s_mov_b32 s56, 0
    s_mov_b32 s57, 0
    s_lshl_b32 s58, s48, 10
    s_lshr_b32 s63, s48, 1
    s_lshl_b32 s59, s63, 10
    s_and_b32 s62, s48, 1
    s_lshl_b32 s62, s62, 8
    s_add_u32 s59, s59, s62
    s_add_u32 s59, s59, 8192
    s_mov_b32 s60, 49152
    v_cndmask_b32 v16, 0, v229, vcc
    v_cndmask_b32 v20, 0, v229, vcc
    v_cndmask_b32 v17, 0, v229, vcc
    v_cndmask_b32 v21, 0, v229, vcc
    v_cndmask_b32 v18, 0, v229, vcc
    v_cndmask_b32 v22, 0, v229, vcc
    v_cndmask_b32 v19, 0, v229, vcc
    v_cndmask_b32 v23, 0, v229, vcc
    s_mov_b64 exec, s[52:53]
    ds_read_b128 v[16:19], v226
    s_mov_b64 exec, -1
    s_waitcnt lgkmcnt(2)
    v_mfma_f32_32x32x16_bf16 v[40:55], v[32:35], v[4:7], 0
    v_mfma_f32_32x32x16_bf16 v[56:71], v[32:35], v[8:11], 0
    s_add_u32 m0, s57, s59
    s_mov_b64 exec, s[52:53]
    buffer_load_dwordx4 v114, s[4:7], s55 offen sc1 lds
    s_mov_b64 exec, -1
    s_add_u32 s55, s55, 2048
    s_add_u32 s57, s57, 12288
    s_cmp_eq_u32 s57, 98304
    s_cselect_b32 s57, 0, s57
    s_add_u32 m0, s57, s59
    s_mov_b64 exec, s[52:53]
    buffer_load_dwordx4 v114, s[4:7], s55 offen sc1 lds
    s_mov_b64 exec, -1
    s_add_u32 s55, s55, 2048
    s_add_u32 s57, s57, 12288
    s_cmp_eq_u32 s57, 98304
    s_cselect_b32 s57, 0, s57
    s_add_u32 m0, s57, s59
    s_mov_b64 exec, s[52:53]
    buffer_load_dwordx4 v114, s[4:7], s55 offen sc1 lds
    s_mov_b64 exec, -1
    s_add_u32 s55, s55, 2048
    s_add_u32 s57, s57, 12288
    s_cmp_eq_u32 s57, 98304
    s_cselect_b32 s57, 0, s57
    v_max3_f32 v230, v40, v41, v42
    v_max3_f32 v230, v230, v43, v44
    v_max3_f32 v230, v230, v45, v46
    v_max3_f32 v230, v230, v47, v48
    v_max3_f32 v230, v230, v49, v50
    v_max3_f32 v230, v230, v51, v52
    v_max3_f32 v230, v230, v53, v54
    v_max_f32 v230, v230, v55
    v_mov_b32 v231, v230
    s_nop 1
    v_permlane32_swap_b32 v230, v231
    s_nop 1
    v_max_f32 v230, v230, v231
    v_sub_f32 v128, 0, v230
    v_sub_f32 v129, 0, v230
    v_sub_f32 v130, 0, v230
    v_sub_f32 v131, 0, v230
    v_sub_f32 v132, 0, v230
    v_sub_f32 v133, 0, v230
    v_sub_f32 v134, 0, v230
    v_sub_f32 v135, 0, v230
    v_sub_f32 v136, 0, v230
    v_sub_f32 v137, 0, v230
    v_sub_f32 v138, 0, v230
    v_sub_f32 v139, 0, v230
    v_sub_f32 v140, 0, v230
    v_sub_f32 v141, 0, v230
    v_sub_f32 v142, 0, v230
    v_sub_f32 v143, 0, v230
    s_waitcnt lgkmcnt(0)
    s_nop 0
    v_mfma_f32_32x32x16_bf16 v[40:55], v[12:15], v[4:7], v[128:143]
    v_max3_f32 v230, v56, v57, v58
    v_max3_f32 v230, v230, v59, v60
    v_max3_f32 v230, v230, v61, v62
    v_max3_f32 v230, v230, v63, v64
    v_max3_f32 v230, v230, v65, v66
    v_max3_f32 v230, v230, v67, v68
    v_max3_f32 v230, v230, v69, v70
    v_max_f32 v230, v230, v71
    v_mov_b32 v231, v230
    s_nop 1
    v_permlane32_swap_b32 v230, v231
    s_nop 1
    v_max_f32 v230, v230, v231
    v_sub_f32 v144, 0, v230
    v_sub_f32 v145, 0, v230
    v_sub_f32 v146, 0, v230
    v_sub_f32 v147, 0, v230
    v_sub_f32 v148, 0, v230
    v_sub_f32 v149, 0, v230
    v_sub_f32 v150, 0, v230
    v_sub_f32 v151, 0, v230
    v_sub_f32 v152, 0, v230
    v_sub_f32 v153, 0, v230
    v_sub_f32 v154, 0, v230
    v_sub_f32 v155, 0, v230
    v_sub_f32 v156, 0, v230
    v_sub_f32 v157, 0, v230
    v_sub_f32 v158, 0, v230
    v_sub_f32 v159, 0, v230
    s_add_u32 m0, s57, s59
    s_mov_b64 exec, s[52:53]
    buffer_load_dwordx4 v114, s[4:7], s55 offen sc1 lds
    s_mov_b64 exec, -1
    s_add_u32 s55, s55, 2048
    s_add_u32 s57, s57, 12288
    s_cmp_eq_u32 s57, 98304
    s_cselect_b32 s57, 0, s57
    s_add_u32 m0, s57, s59
    s_mov_b64 exec, s[52:53]
    buffer_load_dwordx4 v114, s[4:7], s55 offen sc1 lds
    s_mov_b64 exec, -1
    s_add_u32 s55, s55, 2048
    s_add_u32 s57, s57, 12288
    s_cmp_eq_u32 s57, 98304
    s_cselect_b32 s57, 0, s57
    s_add_u32 m0, s57, s59
    s_mov_b64 exec, s[52:53]
    buffer_load_dwordx4 v114, s[4:7], s55 offen sc1 lds
    s_mov_b64 exec, -1
    s_add_u32 s55, s55, 2048
    s_add_u32 s57, s57, 12288
    s_cmp_eq_u32 s57, 98304
    s_cselect_b32 s57, 0, s57
    s_waitcnt vmcnt(5)
    s_barrier
    v_mfma_f32_32x32x16_bf16 v[56:71], v[12:15], v[8:11], v[144:159]
    v_exp_f32 v40, v40
    ds_read_b128 v[12:15], v116 offset:0
    v_exp_f32 v41, v41
    v_exp_f32 v42, v42
    v_exp_f32 v43, v43
    v_exp_f32 v44, v44
    v_cvt_pk_bf16_f32 v24, v40, v41
    v_exp_f32 v45, v45
    v_cvt_pk_bf16_f32 v25, v42, v43
    s_add_u32 m0, s57, s59
    v_exp_f32 v46, v46
    s_mov_b64 exec, s[52:53]
    ds_read_b128 v[20:23], v117 offset:1024
    buffer_load_dwordx4 v114, s[4:7], s55 offen sc1 lds
    s_mov_b64 exec, -1
    v_exp_f32 v47, v47
    s_add_u32 s55, s55, 2048
    s_add_u32 s57, s57, 12288
    s_cmp_eq_u32 s57, 98304
    s_cselect_b32 s57, 0, s57
    v_cvt_pk_bf16_f32 v26, v44, v45
    v_cvt_pk_bf16_f32 v27, v46, v47
    v_exp_f32 v48, v48
    v_exp_f32 v49, v49
    v_exp_f32 v50, v50
    v_cvt_pk_bf16_f32 v28, v48, v49
    v_mfma_f32_32x32x16_bf16 v[72:87], v[16:19], v[24:27], 0
    v_exp_f32 v51, v51
    v_exp_f32 v52, v52
    v_cvt_pk_bf16_f32 v29, v50, v51
    v_exp_f32 v53, v53
    v_exp_f32 v54, v54
    v_exp_f32 v55, v55
    v_cvt_pk_bf16_f32 v30, v52, v53
    v_cvt_pk_bf16_f32 v31, v54, v55
    s_waitcnt lgkmcnt(1)
    v_mfma_f32_32x32x16_bf16 v[40:55], v[12:15], v[4:7], v[128:143]
    v_exp_f32 v56, v56
    v_exp_f32 v57, v57
    v_exp_f32 v58, v58
    v_exp_f32 v59, v59
    v_exp_f32 v60, v60
    v_cvt_pk_bf16_f32 v24, v56, v57
    v_exp_f32 v61, v61
    v_cvt_pk_bf16_f32 v25, v58, v59
    s_waitcnt lgkmcnt(0)
    v_mfma_f32_32x32x16_bf16 v[72:87], v[20:23], v[28:31], v[72:87]
    v_exp_f32 v62, v62
    v_exp_f32 v63, v63
    v_cvt_pk_bf16_f32 v26, v60, v61
    v_cvt_pk_bf16_f32 v27, v62, v63
    v_exp_f32 v64, v64
    v_exp_f32 v65, v65
    v_exp_f32 v66, v66
    v_cvt_pk_bf16_f32 v28, v64, v65
    v_mfma_f32_32x32x16_bf16 v[88:103], v[16:19], v[24:27], 0
    v_exp_f32 v67, v67
    s_mov_b64 exec, s[52:53]
    ds_read_b128 v[16:19], v117 offset:0
    s_mov_b64 exec, -1
    v_exp_f32 v68, v68
    v_cvt_pk_bf16_f32 v29, v66, v67
    v_exp_f32 v69, v69
    v_exp_f32 v70, v70
    v_exp_f32 v71, v71
    v_cvt_pk_bf16_f32 v30, v68, v69
    v_cvt_pk_bf16_f32 v31, v70, v71
    s_waitcnt vmcnt(5)
    s_barrier
    v_mfma_f32_32x32x16_bf16 v[56:71], v[12:15], v[8:11], v[144:159]
    v_exp_f32 v40, v40
    ds_read_b128 v[12:15], v116 offset:12288
    v_exp_f32 v41, v41
    v_exp_f32 v42, v42
    v_exp_f32 v43, v43
    v_exp_f32 v44, v44
    v_cvt_pk_bf16_f32 v24, v40, v41
    v_exp_f32 v45, v45
    v_cvt_pk_bf16_f32 v25, v42, v43
    v_mfma_f32_32x32x16_bf16 v[88:103], v[20:23], v[28:31], v[88:103]
    s_add_u32 m0, s57, s59
    v_exp_f32 v46, v46
    s_mov_b64 exec, s[52:53]
    ds_read_b128 v[20:23], v117 offset:13312
    buffer_load_dwordx4 v114, s[4:7], s55 offen sc1 lds
    s_mov_b64 exec, -1
    v_exp_f32 v47, v47
    s_add_u32 s55, s55, 2048
    s_add_u32 s57, s57, 12288
    s_cmp_eq_u32 s57, 98304
    s_cselect_b32 s57, 0, s57
    v_cvt_pk_bf16_f32 v26, v44, v45
    v_cvt_pk_bf16_f32 v27, v46, v47
    v_exp_f32 v48, v48
    v_exp_f32 v49, v49
    v_exp_f32 v50, v50
    v_cvt_pk_bf16_f32 v28, v48, v49
    s_waitcnt lgkmcnt(2)
    v_mfma_f32_32x32x16_bf16 v[72:87], v[16:19], v[24:27], v[72:87]
    v_exp_f32 v51, v51
    v_exp_f32 v52, v52
    v_cvt_pk_bf16_f32 v29, v50, v51
    v_exp_f32 v53, v53
    v_exp_f32 v54, v54
    v_exp_f32 v55, v55
    v_cvt_pk_bf16_f32 v30, v52, v53
    v_cvt_pk_bf16_f32 v31, v54, v55
    s_waitcnt lgkmcnt(1)
    v_mfma_f32_32x32x16_bf16 v[40:55], v[12:15], v[4:7], v[128:143]
    v_exp_f32 v56, v56
    v_exp_f32 v57, v57
    v_exp_f32 v58, v58
    v_exp_f32 v59, v59
    v_exp_f32 v60, v60
    v_cvt_pk_bf16_f32 v24, v56, v57
    v_exp_f32 v61, v61
    v_cvt_pk_bf16_f32 v25, v58, v59
    s_waitcnt lgkmcnt(0)
    v_mfma_f32_32x32x16_bf16 v[72:87], v[20:23], v[28:31], v[72:87]
    v_exp_f32 v62, v62
    v_exp_f32 v63, v63
    v_cvt_pk_bf16_f32 v26, v60, v61
    v_cvt_pk_bf16_f32 v27, v62, v63
    v_exp_f32 v64, v64
    v_exp_f32 v65, v65
    v_exp_f32 v66, v66
    v_cvt_pk_bf16_f32 v28, v64, v65
    v_mfma_f32_32x32x16_bf16 v[88:103], v[16:19], v[24:27], v[88:103]
    v_exp_f32 v67, v67
    s_mov_b64 exec, s[52:53]
    ds_read_b128 v[16:19], v117 offset:12288
    s_mov_b64 exec, -1
    v_exp_f32 v68, v68
    v_cvt_pk_bf16_f32 v29, v66, v67
    v_exp_f32 v69, v69
    v_exp_f32 v70, v70
    v_exp_f32 v71, v71
    v_cvt_pk_bf16_f32 v30, v68, v69
    v_cvt_pk_bf16_f32 v31, v70, v71
    s_waitcnt vmcnt(5)
    s_barrier
    v_mfma_f32_32x32x16_bf16 v[56:71], v[12:15], v[8:11], v[144:159]
    v_exp_f32 v40, v40
    ds_read_b128 v[12:15], v116 offset:24576
    v_exp_f32 v41, v41
    v_exp_f32 v42, v42
    v_exp_f32 v43, v43
    v_exp_f32 v44, v44
    v_cvt_pk_bf16_f32 v24, v40, v41
    v_exp_f32 v45, v45
    v_cvt_pk_bf16_f32 v25, v42, v43
    v_mfma_f32_32x32x16_bf16 v[88:103], v[20:23], v[28:31], v[88:103]
    s_add_u32 m0, s57, s59
    v_exp_f32 v46, v46
    s_mov_b64 exec, s[52:53]
    ds_read_b128 v[20:23], v117 offset:25600
    buffer_load_dwordx4 v114, s[4:7], s55 offen sc1 lds
    s_mov_b64 exec, -1
    v_exp_f32 v47, v47
    s_add_u32 s55, s55, 2048
    s_add_u32 s57, s57, 12288
    s_cmp_eq_u32 s57, 98304
    s_cselect_b32 s57, 0, s57
    v_cvt_pk_bf16_f32 v26, v44, v45
    v_cvt_pk_bf16_f32 v27, v46, v47
    v_exp_f32 v48, v48
    v_exp_f32 v49, v49
    v_exp_f32 v50, v50
    v_cvt_pk_bf16_f32 v28, v48, v49
    s_waitcnt lgkmcnt(2)
    v_mfma_f32_32x32x16_bf16 v[72:87], v[16:19], v[24:27], v[72:87]
    v_exp_f32 v51, v51
    v_exp_f32 v52, v52
    v_cvt_pk_bf16_f32 v29, v50, v51
    v_exp_f32 v53, v53
    v_exp_f32 v54, v54
    v_exp_f32 v55, v55
    v_cvt_pk_bf16_f32 v30, v52, v53
    v_cvt_pk_bf16_f32 v31, v54, v55
    s_waitcnt lgkmcnt(1)
    v_mfma_f32_32x32x16_bf16 v[40:55], v[12:15], v[4:7], v[128:143]
    v_exp_f32 v56, v56
    v_exp_f32 v57, v57
    v_exp_f32 v58, v58
    v_exp_f32 v59, v59
    v_exp_f32 v60, v60
    v_cvt_pk_bf16_f32 v24, v56, v57
    v_exp_f32 v61, v61
    v_cvt_pk_bf16_f32 v25, v58, v59
    s_waitcnt lgkmcnt(0)
    v_mfma_f32_32x32x16_bf16 v[72:87], v[20:23], v[28:31], v[72:87]
    v_exp_f32 v62, v62
    v_exp_f32 v63, v63
    v_cvt_pk_bf16_f32 v26, v60, v61
    v_cvt_pk_bf16_f32 v27, v62, v63
    v_exp_f32 v64, v64
    v_exp_f32 v65, v65
    v_exp_f32 v66, v66
    v_cvt_pk_bf16_f32 v28, v64, v65
    v_mfma_f32_32x32x16_bf16 v[88:103], v[16:19], v[24:27], v[88:103]
    v_exp_f32 v67, v67
    s_mov_b64 exec, s[52:53]
    ds_read_b128 v[16:19], v117 offset:24576
    s_mov_b64 exec, -1
    v_exp_f32 v68, v68
    v_cvt_pk_bf16_f32 v29, v66, v67
    v_exp_f32 v69, v69
    v_exp_f32 v70, v70
    v_exp_f32 v71, v71
    v_cvt_pk_bf16_f32 v30, v68, v69
    v_cvt_pk_bf16_f32 v31, v70, v71
    s_waitcnt vmcnt(5)
    s_barrier
    v_mfma_f32_32x32x16_bf16 v[56:71], v[12:15], v[8:11], v[144:159]
    v_exp_f32 v40, v40
    ds_read_b128 v[12:15], v116 offset:36864
    v_exp_f32 v41, v41
    v_exp_f32 v42, v42
    v_exp_f32 v43, v43
    v_exp_f32 v44, v44
    v_cvt_pk_bf16_f32 v24, v40, v41
    v_exp_f32 v45, v45
    v_cvt_pk_bf16_f32 v25, v42, v43
    v_mfma_f32_32x32x16_bf16 v[88:103], v[20:23], v[28:31], v[88:103]
    s_add_u32 m0, s57, s59
    v_exp_f32 v46, v46
    s_mov_b64 exec, s[52:53]
    ds_read_b128 v[20:23], v117 offset:37888
    buffer_load_dwordx4 v114, s[4:7], s55 offen sc1 lds
    s_mov_b64 exec, -1
    v_exp_f32 v47, v47
    s_add_u32 s55, s55, 2048
    s_add_u32 s57, s57, 12288
    s_cmp_eq_u32 s57, 98304
    s_cselect_b32 s57, 0, s57
    v_cvt_pk_bf16_f32 v26, v44, v45
    v_cvt_pk_bf16_f32 v27, v46, v47
    v_exp_f32 v48, v48
    v_exp_f32 v49, v49
    v_exp_f32 v50, v50
    v_cvt_pk_bf16_f32 v28, v48, v49
    s_waitcnt lgkmcnt(2)
    v_mfma_f32_32x32x16_bf16 v[72:87], v[16:19], v[24:27], v[72:87]
    v_exp_f32 v51, v51
    v_exp_f32 v52, v52
    v_cvt_pk_bf16_f32 v29, v50, v51
    v_exp_f32 v53, v53
    v_exp_f32 v54, v54
    v_exp_f32 v55, v55
    v_cvt_pk_bf16_f32 v30, v52, v53
    v_cvt_pk_bf16_f32 v31, v54, v55
    s_waitcnt lgkmcnt(1)
    v_mfma_f32_32x32x16_bf16 v[40:55], v[12:15], v[4:7], v[128:143]
    v_exp_f32 v56, v56
    v_exp_f32 v57, v57
    v_exp_f32 v58, v58
    v_exp_f32 v59, v59
    v_exp_f32 v60, v60
    v_cvt_pk_bf16_f32 v24, v56, v57
    v_exp_f32 v61, v61
    v_cvt_pk_bf16_f32 v25, v58, v59
    s_waitcnt lgkmcnt(0)
    v_mfma_f32_32x32x16_bf16 v[72:87], v[20:23], v[28:31], v[72:87]
    v_exp_f32 v62, v62
    v_exp_f32 v63, v63
    v_cvt_pk_bf16_f32 v26, v60, v61
    v_cvt_pk_bf16_f32 v27, v62, v63
    v_exp_f32 v64, v64
    v_exp_f32 v65, v65
    v_exp_f32 v66, v66
    v_cvt_pk_bf16_f32 v28, v64, v65
    v_mfma_f32_32x32x16_bf16 v[88:103], v[16:19], v[24:27], v[88:103]
    v_exp_f32 v67, v67
    s_mov_b64 exec, s[52:53]
    ds_read_b128 v[16:19], v117 offset:36864
    s_mov_b64 exec, -1
    v_exp_f32 v68, v68
    v_cvt_pk_bf16_f32 v29, v66, v67
    v_exp_f32 v69, v69
    v_exp_f32 v70, v70
    v_exp_f32 v71, v71
    v_cvt_pk_bf16_f32 v30, v68, v69
    v_cvt_pk_bf16_f32 v31, v70, v71
    s_waitcnt vmcnt(4)
    s_waitcnt lgkmcnt(0)
    v_add_u32 v116, s60, v116
    v_add_u32 v117, s60, v117
    s_sub_u32 s60, 0, s60
    s_mov_b32 s61, 5
parallel_sum__grouped_kv_mqa__mixer_gmlp__prompt_kernel_b2_loop:
    s_barrier
    v_mfma_f32_32x32x16_bf16 v[56:71], v[12:15], v[8:11], v[144:159]
    v_exp_f32 v40, v40
    ds_read_b128 v[12:15], v116 offset:0
    v_exp_f32 v41, v41
    v_exp_f32 v42, v42
    v_exp_f32 v43, v43
    v_exp_f32 v44, v44
    v_cvt_pk_bf16_f32 v24, v40, v41
    v_exp_f32 v45, v45
    v_cvt_pk_bf16_f32 v25, v42, v43
    v_mfma_f32_32x32x16_bf16 v[88:103], v[20:23], v[28:31], v[88:103]
    s_add_u32 m0, s57, s59
    v_exp_f32 v46, v46
    s_mov_b64 exec, s[52:53]
    ds_read_b128 v[20:23], v117 offset:1024
    buffer_load_dwordx4 v114, s[4:7], s55 offen sc1 lds
    s_mov_b64 exec, -1
    v_exp_f32 v47, v47
    s_add_u32 s55, s55, 2048
    s_add_u32 s57, s57, 12288
    s_cmp_eq_u32 s57, 98304
    s_cselect_b32 s57, 0, s57
    v_cvt_pk_bf16_f32 v26, v44, v45
    v_cvt_pk_bf16_f32 v27, v46, v47
    v_exp_f32 v48, v48
    v_exp_f32 v49, v49
    v_exp_f32 v50, v50
    v_cvt_pk_bf16_f32 v28, v48, v49
    v_mfma_f32_32x32x16_bf16 v[72:87], v[16:19], v[24:27], v[72:87]
    v_exp_f32 v51, v51
    v_exp_f32 v52, v52
    v_cvt_pk_bf16_f32 v29, v50, v51
    v_exp_f32 v53, v53
    v_exp_f32 v54, v54
    v_exp_f32 v55, v55
    v_cvt_pk_bf16_f32 v30, v52, v53
    v_cvt_pk_bf16_f32 v31, v54, v55
    s_waitcnt lgkmcnt(1)
    v_mfma_f32_32x32x16_bf16 v[40:55], v[12:15], v[4:7], v[128:143]
    v_exp_f32 v56, v56
    v_exp_f32 v57, v57
    v_exp_f32 v58, v58
    v_exp_f32 v59, v59
    v_exp_f32 v60, v60
    v_cvt_pk_bf16_f32 v24, v56, v57
    v_exp_f32 v61, v61
    v_cvt_pk_bf16_f32 v25, v58, v59
    s_waitcnt lgkmcnt(0)
    v_mfma_f32_32x32x16_bf16 v[72:87], v[20:23], v[28:31], v[72:87]
    v_exp_f32 v62, v62
    v_exp_f32 v63, v63
    v_cvt_pk_bf16_f32 v26, v60, v61
    v_cvt_pk_bf16_f32 v27, v62, v63
    v_exp_f32 v64, v64
    v_exp_f32 v65, v65
    v_exp_f32 v66, v66
    v_cvt_pk_bf16_f32 v28, v64, v65
    v_mfma_f32_32x32x16_bf16 v[88:103], v[16:19], v[24:27], v[88:103]
    v_exp_f32 v67, v67
    s_mov_b64 exec, s[52:53]
    ds_read_b128 v[16:19], v117 offset:0
    s_mov_b64 exec, -1
    v_exp_f32 v68, v68
    v_cvt_pk_bf16_f32 v29, v66, v67
    v_exp_f32 v69, v69
    v_exp_f32 v70, v70
    v_exp_f32 v71, v71
    v_cvt_pk_bf16_f32 v30, v68, v69
    v_cvt_pk_bf16_f32 v31, v70, v71
    v_mfma_f32_32x32x16_bf16 v[56:71], v[12:15], v[8:11], v[144:159]
    v_exp_f32 v40, v40
    ds_read_b128 v[12:15], v116 offset:12288
    v_exp_f32 v41, v41
    v_exp_f32 v42, v42
    v_exp_f32 v43, v43
    v_exp_f32 v44, v44
    v_cvt_pk_bf16_f32 v24, v40, v41
    v_exp_f32 v45, v45
    v_cvt_pk_bf16_f32 v25, v42, v43
    v_mfma_f32_32x32x16_bf16 v[88:103], v[20:23], v[28:31], v[88:103]
    s_add_u32 m0, s57, s59
    v_exp_f32 v46, v46
    s_mov_b64 exec, s[52:53]
    ds_read_b128 v[20:23], v117 offset:13312
    buffer_load_dwordx4 v114, s[4:7], s55 offen sc1 lds
    s_mov_b64 exec, -1
    v_exp_f32 v47, v47
    s_add_u32 s55, s55, 2048
    s_add_u32 s57, s57, 12288
    s_cmp_eq_u32 s57, 98304
    s_cselect_b32 s57, 0, s57
    v_cvt_pk_bf16_f32 v26, v44, v45
    v_cvt_pk_bf16_f32 v27, v46, v47
    v_exp_f32 v48, v48
    v_exp_f32 v49, v49
    v_exp_f32 v50, v50
    v_cvt_pk_bf16_f32 v28, v48, v49
    s_waitcnt lgkmcnt(2)
    v_mfma_f32_32x32x16_bf16 v[72:87], v[16:19], v[24:27], v[72:87]
    v_exp_f32 v51, v51
    v_exp_f32 v52, v52
    v_cvt_pk_bf16_f32 v29, v50, v51
    v_exp_f32 v53, v53
    v_exp_f32 v54, v54
    v_exp_f32 v55, v55
    v_cvt_pk_bf16_f32 v30, v52, v53
    v_cvt_pk_bf16_f32 v31, v54, v55
    s_waitcnt lgkmcnt(1)
    v_mfma_f32_32x32x16_bf16 v[40:55], v[12:15], v[4:7], v[128:143]
    v_exp_f32 v56, v56
    v_exp_f32 v57, v57
    v_exp_f32 v58, v58
    v_exp_f32 v59, v59
    v_exp_f32 v60, v60
    v_cvt_pk_bf16_f32 v24, v56, v57
    v_exp_f32 v61, v61
    v_cvt_pk_bf16_f32 v25, v58, v59
    s_waitcnt lgkmcnt(0)
    v_mfma_f32_32x32x16_bf16 v[72:87], v[20:23], v[28:31], v[72:87]
    v_exp_f32 v62, v62
    v_exp_f32 v63, v63
    v_cvt_pk_bf16_f32 v26, v60, v61
    v_cvt_pk_bf16_f32 v27, v62, v63
    v_exp_f32 v64, v64
    v_exp_f32 v65, v65
    v_exp_f32 v66, v66
    v_cvt_pk_bf16_f32 v28, v64, v65
    v_mfma_f32_32x32x16_bf16 v[88:103], v[16:19], v[24:27], v[88:103]
    v_exp_f32 v67, v67
    s_mov_b64 exec, s[52:53]
    ds_read_b128 v[16:19], v117 offset:12288
    s_mov_b64 exec, -1
    v_exp_f32 v68, v68
    v_cvt_pk_bf16_f32 v29, v66, v67
    v_exp_f32 v69, v69
    v_exp_f32 v70, v70
    v_exp_f32 v71, v71
    v_cvt_pk_bf16_f32 v30, v68, v69
    v_cvt_pk_bf16_f32 v31, v70, v71
    s_waitcnt vmcnt(4)
    s_waitcnt lgkmcnt(0)
    s_barrier
    v_mfma_f32_32x32x16_bf16 v[56:71], v[12:15], v[8:11], v[144:159]
    v_exp_f32 v40, v40
    ds_read_b128 v[12:15], v116 offset:24576
    v_exp_f32 v41, v41
    v_exp_f32 v42, v42
    v_exp_f32 v43, v43
    v_exp_f32 v44, v44
    v_cvt_pk_bf16_f32 v24, v40, v41
    v_exp_f32 v45, v45
    v_cvt_pk_bf16_f32 v25, v42, v43
    v_mfma_f32_32x32x16_bf16 v[88:103], v[20:23], v[28:31], v[88:103]
    s_add_u32 m0, s57, s59
    v_exp_f32 v46, v46
    s_mov_b64 exec, s[52:53]
    ds_read_b128 v[20:23], v117 offset:25600
    buffer_load_dwordx4 v114, s[4:7], s55 offen sc1 lds
    s_mov_b64 exec, -1
    v_exp_f32 v47, v47
    s_add_u32 s55, s55, 2048
    s_add_u32 s57, s57, 12288
    s_cmp_eq_u32 s57, 98304
    s_cselect_b32 s57, 0, s57
    v_cvt_pk_bf16_f32 v26, v44, v45
    v_cvt_pk_bf16_f32 v27, v46, v47
    v_exp_f32 v48, v48
    v_exp_f32 v49, v49
    v_exp_f32 v50, v50
    v_cvt_pk_bf16_f32 v28, v48, v49
    v_mfma_f32_32x32x16_bf16 v[72:87], v[16:19], v[24:27], v[72:87]
    v_exp_f32 v51, v51
    v_exp_f32 v52, v52
    v_cvt_pk_bf16_f32 v29, v50, v51
    v_exp_f32 v53, v53
    v_exp_f32 v54, v54
    v_exp_f32 v55, v55
    v_cvt_pk_bf16_f32 v30, v52, v53
    v_cvt_pk_bf16_f32 v31, v54, v55
    s_waitcnt lgkmcnt(1)
    v_mfma_f32_32x32x16_bf16 v[40:55], v[12:15], v[4:7], v[128:143]
    v_exp_f32 v56, v56
    v_exp_f32 v57, v57
    v_exp_f32 v58, v58
    v_exp_f32 v59, v59
    v_exp_f32 v60, v60
    v_cvt_pk_bf16_f32 v24, v56, v57
    v_exp_f32 v61, v61
    v_cvt_pk_bf16_f32 v25, v58, v59
    s_waitcnt lgkmcnt(0)
    v_mfma_f32_32x32x16_bf16 v[72:87], v[20:23], v[28:31], v[72:87]
    v_exp_f32 v62, v62
    v_exp_f32 v63, v63
    v_cvt_pk_bf16_f32 v26, v60, v61
    v_cvt_pk_bf16_f32 v27, v62, v63
    v_exp_f32 v64, v64
    v_exp_f32 v65, v65
    v_exp_f32 v66, v66
    v_cvt_pk_bf16_f32 v28, v64, v65
    v_mfma_f32_32x32x16_bf16 v[88:103], v[16:19], v[24:27], v[88:103]
    v_exp_f32 v67, v67
    s_mov_b64 exec, s[52:53]
    ds_read_b128 v[16:19], v117 offset:24576
    s_mov_b64 exec, -1
    v_exp_f32 v68, v68
    v_cvt_pk_bf16_f32 v29, v66, v67
    v_exp_f32 v69, v69
    v_exp_f32 v70, v70
    v_exp_f32 v71, v71
    v_cvt_pk_bf16_f32 v30, v68, v69
    v_cvt_pk_bf16_f32 v31, v70, v71
    v_mfma_f32_32x32x16_bf16 v[56:71], v[12:15], v[8:11], v[144:159]
    v_exp_f32 v40, v40
    ds_read_b128 v[12:15], v116 offset:36864
    v_exp_f32 v41, v41
    v_exp_f32 v42, v42
    v_exp_f32 v43, v43
    v_exp_f32 v44, v44
    v_cvt_pk_bf16_f32 v24, v40, v41
    v_exp_f32 v45, v45
    v_cvt_pk_bf16_f32 v25, v42, v43
    v_mfma_f32_32x32x16_bf16 v[88:103], v[20:23], v[28:31], v[88:103]
    s_add_u32 m0, s57, s59
    v_exp_f32 v46, v46
    s_mov_b64 exec, s[52:53]
    ds_read_b128 v[20:23], v117 offset:37888
    buffer_load_dwordx4 v114, s[4:7], s55 offen sc1 lds
    s_mov_b64 exec, -1
    v_exp_f32 v47, v47
    s_add_u32 s55, s55, 2048
    s_add_u32 s57, s57, 12288
    s_cmp_eq_u32 s57, 98304
    s_cselect_b32 s57, 0, s57
    v_cvt_pk_bf16_f32 v26, v44, v45
    v_cvt_pk_bf16_f32 v27, v46, v47
    v_exp_f32 v48, v48
    v_exp_f32 v49, v49
    v_exp_f32 v50, v50
    v_cvt_pk_bf16_f32 v28, v48, v49
    s_waitcnt lgkmcnt(2)
    v_mfma_f32_32x32x16_bf16 v[72:87], v[16:19], v[24:27], v[72:87]
    v_exp_f32 v51, v51
    v_exp_f32 v52, v52
    v_cvt_pk_bf16_f32 v29, v50, v51
    v_exp_f32 v53, v53
    v_exp_f32 v54, v54
    v_exp_f32 v55, v55
    v_cvt_pk_bf16_f32 v30, v52, v53
    v_cvt_pk_bf16_f32 v31, v54, v55
    s_waitcnt lgkmcnt(1)
    v_mfma_f32_32x32x16_bf16 v[40:55], v[12:15], v[4:7], v[128:143]
    v_exp_f32 v56, v56
    v_exp_f32 v57, v57
    v_exp_f32 v58, v58
    v_exp_f32 v59, v59
    v_exp_f32 v60, v60
    v_cvt_pk_bf16_f32 v24, v56, v57
    v_exp_f32 v61, v61
    v_cvt_pk_bf16_f32 v25, v58, v59
    s_waitcnt lgkmcnt(0)
    v_mfma_f32_32x32x16_bf16 v[72:87], v[20:23], v[28:31], v[72:87]
    v_exp_f32 v62, v62
    v_exp_f32 v63, v63
    v_cvt_pk_bf16_f32 v26, v60, v61
    v_cvt_pk_bf16_f32 v27, v62, v63
    v_exp_f32 v64, v64
    v_exp_f32 v65, v65
    v_exp_f32 v66, v66
    v_cvt_pk_bf16_f32 v28, v64, v65
    v_mfma_f32_32x32x16_bf16 v[88:103], v[16:19], v[24:27], v[88:103]
    v_exp_f32 v67, v67
    s_mov_b64 exec, s[52:53]
    ds_read_b128 v[16:19], v117 offset:36864
    s_mov_b64 exec, -1
    v_exp_f32 v68, v68
    v_cvt_pk_bf16_f32 v29, v66, v67
    v_exp_f32 v69, v69
    v_exp_f32 v70, v70
    v_exp_f32 v71, v71
    v_cvt_pk_bf16_f32 v30, v68, v69
    v_cvt_pk_bf16_f32 v31, v70, v71
    s_waitcnt vmcnt(4)
    s_waitcnt lgkmcnt(0)
    v_add_u32 v116, s60, v116
    v_add_u32 v117, s60, v117
    s_sub_u32 s60, 0, s60
    s_sub_u32 s61, s61, 1
    s_cmp_lg_u32 s61, 0
    s_cbranch_scc1 parallel_sum__grouped_kv_mqa__mixer_gmlp__prompt_kernel_b2_loop
    s_barrier
    v_mfma_f32_32x32x16_bf16 v[56:71], v[12:15], v[8:11], v[144:159]
    v_exp_f32 v40, v40
    ds_read_b128 v[12:15], v116 offset:0
    v_exp_f32 v41, v41
    v_exp_f32 v42, v42
    v_exp_f32 v43, v43
    v_exp_f32 v44, v44
    v_cvt_pk_bf16_f32 v24, v40, v41
    v_exp_f32 v45, v45
    v_cvt_pk_bf16_f32 v25, v42, v43
    v_mfma_f32_32x32x16_bf16 v[88:103], v[20:23], v[28:31], v[88:103]
    s_add_u32 m0, s57, s59
    v_exp_f32 v46, v46
    s_mov_b64 exec, s[52:53]
    ds_read_b128 v[20:23], v117 offset:1024
    buffer_load_dwordx4 v114, s[4:7], s55 offen sc1 lds
    s_mov_b64 exec, -1
    v_exp_f32 v47, v47
    s_add_u32 s55, s55, 2048
    s_add_u32 s57, s57, 12288
    s_cmp_eq_u32 s57, 98304
    s_cselect_b32 s57, 0, s57
    v_cvt_pk_bf16_f32 v26, v44, v45
    v_cvt_pk_bf16_f32 v27, v46, v47
    v_exp_f32 v48, v48
    v_exp_f32 v49, v49
    v_exp_f32 v50, v50
    v_cvt_pk_bf16_f32 v28, v48, v49
    v_mfma_f32_32x32x16_bf16 v[72:87], v[16:19], v[24:27], v[72:87]
    v_exp_f32 v51, v51
    v_exp_f32 v52, v52
    v_cvt_pk_bf16_f32 v29, v50, v51
    v_exp_f32 v53, v53
    v_exp_f32 v54, v54
    v_exp_f32 v55, v55
    v_cvt_pk_bf16_f32 v30, v52, v53
    v_cvt_pk_bf16_f32 v31, v54, v55
    s_waitcnt lgkmcnt(1)
    v_mfma_f32_32x32x16_bf16 v[40:55], v[12:15], v[4:7], v[128:143]
    v_exp_f32 v56, v56
    v_bfe_u32 v225, v1, 2, 2
    v_and_b32 v226, 3, v1
    v_lshrrev_b32 v227, 4, v1
    v_lshrrev_b32 v224, 1, v227
    v_lshl_add_u32 v224, v224, 2, v225
    s_lshl_b32 s62, s49, 3
    v_add_u32 v224, s62, v224
    v_lshlrev_b32 v105, 10, v224
    v_and_b32 v224, 1, v227
    v_lshl_add_u32 v105, v224, 6, v105
    v_lshl_add_u32 v105, v226, 4, v105
    s_lshl_b32 s62, s47, 7
    v_add_u32 v105, s62, v105
    v_lshlrev_b32 v106, 9, v2
    v_lshl_add_u32 v106, v225, 6, v106
    v_lshl_add_u32 v106, v224, 5, v106
    v_lshl_add_u32 v106, v226, 3, v106
    s_lshl_b32 s62, s50, 14
    s_add_u32 s62, s62, 98304
    v_add_u32 v107, s62, v106
    s_lshl_b32 s62, s50, 11
    s_add_u32 s62, s62, 0
    v_add_u32 v106, s62, v106
    v_add_u32 v108, 65536, v106
    s_lshl_b32 s62, s49, 10
    s_lshl_b32 s63, s50, 14
    s_add_u32 s96, s62, s63
    s_add_u32 s96, s96, 98304
    s_lshl_b32 s97, s50, 17
    s_lshl_b32 s63, s50, 11
    s_add_u32 s98, s62, s63
    s_mul_i32 s99, s50, 229376
    v_exp_f32 v57, v57
    v_exp_f32 v58, v58
    v_exp_f32 v59, v59
    v_exp_f32 v60, v60
    v_cvt_pk_bf16_f32 v24, v56, v57
    v_exp_f32 v61, v61
    v_cvt_pk_bf16_f32 v25, v58, v59
    s_waitcnt lgkmcnt(0)
    v_mfma_f32_32x32x16_bf16 v[72:87], v[20:23], v[28:31], v[72:87]
    v_exp_f32 v62, v62
    s_add_u32 m0, s96, 0
    s_add_u32 s62, s97, 0
    buffer_load_dwordx4 v105, s[28:31], s62 offen lds
    v_exp_f32 v63, v63
    v_cvt_pk_bf16_f32 v26, v60, v61
    v_cvt_pk_bf16_f32 v27, v62, v63
    v_exp_f32 v64, v64
    v_exp_f32 v65, v65
    v_exp_f32 v66, v66
    v_cvt_pk_bf16_f32 v28, v64, v65
    v_mfma_f32_32x32x16_bf16 v[88:103], v[16:19], v[24:27], v[88:103]
    v_exp_f32 v67, v67
    s_mov_b64 exec, s[52:53]
    ds_read_b128 v[16:19], v117 offset:0
    s_mov_b64 exec, -1
    v_exp_f32 v68, v68
    v_cvt_pk_bf16_f32 v29, v66, v67
    v_exp_f32 v69, v69
    v_exp_f32 v70, v70
    v_exp_f32 v71, v71
    v_cvt_pk_bf16_f32 v30, v68, v69
    v_cvt_pk_bf16_f32 v31, v70, v71
    s_barrier
    v_mfma_f32_32x32x16_bf16 v[56:71], v[12:15], v[8:11], v[144:159]
    v_exp_f32 v40, v40
    ds_read_b128 v[12:15], v116 offset:12288
    v_exp_f32 v41, v41
    v_exp_f32 v42, v42
    v_exp_f32 v43, v43
    v_exp_f32 v44, v44
    v_cvt_pk_bf16_f32 v24, v40, v41
    v_exp_f32 v45, v45
    v_cvt_pk_bf16_f32 v25, v42, v43
    v_mfma_f32_32x32x16_bf16 v[88:103], v[20:23], v[28:31], v[88:103]
    s_add_u32 m0, s57, s59
    v_exp_f32 v46, v46
    s_mov_b64 exec, s[52:53]
    ds_read_b128 v[20:23], v117 offset:13312
    buffer_load_dwordx4 v114, s[4:7], s55 offen sc1 lds
    s_mov_b64 exec, -1
    v_exp_f32 v47, v47
    s_add_u32 s55, s55, 2048
    s_add_u32 s57, s57, 12288
    s_cmp_eq_u32 s57, 98304
    s_cselect_b32 s57, 0, s57
    v_cvt_pk_bf16_f32 v26, v44, v45
    v_cvt_pk_bf16_f32 v27, v46, v47
    v_exp_f32 v48, v48
    v_exp_f32 v49, v49
    v_exp_f32 v50, v50
    v_cvt_pk_bf16_f32 v28, v48, v49
    s_waitcnt lgkmcnt(2)
    v_mfma_f32_32x32x16_bf16 v[72:87], v[16:19], v[24:27], v[72:87]
    v_exp_f32 v51, v51
    v_exp_f32 v52, v52
    v_cvt_pk_bf16_f32 v29, v50, v51
    v_exp_f32 v53, v53
    v_exp_f32 v54, v54
    v_exp_f32 v55, v55
    v_cvt_pk_bf16_f32 v30, v52, v53
    v_cvt_pk_bf16_f32 v31, v54, v55
    s_waitcnt lgkmcnt(1)
    v_mfma_f32_32x32x16_bf16 v[40:55], v[12:15], v[4:7], v[128:143]
    v_exp_f32 v56, v56
    s_add_u32 m0, s96, 2048
    s_add_u32 s62, s97, 16384
    buffer_load_dwordx4 v105, s[28:31], s62 offen lds
    v_exp_f32 v57, v57
    v_exp_f32 v58, v58
    v_exp_f32 v59, v59
    v_exp_f32 v60, v60
    v_cvt_pk_bf16_f32 v24, v56, v57
    v_exp_f32 v61, v61
    v_cvt_pk_bf16_f32 v25, v58, v59
    s_waitcnt lgkmcnt(0)
    v_mfma_f32_32x32x16_bf16 v[72:87], v[20:23], v[28:31], v[72:87]
    v_exp_f32 v62, v62
    v_exp_f32 v63, v63
    v_cvt_pk_bf16_f32 v26, v60, v61
    v_cvt_pk_bf16_f32 v27, v62, v63
    v_exp_f32 v64, v64
    v_exp_f32 v65, v65
    v_exp_f32 v66, v66
    v_cvt_pk_bf16_f32 v28, v64, v65
    v_mfma_f32_32x32x16_bf16 v[88:103], v[16:19], v[24:27], v[88:103]
    v_exp_f32 v67, v67
    s_mov_b64 exec, s[52:53]
    ds_read_b128 v[16:19], v117 offset:12288
    s_mov_b64 exec, -1
    v_exp_f32 v68, v68
    v_cvt_pk_bf16_f32 v29, v66, v67
    v_exp_f32 v69, v69
    v_exp_f32 v70, v70
    v_exp_f32 v71, v71
    v_cvt_pk_bf16_f32 v30, v68, v69
    v_cvt_pk_bf16_f32 v31, v70, v71
    s_waitcnt vmcnt(7)
    s_barrier
    v_mfma_f32_32x32x16_bf16 v[56:71], v[12:15], v[8:11], v[144:159]
    v_exp_f32 v40, v40
    ds_read_b128 v[12:15], v116 offset:24576
    v_exp_f32 v41, v41
    v_exp_f32 v42, v42
    v_exp_f32 v43, v43
    v_exp_f32 v44, v44
    v_cvt_pk_bf16_f32 v24, v40, v41
    v_exp_f32 v45, v45
    v_cvt_pk_bf16_f32 v25, v42, v43
    v_mfma_f32_32x32x16_bf16 v[88:103], v[20:23], v[28:31], v[88:103]
    v_exp_f32 v46, v46
    s_mov_b64 exec, s[52:53]
    ds_read_b128 v[20:23], v117 offset:25600
    s_mov_b64 exec, -1
    v_exp_f32 v47, v47
    v_cvt_pk_bf16_f32 v26, v44, v45
    v_cvt_pk_bf16_f32 v27, v46, v47
    v_exp_f32 v48, v48
    v_exp_f32 v49, v49
    v_exp_f32 v50, v50
    v_cvt_pk_bf16_f32 v28, v48, v49
    s_waitcnt lgkmcnt(2)
    v_mfma_f32_32x32x16_bf16 v[72:87], v[16:19], v[24:27], v[72:87]
    v_exp_f32 v51, v51
    v_exp_f32 v52, v52
    v_cvt_pk_bf16_f32 v29, v50, v51
    v_exp_f32 v53, v53
    v_exp_f32 v54, v54
    v_exp_f32 v55, v55
    v_cvt_pk_bf16_f32 v30, v52, v53
    v_cvt_pk_bf16_f32 v31, v54, v55
    s_waitcnt lgkmcnt(1)
    v_mfma_f32_32x32x16_bf16 v[40:55], v[12:15], v[4:7], v[128:143]
    v_exp_f32 v56, v56
    s_add_u32 m0, s96, 4096
    s_add_u32 s62, s97, 32768
    buffer_load_dwordx4 v105, s[28:31], s62 offen lds
    v_exp_f32 v57, v57
    v_exp_f32 v58, v58
    v_exp_f32 v59, v59
    v_exp_f32 v60, v60
    v_cvt_pk_bf16_f32 v24, v56, v57
    v_exp_f32 v61, v61
    v_cvt_pk_bf16_f32 v25, v58, v59
    s_waitcnt lgkmcnt(0)
    v_mfma_f32_32x32x16_bf16 v[72:87], v[20:23], v[28:31], v[72:87]
    v_exp_f32 v62, v62
    s_add_u32 m0, s98, 0
    s_add_u32 s62, s99, 196608
    buffer_load_dwordx4 v105, s[32:35], s62 offen lds
    v_exp_f32 v63, v63
    v_cvt_pk_bf16_f32 v26, v60, v61
    v_cvt_pk_bf16_f32 v27, v62, v63
    v_exp_f32 v64, v64
    v_exp_f32 v65, v65
    v_exp_f32 v66, v66
    v_cvt_pk_bf16_f32 v28, v64, v65
    v_mfma_f32_32x32x16_bf16 v[88:103], v[16:19], v[24:27], v[88:103]
    v_exp_f32 v67, v67
    s_mov_b64 exec, s[52:53]
    ds_read_b128 v[16:19], v117 offset:24576
    s_mov_b64 exec, -1
    v_exp_f32 v68, v68
    v_cvt_pk_bf16_f32 v29, v66, v67
    v_exp_f32 v69, v69
    v_exp_f32 v70, v70
    v_exp_f32 v71, v71
    v_cvt_pk_bf16_f32 v30, v68, v69
    v_cvt_pk_bf16_f32 v31, v70, v71
    s_waitcnt vmcnt(8)
    s_barrier
    v_mfma_f32_32x32x16_bf16 v[56:71], v[12:15], v[8:11], v[144:159]
    v_exp_f32 v40, v40
    ds_read_b128 v[12:15], v116 offset:36864
    v_exp_f32 v41, v41
    v_exp_f32 v42, v42
    v_exp_f32 v43, v43
    v_exp_f32 v44, v44
    v_cvt_pk_bf16_f32 v24, v40, v41
    v_exp_f32 v45, v45
    v_cvt_pk_bf16_f32 v25, v42, v43
    v_mfma_f32_32x32x16_bf16 v[88:103], v[20:23], v[28:31], v[88:103]
    v_exp_f32 v46, v46
    s_mov_b64 exec, s[52:53]
    ds_read_b128 v[20:23], v117 offset:37888
    s_mov_b64 exec, -1
    v_exp_f32 v47, v47
    v_cvt_pk_bf16_f32 v26, v44, v45
    v_cvt_pk_bf16_f32 v27, v46, v47
    v_exp_f32 v48, v48
    v_exp_f32 v49, v49
    v_exp_f32 v50, v50
    v_cvt_pk_bf16_f32 v28, v48, v49
    s_waitcnt lgkmcnt(2)
    v_mfma_f32_32x32x16_bf16 v[72:87], v[16:19], v[24:27], v[72:87]
    v_exp_f32 v51, v51
    v_exp_f32 v52, v52
    v_cvt_pk_bf16_f32 v29, v50, v51
    v_exp_f32 v53, v53
    v_exp_f32 v54, v54
    v_exp_f32 v55, v55
    v_cvt_pk_bf16_f32 v30, v52, v53
    v_cvt_pk_bf16_f32 v31, v54, v55
    s_waitcnt lgkmcnt(1)
    v_mfma_f32_32x32x16_bf16 v[40:55], v[12:15], v[4:7], v[128:143]
    v_exp_f32 v56, v56
    s_add_u32 m0, s96, 6144
    s_add_u32 s62, s97, 49152
    buffer_load_dwordx4 v105, s[28:31], s62 offen lds
    v_exp_f32 v57, v57
    v_exp_f32 v58, v58
    v_exp_f32 v59, v59
    v_exp_f32 v60, v60
    v_cvt_pk_bf16_f32 v24, v56, v57
    v_exp_f32 v61, v61
    v_cvt_pk_bf16_f32 v25, v58, v59
    s_waitcnt lgkmcnt(0)
    v_mfma_f32_32x32x16_bf16 v[72:87], v[20:23], v[28:31], v[72:87]
    v_exp_f32 v62, v62
    s_add_u32 m0, s98, 8192
    s_add_u32 s62, s99, 212992
    buffer_load_dwordx4 v105, s[32:35], s62 offen lds
    v_exp_f32 v63, v63
    v_cvt_pk_bf16_f32 v26, v60, v61
    v_cvt_pk_bf16_f32 v27, v62, v63
    v_exp_f32 v64, v64
    v_exp_f32 v65, v65
    v_exp_f32 v66, v66
    v_cvt_pk_bf16_f32 v28, v64, v65
    v_mfma_f32_32x32x16_bf16 v[88:103], v[16:19], v[24:27], v[88:103]
    v_exp_f32 v67, v67
    s_mov_b64 exec, s[52:53]
    ds_read_b128 v[16:19], v117 offset:36864
    s_mov_b64 exec, -1
    v_exp_f32 v68, v68
    v_cvt_pk_bf16_f32 v29, v66, v67
    v_exp_f32 v69, v69
    v_exp_f32 v70, v70
    v_exp_f32 v71, v71
    v_cvt_pk_bf16_f32 v30, v68, v69
    v_cvt_pk_bf16_f32 v31, v70, v71
    s_waitcnt vmcnt(9)
    v_add_u32 v116, s60, v116
    v_add_u32 v117, s60, v117
    s_sub_u32 s60, 0, s60
    s_barrier
    v_mfma_f32_32x32x16_bf16 v[56:71], v[12:15], v[8:11], v[144:159]
    v_exp_f32 v40, v40
    ds_read_b128 v[12:15], v116 offset:0
    v_exp_f32 v41, v41
    v_exp_f32 v42, v42
    v_exp_f32 v43, v43
    v_exp_f32 v44, v44
    v_cvt_pk_bf16_f32 v24, v40, v41
    v_exp_f32 v45, v45
    v_cvt_pk_bf16_f32 v25, v42, v43
    v_mfma_f32_32x32x16_bf16 v[88:103], v[20:23], v[28:31], v[88:103]
    v_exp_f32 v46, v46
    s_mov_b64 exec, s[52:53]
    ds_read_b128 v[20:23], v117 offset:1024
    s_mov_b64 exec, -1
    v_exp_f32 v47, v47
    v_cvt_pk_bf16_f32 v26, v44, v45
    v_cvt_pk_bf16_f32 v27, v46, v47
    v_exp_f32 v48, v48
    v_exp_f32 v49, v49
    v_exp_f32 v50, v50
    v_cvt_pk_bf16_f32 v28, v48, v49
    s_waitcnt lgkmcnt(2)
    v_mfma_f32_32x32x16_bf16 v[72:87], v[16:19], v[24:27], v[72:87]
    v_exp_f32 v51, v51
    v_exp_f32 v52, v52
    v_cvt_pk_bf16_f32 v29, v50, v51
    v_exp_f32 v53, v53
    v_exp_f32 v54, v54
    v_exp_f32 v55, v55
    v_cvt_pk_bf16_f32 v30, v52, v53
    v_cvt_pk_bf16_f32 v31, v54, v55
    s_waitcnt lgkmcnt(1)
    v_mfma_f32_32x32x16_bf16 v[40:55], v[12:15], v[4:7], v[128:143]
    v_exp_f32 v56, v56
    s_add_u32 m0, s96, 8192
    s_add_u32 s62, s97, 65536
    buffer_load_dwordx4 v105, s[28:31], s62 offen lds
    v_exp_f32 v57, v57
    v_exp_f32 v58, v58
    v_exp_f32 v59, v59
    v_exp_f32 v60, v60
    v_cvt_pk_bf16_f32 v24, v56, v57
    v_exp_f32 v61, v61
    v_cvt_pk_bf16_f32 v25, v58, v59
    s_waitcnt lgkmcnt(0)
    v_mfma_f32_32x32x16_bf16 v[72:87], v[20:23], v[28:31], v[72:87]
    v_exp_f32 v62, v62
    v_exp_f32 v63, v63
    v_cvt_pk_bf16_f32 v26, v60, v61
    v_cvt_pk_bf16_f32 v27, v62, v63
    v_exp_f32 v64, v64
    v_exp_f32 v65, v65
    v_exp_f32 v66, v66
    v_cvt_pk_bf16_f32 v28, v64, v65
    v_mfma_f32_32x32x16_bf16 v[88:103], v[16:19], v[24:27], v[88:103]
    v_exp_f32 v67, v67
    s_mov_b64 exec, s[52:53]
    ds_read_b128 v[16:19], v117 offset:0
    s_mov_b64 exec, -1
    v_exp_f32 v68, v68
    v_cvt_pk_bf16_f32 v29, v66, v67
    v_exp_f32 v69, v69
    v_exp_f32 v70, v70
    v_exp_f32 v71, v71
    v_cvt_pk_bf16_f32 v30, v68, v69
    v_cvt_pk_bf16_f32 v31, v70, v71
    s_waitcnt vmcnt(9)
    s_barrier
    v_mfma_f32_32x32x16_bf16 v[56:71], v[12:15], v[8:11], v[144:159]
    v_exp_f32 v40, v40
    ds_read_b128 v[12:15], v116 offset:12288
    v_exp_f32 v41, v41
    v_exp_f32 v42, v42
    v_exp_f32 v43, v43
    v_exp_f32 v44, v44
    v_cvt_pk_bf16_f32 v24, v40, v41
    v_exp_f32 v45, v45
    v_cvt_pk_bf16_f32 v25, v42, v43
    v_mfma_f32_32x32x16_bf16 v[88:103], v[20:23], v[28:31], v[88:103]
    v_exp_f32 v46, v46
    s_mov_b64 exec, s[52:53]
    ds_read_b128 v[20:23], v117 offset:13312
    s_mov_b64 exec, -1
    v_exp_f32 v47, v47
    v_cvt_pk_bf16_f32 v26, v44, v45
    v_cvt_pk_bf16_f32 v27, v46, v47
    v_exp_f32 v48, v48
    v_exp_f32 v49, v49
    v_exp_f32 v50, v50
    v_cvt_pk_bf16_f32 v28, v48, v49
    s_waitcnt lgkmcnt(2)
    v_mfma_f32_32x32x16_bf16 v[72:87], v[16:19], v[24:27], v[72:87]
    v_exp_f32 v51, v51
    v_exp_f32 v52, v52
    v_cvt_pk_bf16_f32 v29, v50, v51
    v_exp_f32 v53, v53
    v_exp_f32 v54, v54
    v_exp_f32 v55, v55
    v_cvt_pk_bf16_f32 v30, v52, v53
    v_cvt_pk_bf16_f32 v31, v54, v55
    s_waitcnt lgkmcnt(1)
    v_mfma_f32_32x32x16_bf16 v[40:55], v[12:15], v[4:7], v[128:143]
    v_exp_f32 v56, v56
    s_add_u32 m0, s96, 10240
    s_add_u32 s62, s97, 81920
    buffer_load_dwordx4 v105, s[28:31], s62 offen lds
    v_exp_f32 v57, v57
    v_exp_f32 v58, v58
    v_exp_f32 v59, v59
    v_exp_f32 v60, v60
    v_cvt_pk_bf16_f32 v24, v56, v57
    v_exp_f32 v61, v61
    v_cvt_pk_bf16_f32 v25, v58, v59
    s_waitcnt lgkmcnt(0)
    v_mfma_f32_32x32x16_bf16 v[72:87], v[20:23], v[28:31], v[72:87]
    v_exp_f32 v62, v62
    s_add_u32 m0, s98, 16384
    s_add_u32 s62, s99, 32768
    buffer_load_dwordx4 v105, s[32:35], s62 offen lds
    v_exp_f32 v63, v63
    v_cvt_pk_bf16_f32 v26, v60, v61
    v_cvt_pk_bf16_f32 v27, v62, v63
    v_exp_f32 v64, v64
    v_exp_f32 v65, v65
    v_exp_f32 v66, v66
    v_cvt_pk_bf16_f32 v28, v64, v65
    v_mfma_f32_32x32x16_bf16 v[88:103], v[16:19], v[24:27], v[88:103]
    v_exp_f32 v67, v67
    s_mov_b64 exec, s[52:53]
    ds_read_b128 v[16:19], v117 offset:12288
    s_mov_b64 exec, -1
    v_exp_f32 v68, v68
    v_cvt_pk_bf16_f32 v29, v66, v67
    v_exp_f32 v69, v69
    v_exp_f32 v70, v70
    v_exp_f32 v71, v71
    v_cvt_pk_bf16_f32 v30, v68, v69
    v_cvt_pk_bf16_f32 v31, v70, v71
    s_waitcnt vmcnt(10)
    s_barrier
    v_mfma_f32_32x32x16_bf16 v[56:71], v[12:15], v[8:11], v[144:159]
    v_exp_f32 v40, v40
    ds_read_b128 v[12:15], v116 offset:24576
    v_exp_f32 v41, v41
    v_exp_f32 v42, v42
    v_exp_f32 v43, v43
    v_exp_f32 v44, v44
    v_cvt_pk_bf16_f32 v24, v40, v41
    v_exp_f32 v45, v45
    v_cvt_pk_bf16_f32 v25, v42, v43
    v_mfma_f32_32x32x16_bf16 v[88:103], v[20:23], v[28:31], v[88:103]
    v_exp_f32 v46, v46
    s_mov_b64 exec, s[52:53]
    ds_read_b128 v[20:23], v117 offset:25600
    s_mov_b64 exec, -1
    v_exp_f32 v47, v47
    v_cvt_pk_bf16_f32 v26, v44, v45
    v_cvt_pk_bf16_f32 v27, v46, v47
    v_exp_f32 v48, v48
    v_exp_f32 v49, v49
    v_exp_f32 v50, v50
    v_cvt_pk_bf16_f32 v28, v48, v49
    s_waitcnt lgkmcnt(2)
    v_mfma_f32_32x32x16_bf16 v[72:87], v[16:19], v[24:27], v[72:87]
    v_exp_f32 v51, v51
    v_exp_f32 v52, v52
    v_cvt_pk_bf16_f32 v29, v50, v51
    v_exp_f32 v53, v53
    v_exp_f32 v54, v54
    v_exp_f32 v55, v55
    v_cvt_pk_bf16_f32 v30, v52, v53
    v_cvt_pk_bf16_f32 v31, v54, v55
    s_waitcnt lgkmcnt(1)
    v_mfma_f32_32x32x16_bf16 v[40:55], v[12:15], v[4:7], v[128:143]
    v_exp_f32 v56, v56
    s_add_u32 m0, s96, 12288
    s_add_u32 s62, s97, 98304
    buffer_load_dwordx4 v105, s[28:31], s62 offen lds
    v_exp_f32 v57, v57
    v_exp_f32 v58, v58
    v_exp_f32 v59, v59
    v_exp_f32 v60, v60
    v_cvt_pk_bf16_f32 v24, v56, v57
    v_exp_f32 v61, v61
    v_cvt_pk_bf16_f32 v25, v58, v59
    s_waitcnt lgkmcnt(0)
    v_mfma_f32_32x32x16_bf16 v[72:87], v[20:23], v[28:31], v[72:87]
    v_exp_f32 v62, v62
    s_add_u32 m0, s98, 24576
    s_add_u32 s62, s99, 49152
    buffer_load_dwordx4 v105, s[32:35], s62 offen lds
    v_exp_f32 v63, v63
    v_cvt_pk_bf16_f32 v26, v60, v61
    v_cvt_pk_bf16_f32 v27, v62, v63
    v_exp_f32 v64, v64
    v_exp_f32 v65, v65
    v_exp_f32 v66, v66
    v_cvt_pk_bf16_f32 v28, v64, v65
    v_mfma_f32_32x32x16_bf16 v[88:103], v[16:19], v[24:27], v[88:103]
    v_exp_f32 v67, v67
    s_mov_b64 exec, s[52:53]
    ds_read_b128 v[16:19], v117 offset:24576
    s_mov_b64 exec, -1
    v_exp_f32 v68, v68
    v_cvt_pk_bf16_f32 v29, v66, v67
    v_exp_f32 v69, v69
    v_exp_f32 v70, v70
    v_exp_f32 v71, v71
    v_cvt_pk_bf16_f32 v30, v68, v69
    v_cvt_pk_bf16_f32 v31, v70, v71
    s_waitcnt vmcnt(5)
    s_barrier
    v_mfma_f32_32x32x16_bf16 v[56:71], v[12:15], v[8:11], v[144:159]
    v_exp_f32 v40, v40
    v_exp_f32 v41, v41
    v_exp_f32 v42, v42
    v_exp_f32 v43, v43
    v_exp_f32 v44, v44
    v_cvt_pk_bf16_f32 v24, v40, v41
    v_exp_f32 v45, v45
    v_cvt_pk_bf16_f32 v25, v42, v43
    v_mfma_f32_32x32x16_bf16 v[88:103], v[20:23], v[28:31], v[88:103]
    v_exp_f32 v46, v46
    s_mov_b64 exec, s[52:53]
    ds_read_b128 v[20:23], v117 offset:37888
    s_mov_b64 exec, -1
    v_exp_f32 v47, v47
    v_cvt_pk_bf16_f32 v26, v44, v45
    v_cvt_pk_bf16_f32 v27, v46, v47
    v_exp_f32 v48, v48
    v_exp_f32 v49, v49
    v_exp_f32 v50, v50
    v_cvt_pk_bf16_f32 v28, v48, v49
    s_waitcnt lgkmcnt(1)
    v_mfma_f32_32x32x16_bf16 v[72:87], v[16:19], v[24:27], v[72:87]
    v_exp_f32 v51, v51
    v_exp_f32 v52, v52
    v_cvt_pk_bf16_f32 v29, v50, v51
    v_exp_f32 v53, v53
    v_exp_f32 v54, v54
    v_exp_f32 v55, v55
    v_cvt_pk_bf16_f32 v30, v52, v53
    v_cvt_pk_bf16_f32 v31, v54, v55
    v_exp_f32 v56, v56
    s_add_u32 m0, s96, 14336
    s_add_u32 s62, s97, 114688
    buffer_load_dwordx4 v105, s[28:31], s62 offen lds
    v_exp_f32 v57, v57
    v_exp_f32 v58, v58
    v_exp_f32 v59, v59
    v_exp_f32 v60, v60
    v_cvt_pk_bf16_f32 v24, v56, v57
    v_exp_f32 v61, v61
    v_cvt_pk_bf16_f32 v25, v58, v59
    s_waitcnt lgkmcnt(0)
    v_mfma_f32_32x32x16_bf16 v[72:87], v[20:23], v[28:31], v[72:87]
    v_exp_f32 v62, v62
    s_add_u32 m0, s98, 32768
    s_add_u32 s62, s99, 65536
    buffer_load_dwordx4 v105, s[32:35], s62 offen lds
    v_subrev_u32 v110, 0, v106
    ds_read_b64_tr_b16 v[240:241], v110 offset:0
    ds_read_b64_tr_b16 v[242:243], v110 offset:1024
    ds_read_b64_tr_b16 v[244:245], v110 offset:256
    ds_read_b64_tr_b16 v[246:247], v110 offset:1280
    ds_read_b64_tr_b16 v[248:249], v110 offset:8192
    ds_read_b64_tr_b16 v[250:251], v110 offset:9216
    ds_read_b64_tr_b16 v[252:253], v110 offset:8448
    ds_read_b64_tr_b16 v[254:255], v110 offset:9472
    v_exp_f32 v63, v63
    v_cvt_pk_bf16_f32 v26, v60, v61
    v_cvt_pk_bf16_f32 v27, v62, v63
    v_exp_f32 v64, v64
    v_exp_f32 v65, v65
    v_exp_f32 v66, v66
    v_cvt_pk_bf16_f32 v28, v64, v65
    v_mfma_f32_32x32x16_bf16 v[88:103], v[16:19], v[24:27], v[88:103]
    v_exp_f32 v67, v67
    v_exp_f32 v68, v68
    v_cvt_pk_bf16_f32 v29, v66, v67
    v_exp_f32 v69, v69
    v_exp_f32 v70, v70
    v_exp_f32 v71, v71
    v_cvt_pk_bf16_f32 v30, v68, v69
    v_cvt_pk_bf16_f32 v31, v70, v71
    s_nop 1
    v_mfma_f32_32x32x16_bf16 v[88:103], v[20:23], v[28:31], v[88:103]
    s_waitcnt lgkmcnt(0)
    s_barrier
    s_lshl_b32 s70, s46, 1
    s_add_u32 s70, s70, s49
    v_lshlrev_b32 v225, 4, v1
    s_mul_i32 s64, s48, 7168
    s_add_u32 s64, s64, 40960
    v_add_u32 v228, s64, v225
    s_xor_b32 s65, s48, 4
    s_mul_i32 s65, s65, 7168
    s_add_u32 s65, s65, 40960
    v_add_u32 v229, s65, v225
    s_mul_i32 s63, s70, 88
    s_lshl_b32 s64, s47, 2
    s_add_u32 s64, s64, s50
    s_add_u32 s68, s63, s64
    s_lshl_b32 s68, s68, 10
    s_add_u32 s68, s68, 9699328
    s_lshl_b32 s64, s64, 1
    s_add_u32 s69, s63, s64
    s_add_u32 s69, s69, 32
    s_lshl_b32 s69, s69, 10
    s_add_u32 s69, s69, 9699328
    s_nop 7
    s_cmp_eq_u32 s49, 0
    s_cbranch_scc0 parallel_sum__grouped_kv_mqa__mixer_gmlp__prompt_kernel_b2_x1
    ds_write_b128 v228, v[88:91] offset:0
    ds_write_b128 v228, v[92:95] offset:1024
    ds_write_b128 v228, v[96:99] offset:2048
    s_waitcnt lgkmcnt(0)
    s_barrier
    ds_read_b128 v[88:91], v229 offset:0
    ds_read_b128 v[92:95], v229 offset:1024
    ds_read_b128 v[96:99], v229 offset:2048
    s_waitcnt lgkmcnt(0)
    v_add_f32 v72, v72, v88
    v_add_f32 v73, v73, v89
    v_add_f32 v74, v74, v90
    v_add_f32 v75, v75, v91
    v_add_f32 v76, v76, v92
    v_add_f32 v77, v77, v93
    v_add_f32 v78, v78, v94
    v_add_f32 v79, v79, v95
    v_add_f32 v80, v80, v96
    v_mul_f32 v230, 0, v72
    v_fma_f32 v230, v73, 0, v230
    v_fma_f32 v230, v74, 0, v230
    v_fma_f32 v230, v75, 0, v230
    v_fma_f32 v230, v76, 0, v230
    v_fma_f32 v230, v77, 0, v230
    v_fma_f32 v230, v78, 0, v230
    v_fma_f32 v230, v79, 0, v230
    s_mov_b32 s64, 0x5f800000
    v_cmp_u_f32 vcc, v230, v230
    v_cmp_nle_f32 s[66:67], v80, s64
    s_nop 1
    s_or_b64 vcc, vcc, s[66:67]
    s_cbranch_vccnz parallel_sum__grouped_kv_mqa__mixer_gmlp__prompt_kernel_b2_v0_fb
parallel_sum__grouped_kv_mqa__mixer_gmlp__prompt_kernel_b2_v0_ok:
    v_rcp_f32 v230, v80
    s_waitcnt lgkmcnt(0)
    v_mul_f32 v72, v72, v230
    v_mul_f32 v73, v73, v230
    v_mul_f32 v74, v74, v230
    v_mul_f32 v75, v75, v230
    v_mul_f32 v76, v76, v230
    v_mul_f32 v77, v77, v230
    v_mul_f32 v78, v78, v230
    v_mul_f32 v79, v79, v230
    v_cvt_pk_bf16_f32 v24, v72, v73
    v_cvt_pk_bf16_f32 v25, v74, v75
    v_cvt_pk_bf16_f32 v26, v76, v77
    v_cvt_pk_bf16_f32 v27, v78, v79
    buffer_store_dwordx4 v[24:27], v225, s[4:7], s68 offen sc1
    s_branch parallel_sum__grouped_kv_mqa__mixer_gmlp__prompt_kernel_b2_x2
parallel_sum__grouped_kv_mqa__mixer_gmlp__prompt_kernel_b2_x1:
    ds_write_b128 v228, v[72:75] offset:0
    ds_write_b128 v228, v[76:79] offset:1024
    ds_write_b128 v228, v[80:83] offset:2048
    s_waitcnt lgkmcnt(0)
    s_barrier
    ds_read_b128 v[72:75], v229 offset:0
    ds_read_b128 v[76:79], v229 offset:1024
    ds_read_b128 v[80:83], v229 offset:2048
    s_waitcnt lgkmcnt(0)
    v_add_f32 v88, v88, v72
    v_add_f32 v89, v89, v73
    v_add_f32 v90, v90, v74
    v_add_f32 v91, v91, v75
    v_add_f32 v92, v92, v76
    v_add_f32 v93, v93, v77
    v_add_f32 v94, v94, v78
    v_add_f32 v95, v95, v79
    v_add_f32 v96, v96, v80
    v_mul_f32 v230, 0, v88
    v_fma_f32 v230, v89, 0, v230
    v_fma_f32 v230, v90, 0, v230
    v_fma_f32 v230, v91, 0, v230
    v_fma_f32 v230, v92, 0, v230
    v_fma_f32 v230, v93, 0, v230
    v_fma_f32 v230, v94, 0, v230
    v_fma_f32 v230, v95, 0, v230
    s_mov_b32 s64, 0x5f800000
    v_cmp_u_f32 vcc, v230, v230
    v_cmp_nle_f32 s[66:67], v96, s64
    s_nop 1
    s_or_b64 vcc, vcc, s[66:67]
    s_cbranch_vccnz parallel_sum__grouped_kv_mqa__mixer_gmlp__prompt_kernel_b2_v1_fb
parallel_sum__grouped_kv_mqa__mixer_gmlp__prompt_kernel_b2_v1_ok:
    v_rcp_f32 v230, v96
    s_waitcnt lgkmcnt(0)
    v_mul_f32 v88, v88, v230
    v_mul_f32 v89, v89, v230
    v_mul_f32 v90, v90, v230
    v_mul_f32 v91, v91, v230
    v_mul_f32 v92, v92, v230
    v_mul_f32 v93, v93, v230
    v_mul_f32 v94, v94, v230
    v_mul_f32 v95, v95, v230
    v_cvt_pk_bf16_f32 v24, v88, v89
    v_cvt_pk_bf16_f32 v25, v90, v91
    v_cvt_pk_bf16_f32 v26, v92, v93
    v_cvt_pk_bf16_f32 v27, v94, v95
    buffer_store_dwordx4 v[24:27], v225, s[4:7], s68 offen sc1
parallel_sum__grouped_kv_mqa__mixer_gmlp__prompt_kernel_b2_x2:
    s_branch parallel_sum__grouped_kv_mqa__mixer_gmlp__prompt_kernel_p3
parallel_sum__grouped_kv_mqa__mixer_gmlp__prompt_kernel_a2_v0_fb:
    v_add_u32 v234, 2097152, v225
    v_mov_b32 v235, 0xff800000
    s_mov_b32 s64, 0
parallel_sum__grouped_kv_mqa__mixer_gmlp__prompt_kernel_a2_v0_fb1:
    buffer_load_dwordx4 v[32:35], v234, s[4:7], s64 offen sc1
    s_waitcnt vmcnt(0)
    v_mfma_f32_32x32x16_bf16 v[40:55], v[32:35], v[4:7], 0
    s_nop 7
    s_nop 7
    v_max3_f32 v235, v235, v40, v41
    v_max3_f32 v235, v235, v42, v43
    v_max3_f32 v235, v235, v44, v45
    v_max3_f32 v235, v235, v46, v47
    v_max3_f32 v235, v235, v48, v49
    v_max3_f32 v235, v235, v50, v51
    v_max3_f32 v235, v235, v52, v53
    v_max3_f32 v235, v235, v54, v55
    s_add_u32 s64, s64, 1024
    s_cmp_lt_u32 s64, 65536
    s_cbranch_scc1 parallel_sum__grouped_kv_mqa__mixer_gmlp__prompt_kernel_a2_v0_fb1
    v_mov_b32 v236, v235
    s_nop 1
    v_permlane32_swap_b32 v235, v236
    s_nop 1
    v_max_f32 v235, v235, v236
    v_sub_f32 v56, 0, v235
    v_mov_b32 v88, 0
    v_sub_f32 v57, 0, v235
    v_mov_b32 v89, 0
    v_sub_f32 v58, 0, v235
    v_mov_b32 v90, 0
    v_sub_f32 v59, 0, v235
    v_mov_b32 v91, 0
    v_sub_f32 v60, 0, v235
    v_mov_b32 v92, 0
    v_sub_f32 v61, 0, v235
    v_mov_b32 v93, 0
    v_sub_f32 v62, 0, v235
    v_mov_b32 v94, 0
    v_sub_f32 v63, 0, v235
    v_mov_b32 v95, 0
    v_sub_f32 v64, 0, v235
    v_mov_b32 v96, 0
    v_sub_f32 v65, 0, v235
    v_mov_b32 v97, 0
    v_sub_f32 v66, 0, v235
    v_mov_b32 v98, 0
    v_sub_f32 v67, 0, v235
    v_mov_b32 v99, 0
    v_sub_f32 v68, 0, v235
    v_mov_b32 v100, 0
    v_sub_f32 v69, 0, v235
    v_mov_b32 v101, 0
    v_sub_f32 v70, 0, v235
    v_mov_b32 v102, 0
    v_sub_f32 v71, 0, v235
    v_mov_b32 v103, 0
    v_and_b32 v236, 15, v0
    v_lshlrev_b32 v236, 4, v236
    v_lshl_add_u32 v236, v2, 8, v236
    v_add_u32 v236, 2162688, v236
    s_mov_b32 s64, 0
parallel_sum__grouped_kv_mqa__mixer_gmlp__prompt_kernel_a2_v0_fb2:
    buffer_load_dwordx4 v[32:35], v234, s[4:7], s64 offen sc1
    s_mov_b64 exec, s[52:53]
    buffer_load_dwordx4 v[16:19], v236, s[4:7], s64 offen sc1
    buffer_load_dwordx4 v[20:23], v236, s[4:7], s64 offen offset:512 sc1
    s_mov_b64 exec, -1
    s_waitcnt vmcnt(0)
    v_mfma_f32_32x32x16_bf16 v[40:55], v[32:35], v[4:7], v[56:71]
    s_nop 7
    s_nop 7
    v_exp_f32 v40, v40
    v_exp_f32 v41, v41
    v_exp_f32 v42, v42
    v_exp_f32 v43, v43
    v_exp_f32 v44, v44
    v_exp_f32 v45, v45
    v_exp_f32 v46, v46
    v_exp_f32 v47, v47
    v_exp_f32 v48, v48
    v_exp_f32 v49, v49
    v_exp_f32 v50, v50
    v_exp_f32 v51, v51
    v_exp_f32 v52, v52
    v_exp_f32 v53, v53
    v_exp_f32 v54, v54
    v_exp_f32 v55, v55
    s_nop 0
    v_cvt_pk_bf16_f32 v24, v40, v41
    v_cvt_pk_bf16_f32 v25, v42, v43
    v_cvt_pk_bf16_f32 v26, v44, v45
    v_cvt_pk_bf16_f32 v27, v46, v47
    v_cvt_pk_bf16_f32 v28, v48, v49
    v_cvt_pk_bf16_f32 v29, v50, v51
    v_cvt_pk_bf16_f32 v30, v52, v53
    v_cvt_pk_bf16_f32 v31, v54, v55
    s_nop 1
    v_mfma_f32_32x32x16_bf16 v[88:103], v[16:19], v[24:27], v[88:103]
    v_mfma_f32_32x32x16_bf16 v[88:103], v[20:23], v[28:31], v[88:103]
    s_add_u32 s64, s64, 1024
    s_cmp_lt_u32 s64, 65536
    s_cbranch_scc1 parallel_sum__grouped_kv_mqa__mixer_gmlp__prompt_kernel_a2_v0_fb2
    s_nop 7
    s_nop 7
    v_mov_b32 v72, v88
    v_mov_b32 v73, v89
    v_mov_b32 v74, v90
    v_mov_b32 v75, v91
    v_mov_b32 v76, v92
    v_mov_b32 v77, v93
    v_mov_b32 v78, v94
    v_mov_b32 v79, v95
    v_mov_b32 v80, v96
    s_branch parallel_sum__grouped_kv_mqa__mixer_gmlp__prompt_kernel_a2_v0_ok
parallel_sum__grouped_kv_mqa__mixer_gmlp__prompt_kernel_a2_v1_fb:
    v_add_u32 v234, 2097152, v225
    v_mov_b32 v235, 0xff800000
    s_mov_b32 s64, 0
parallel_sum__grouped_kv_mqa__mixer_gmlp__prompt_kernel_a2_v1_fb1:
    buffer_load_dwordx4 v[32:35], v234, s[4:7], s64 offen sc1
    s_waitcnt vmcnt(0)
    v_mfma_f32_32x32x16_bf16 v[40:55], v[32:35], v[8:11], 0
    s_nop 7
    s_nop 7
    v_max3_f32 v235, v235, v40, v41
    v_max3_f32 v235, v235, v42, v43
    v_max3_f32 v235, v235, v44, v45
    v_max3_f32 v235, v235, v46, v47
    v_max3_f32 v235, v235, v48, v49
    v_max3_f32 v235, v235, v50, v51
    v_max3_f32 v235, v235, v52, v53
    v_max3_f32 v235, v235, v54, v55
    s_add_u32 s64, s64, 1024
    s_cmp_lt_u32 s64, 65536
    s_cbranch_scc1 parallel_sum__grouped_kv_mqa__mixer_gmlp__prompt_kernel_a2_v1_fb1
    v_mov_b32 v236, v235
    s_nop 1
    v_permlane32_swap_b32 v235, v236
    s_nop 1
    v_max_f32 v235, v235, v236
    v_sub_f32 v56, 0, v235
    v_mov_b32 v72, 0
    v_sub_f32 v57, 0, v235
    v_mov_b32 v73, 0
    v_sub_f32 v58, 0, v235
    v_mov_b32 v74, 0
    v_sub_f32 v59, 0, v235
    v_mov_b32 v75, 0
    v_sub_f32 v60, 0, v235
    v_mov_b32 v76, 0
    v_sub_f32 v61, 0, v235
    v_mov_b32 v77, 0
    v_sub_f32 v62, 0, v235
    v_mov_b32 v78, 0
    v_sub_f32 v63, 0, v235
    v_mov_b32 v79, 0
    v_sub_f32 v64, 0, v235
    v_mov_b32 v80, 0
    v_sub_f32 v65, 0, v235
    v_mov_b32 v81, 0
    v_sub_f32 v66, 0, v235
    v_mov_b32 v82, 0
    v_sub_f32 v67, 0, v235
    v_mov_b32 v83, 0
    v_sub_f32 v68, 0, v235
    v_mov_b32 v84, 0
    v_sub_f32 v69, 0, v235
    v_mov_b32 v85, 0
    v_sub_f32 v70, 0, v235
    v_mov_b32 v86, 0
    v_sub_f32 v71, 0, v235
    v_mov_b32 v87, 0
    v_and_b32 v236, 15, v0
    v_lshlrev_b32 v236, 4, v236
    v_lshl_add_u32 v236, v2, 8, v236
    v_add_u32 v236, 2162688, v236
    s_mov_b32 s64, 0
parallel_sum__grouped_kv_mqa__mixer_gmlp__prompt_kernel_a2_v1_fb2:
    buffer_load_dwordx4 v[32:35], v234, s[4:7], s64 offen sc1
    s_mov_b64 exec, s[52:53]
    buffer_load_dwordx4 v[16:19], v236, s[4:7], s64 offen sc1
    buffer_load_dwordx4 v[20:23], v236, s[4:7], s64 offen offset:512 sc1
    s_mov_b64 exec, -1
    s_waitcnt vmcnt(0)
    v_mfma_f32_32x32x16_bf16 v[40:55], v[32:35], v[8:11], v[56:71]
    s_nop 7
    s_nop 7
    v_exp_f32 v40, v40
    v_exp_f32 v41, v41
    v_exp_f32 v42, v42
    v_exp_f32 v43, v43
    v_exp_f32 v44, v44
    v_exp_f32 v45, v45
    v_exp_f32 v46, v46
    v_exp_f32 v47, v47
    v_exp_f32 v48, v48
    v_exp_f32 v49, v49
    v_exp_f32 v50, v50
    v_exp_f32 v51, v51
    v_exp_f32 v52, v52
    v_exp_f32 v53, v53
    v_exp_f32 v54, v54
    v_exp_f32 v55, v55
    s_nop 0
    v_cvt_pk_bf16_f32 v24, v40, v41
    v_cvt_pk_bf16_f32 v25, v42, v43
    v_cvt_pk_bf16_f32 v26, v44, v45
    v_cvt_pk_bf16_f32 v27, v46, v47
    v_cvt_pk_bf16_f32 v28, v48, v49
    v_cvt_pk_bf16_f32 v29, v50, v51
    v_cvt_pk_bf16_f32 v30, v52, v53
    v_cvt_pk_bf16_f32 v31, v54, v55
    s_nop 1
    v_mfma_f32_32x32x16_bf16 v[72:87], v[16:19], v[24:27], v[72:87]
    v_mfma_f32_32x32x16_bf16 v[72:87], v[20:23], v[28:31], v[72:87]
    s_add_u32 s64, s64, 1024
    s_cmp_lt_u32 s64, 65536
    s_cbranch_scc1 parallel_sum__grouped_kv_mqa__mixer_gmlp__prompt_kernel_a2_v1_fb2
    s_nop 7
    s_nop 7
    v_mov_b32 v88, v72
    v_mov_b32 v89, v73
    v_mov_b32 v90, v74
    v_mov_b32 v91, v75
    v_mov_b32 v92, v76
    v_mov_b32 v93, v77
    v_mov_b32 v94, v78
    v_mov_b32 v95, v79
    v_mov_b32 v96, v80
    s_branch parallel_sum__grouped_kv_mqa__mixer_gmlp__prompt_kernel_a2_v1_ok
parallel_sum__grouped_kv_mqa__mixer_gmlp__prompt_kernel_b2_v0_fb:
    v_add_u32 v234, 2097152, v225
    v_mov_b32 v235, 0xff800000
    s_mov_b32 s64, 0
parallel_sum__grouped_kv_mqa__mixer_gmlp__prompt_kernel_b2_v0_fb1:
    buffer_load_dwordx4 v[32:35], v234, s[4:7], s64 offen sc1
    s_waitcnt vmcnt(0)
    v_mfma_f32_32x32x16_bf16 v[40:55], v[32:35], v[4:7], 0
    s_nop 7
    s_nop 7
    v_max3_f32 v235, v235, v40, v41
    v_max3_f32 v235, v235, v42, v43
    v_max3_f32 v235, v235, v44, v45
    v_max3_f32 v235, v235, v46, v47
    v_max3_f32 v235, v235, v48, v49
    v_max3_f32 v235, v235, v50, v51
    v_max3_f32 v235, v235, v52, v53
    v_max3_f32 v235, v235, v54, v55
    s_add_u32 s64, s64, 1024
    s_cmp_lt_u32 s64, 65536
    s_cbranch_scc1 parallel_sum__grouped_kv_mqa__mixer_gmlp__prompt_kernel_b2_v0_fb1
    v_mov_b32 v236, v235
    s_nop 1
    v_permlane32_swap_b32 v235, v236
    s_nop 1
    v_max_f32 v235, v235, v236
    v_sub_f32 v56, 0, v235
    v_mov_b32 v88, 0
    v_sub_f32 v57, 0, v235
    v_mov_b32 v89, 0
    v_sub_f32 v58, 0, v235
    v_mov_b32 v90, 0
    v_sub_f32 v59, 0, v235
    v_mov_b32 v91, 0
    v_sub_f32 v60, 0, v235
    v_mov_b32 v92, 0
    v_sub_f32 v61, 0, v235
    v_mov_b32 v93, 0
    v_sub_f32 v62, 0, v235
    v_mov_b32 v94, 0
    v_sub_f32 v63, 0, v235
    v_mov_b32 v95, 0
    v_sub_f32 v64, 0, v235
    v_mov_b32 v96, 0
    v_sub_f32 v65, 0, v235
    v_mov_b32 v97, 0
    v_sub_f32 v66, 0, v235
    v_mov_b32 v98, 0
    v_sub_f32 v67, 0, v235
    v_mov_b32 v99, 0
    v_sub_f32 v68, 0, v235
    v_mov_b32 v100, 0
    v_sub_f32 v69, 0, v235
    v_mov_b32 v101, 0
    v_sub_f32 v70, 0, v235
    v_mov_b32 v102, 0
    v_sub_f32 v71, 0, v235
    v_mov_b32 v103, 0
    v_and_b32 v236, 15, v0
    v_lshlrev_b32 v236, 4, v236
    v_lshl_add_u32 v236, v2, 8, v236
    v_add_u32 v236, 2162688, v236
    s_mov_b32 s64, 0
parallel_sum__grouped_kv_mqa__mixer_gmlp__prompt_kernel_b2_v0_fb2:
    buffer_load_dwordx4 v[32:35], v234, s[4:7], s64 offen sc1
    s_mov_b64 exec, s[52:53]
    buffer_load_dwordx4 v[16:19], v236, s[4:7], s64 offen sc1
    buffer_load_dwordx4 v[20:23], v236, s[4:7], s64 offen offset:512 sc1
    s_mov_b64 exec, -1
    s_waitcnt vmcnt(0)
    v_mfma_f32_32x32x16_bf16 v[40:55], v[32:35], v[4:7], v[56:71]
    s_nop 7
    s_nop 7
    v_exp_f32 v40, v40
    v_exp_f32 v41, v41
    v_exp_f32 v42, v42
    v_exp_f32 v43, v43
    v_exp_f32 v44, v44
    v_exp_f32 v45, v45
    v_exp_f32 v46, v46
    v_exp_f32 v47, v47
    v_exp_f32 v48, v48
    v_exp_f32 v49, v49
    v_exp_f32 v50, v50
    v_exp_f32 v51, v51
    v_exp_f32 v52, v52
    v_exp_f32 v53, v53
    v_exp_f32 v54, v54
    v_exp_f32 v55, v55
    s_nop 0
    v_cvt_pk_bf16_f32 v24, v40, v41
    v_cvt_pk_bf16_f32 v25, v42, v43
    v_cvt_pk_bf16_f32 v26, v44, v45
    v_cvt_pk_bf16_f32 v27, v46, v47
    v_cvt_pk_bf16_f32 v28, v48, v49
    v_cvt_pk_bf16_f32 v29, v50, v51
    v_cvt_pk_bf16_f32 v30, v52, v53
    v_cvt_pk_bf16_f32 v31, v54, v55
    s_nop 1
    v_mfma_f32_32x32x16_bf16 v[88:103], v[16:19], v[24:27], v[88:103]
    v_mfma_f32_32x32x16_bf16 v[88:103], v[20:23], v[28:31], v[88:103]
    s_add_u32 s64, s64, 1024
    s_cmp_lt_u32 s64, 65536
    s_cbranch_scc1 parallel_sum__grouped_kv_mqa__mixer_gmlp__prompt_kernel_b2_v0_fb2
    s_nop 7
    s_nop 7
    v_mov_b32 v72, v88
    v_mov_b32 v73, v89
    v_mov_b32 v74, v90
    v_mov_b32 v75, v91
    v_mov_b32 v76, v92
    v_mov_b32 v77, v93
    v_mov_b32 v78, v94
    v_mov_b32 v79, v95
    v_mov_b32 v80, v96
    s_branch parallel_sum__grouped_kv_mqa__mixer_gmlp__prompt_kernel_b2_v0_ok
parallel_sum__grouped_kv_mqa__mixer_gmlp__prompt_kernel_b2_v1_fb:
    v_add_u32 v234, 2097152, v225
    v_mov_b32 v235, 0xff800000
    s_mov_b32 s64, 0
parallel_sum__grouped_kv_mqa__mixer_gmlp__prompt_kernel_b2_v1_fb1:
    buffer_load_dwordx4 v[32:35], v234, s[4:7], s64 offen sc1
    s_waitcnt vmcnt(0)
    v_mfma_f32_32x32x16_bf16 v[40:55], v[32:35], v[8:11], 0
    s_nop 7
    s_nop 7
    v_max3_f32 v235, v235, v40, v41
    v_max3_f32 v235, v235, v42, v43
    v_max3_f32 v235, v235, v44, v45
    v_max3_f32 v235, v235, v46, v47
    v_max3_f32 v235, v235, v48, v49
    v_max3_f32 v235, v235, v50, v51
    v_max3_f32 v235, v235, v52, v53
    v_max3_f32 v235, v235, v54, v55
    s_add_u32 s64, s64, 1024
    s_cmp_lt_u32 s64, 65536
    s_cbranch_scc1 parallel_sum__grouped_kv_mqa__mixer_gmlp__prompt_kernel_b2_v1_fb1
    v_mov_b32 v236, v235
    s_nop 1
    v_permlane32_swap_b32 v235, v236
    s_nop 1
    v_max_f32 v235, v235, v236
    v_sub_f32 v56, 0, v235
    v_mov_b32 v72, 0
    v_sub_f32 v57, 0, v235
    v_mov_b32 v73, 0
    v_sub_f32 v58, 0, v235
    v_mov_b32 v74, 0
    v_sub_f32 v59, 0, v235
    v_mov_b32 v75, 0
    v_sub_f32 v60, 0, v235
    v_mov_b32 v76, 0
    v_sub_f32 v61, 0, v235
    v_mov_b32 v77, 0
    v_sub_f32 v62, 0, v235
    v_mov_b32 v78, 0
    v_sub_f32 v63, 0, v235
    v_mov_b32 v79, 0
    v_sub_f32 v64, 0, v235
    v_mov_b32 v80, 0
    v_sub_f32 v65, 0, v235
    v_mov_b32 v81, 0
    v_sub_f32 v66, 0, v235
    v_mov_b32 v82, 0
    v_sub_f32 v67, 0, v235
    v_mov_b32 v83, 0
    v_sub_f32 v68, 0, v235
    v_mov_b32 v84, 0
    v_sub_f32 v69, 0, v235
    v_mov_b32 v85, 0
    v_sub_f32 v70, 0, v235
    v_mov_b32 v86, 0
    v_sub_f32 v71, 0, v235
    v_mov_b32 v87, 0
    v_and_b32 v236, 15, v0
    v_lshlrev_b32 v236, 4, v236
    v_lshl_add_u32 v236, v2, 8, v236
    v_add_u32 v236, 2162688, v236
    s_mov_b32 s64, 0
parallel_sum__grouped_kv_mqa__mixer_gmlp__prompt_kernel_b2_v1_fb2:
    buffer_load_dwordx4 v[32:35], v234, s[4:7], s64 offen sc1
    s_mov_b64 exec, s[52:53]
    buffer_load_dwordx4 v[16:19], v236, s[4:7], s64 offen sc1
    buffer_load_dwordx4 v[20:23], v236, s[4:7], s64 offen offset:512 sc1
    s_mov_b64 exec, -1
    s_waitcnt vmcnt(0)
    v_mfma_f32_32x32x16_bf16 v[40:55], v[32:35], v[8:11], v[56:71]
    s_nop 7
    s_nop 7
    v_exp_f32 v40, v40
    v_exp_f32 v41, v41
    v_exp_f32 v42, v42
    v_exp_f32 v43, v43
    v_exp_f32 v44, v44
    v_exp_f32 v45, v45
    v_exp_f32 v46, v46
    v_exp_f32 v47, v47
    v_exp_f32 v48, v48
    v_exp_f32 v49, v49
    v_exp_f32 v50, v50
    v_exp_f32 v51, v51
    v_exp_f32 v52, v52
    v_exp_f32 v53, v53
    v_exp_f32 v54, v54
    v_exp_f32 v55, v55
    s_nop 0
    v_cvt_pk_bf16_f32 v24, v40, v41
    v_cvt_pk_bf16_f32 v25, v42, v43
    v_cvt_pk_bf16_f32 v26, v44, v45
    v_cvt_pk_bf16_f32 v27, v46, v47
    v_cvt_pk_bf16_f32 v28, v48, v49
    v_cvt_pk_bf16_f32 v29, v50, v51
    v_cvt_pk_bf16_f32 v30, v52, v53
    v_cvt_pk_bf16_f32 v31, v54, v55
    s_nop 1
    v_mfma_f32_32x32x16_bf16 v[72:87], v[16:19], v[24:27], v[72:87]
    v_mfma_f32_32x32x16_bf16 v[72:87], v[20:23], v[28:31], v[72:87]
    s_add_u32 s64, s64, 1024
    s_cmp_lt_u32 s64, 65536
    s_cbranch_scc1 parallel_sum__grouped_kv_mqa__mixer_gmlp__prompt_kernel_b2_v1_fb2
    s_nop 7
    s_nop 7
    v_mov_b32 v88, v72
    v_mov_b32 v89, v73
    v_mov_b32 v90, v74
    v_mov_b32 v91, v75
    v_mov_b32 v92, v76
    v_mov_b32 v93, v77
    v_mov_b32 v94, v78
    v_mov_b32 v95, v79
    v_mov_b32 v96, v80
    s_branch parallel_sum__grouped_kv_mqa__mixer_gmlp__prompt_kernel_b2_v1_ok
parallel_sum__grouped_kv_mqa__mixer_gmlp__prompt_kernel_last:
    s_endpgm
.section .rodata,"a"
.p2align 6
.amdhsa_kernel parallel_sum__grouped_kv_mqa__mixer_gmlp__prompt_kernel
  .amdhsa_next_free_vgpr 256
  .amdhsa_next_free_sgpr 102
  .amdhsa_accum_offset 256
  .amdhsa_group_segment_fixed_size 0
  .amdhsa_kernarg_size 104
  .amdhsa_user_sgpr_count 2
  .amdhsa_user_sgpr_kernarg_segment_ptr 1
  .amdhsa_system_sgpr_workgroup_id_x 1
  .amdhsa_float_denorm_mode_32 3
.end_amdhsa_kernel
```
